```python
import torch

def _softmax(x, axis=-1):
    return torch.softmax(x, dim=axis)

def _gelu(x):
    return torch.nn.functional.gelu(x, approximate='tanh')

def _silu(x):
    return torch.nn.functional.silu(x)

def _sigmoid(x):
    return torch.sigmoid(x)

def _layernorm(x, axis=-1, eps=1e-05):
    m = x.mean(dim=axis, keepdim=True)
    v = x.var(dim=axis, keepdim=True, unbiased=False)
    return (x - m) / torch.sqrt(v + eps)

def _scatter_add(tgt, idx, src, axis=0):
    return tgt.clone().index_add_(axis, idx, src)

def _segment_sum(src, seg, n):
    out = torch.zeros((n,) + src.shape[1:], dtype=src.dtype)
    return out.index_add_(0, seg, src)

def _pad(x, pw):
    flat = tuple((v for pair in reversed(pw) for v in pair))
    return torch.nn.functional.pad(x, flat)
kernel_name = 'standalone__dit_adaln_block__diffusion'

def setup_inputs():

    _w = lambda a: (lambda t: t.to(torch.bfloat16) if t.is_floating_point() else t)(torch.as_tensor(a))
    B, N, D = (2, 1024, 768)
    return {'x': _w((lambda *s: torch.randn(*s, dtype=torch.bfloat16) * 0.05)(B, N, D)), 'c': _w((lambda *s: torch.randn(*s, dtype=torch.bfloat16) * 0.2)(B, D)), 'wqkv': _w((lambda *s: torch.randn(*s, dtype=torch.bfloat16) * 0.05)(D, 3 * D)), 'wo': _w((lambda *s: torch.randn(*s, dtype=torch.bfloat16) * 0.05)(D, D)), 'w_mod': _w((lambda *s: torch.randn(*s, dtype=torch.bfloat16) * 0.2)(D, 6 * D))}

def reference(x, c, wqkv, wo, w_mod):
    B, N, D = x.shape
    mod = (_silu(c) @ w_mod).reshape(B, 6, 1, D)
    shift_a, scale_a, gate_a, shift_m, scale_m, gate_m = [mod[:, i] for i in range(6)]
    h = _layernorm(x, axis=-1) * (1 + scale_a) + shift_a
    qkv = h @ wqkv
    q, k, v = (qkv[..., :D].clone(), qkv[..., D:2 * D].clone(), qkv[..., 2 * D:].clone())
    p = _softmax(torch.einsum('bqd,bkd->bqk', q, k) * D ** (-0.5), axis=-1)
    a = torch.einsum('bqk,bkd->bqd', p, v) @ wo
    return x + gate_a * a
```

```asm
; @launch grid=(256,1,1) block=(256,1,1) lds=163840
.amdgcn_target "amdgcn-amd-amdhsa--gfx950"
.text
.globl standalone__dit_adaln_block__diffusion_kernel
.p2align 8
.type standalone__dit_adaln_block__diffusion_kernel,@function
standalone__dit_adaln_block__diffusion_kernel:
    s_cmp_ge_u32 s2, 256
    s_cbranch_scc1 L_exit
    s_load_dwordx4 s[64:67], s[0:1], 0
    s_load_dwordx4 s[68:71], s[0:1], 16
    s_load_dwordx4 s[72:75], s[0:1], 32
    s_load_dwordx4 s[76:79], s[0:1], 48
    v_and_b32 v255, 63, v0
    v_lshrrev_b32 v1, 6, v0
    v_lshlrev_b32 v254, 4, v255
    v_readfirstlane_b32 s20, v1
    s_nop 3
    s_and_b32 s60, s2, 56
    s_cmp_eq_u32 s60, 0
    s_cbranch_scc0 cpe_1
    s_cmp_lt_u32 s20, 3
    s_cbranch_scc0 cpe_1
    s_getpc_b64 s[60:61]
cpe_pc_2:
    s_mov_b32 s62, L_early-cpe_pc_2
    s_cmp_eq_u32 s20, 1
    s_cselect_b32 s62, L_mh-cpe_pc_2, s62
    s_cmp_eq_u32 s20, 2
    s_cselect_b32 s62, w_main1-cpe_pc_2, s62
    s_add_u32 s60, s60, s62
    s_addc_u32 s61, s61, 0
    v_lshlrev_b32 v228, 6, v255
    v_mov_b32 v229, s61
    v_add_co_u32 v228, vcc, s60, v228
    v_addc_co_u32 v229, vcc, 0, v229, vcc
    global_load_dword v230, v[228:229], off
    v_add_co_u32 v228, vcc, 4096, v228
    v_addc_co_u32 v229, vcc, 0, v229, vcc
    global_load_dword v231, v[228:229], off
cpe_1:
L_early:
    s_and_b32 s32, s2, 7
    s_lshr_b32 s33, s2, 3
    s_lshr_b32 s34, s32, 2
    s_lshr_b32 s35, s32, 1
    s_and_b32 s35, s35, 1
    s_lshl_b32 s35, s35, 2
    s_lshr_b32 s60, s33, 2
    s_and_b32 s60, s60, 3
    s_add_u32 s35, s35, s60
    s_and_b32 s36, s32, 1
    s_lshl_b32 s36, s36, 3
    s_lshr_b32 s60, s33, 4
    s_lshl_b32 s60, s60, 2
    s_add_u32 s36, s36, s60
    s_and_b32 s60, s33, 3
    s_add_u32 s36, s36, s60
    s_and_b32 s3, s32, 1
    s_lshl_b32 s3, s3, 2
    s_and_b32 s60, s33, 3
    s_add_u32 s3, s3, s60
    s_cmp_lt_u32 s33, 16
    s_cselect_b32 s60, 8, 0
    s_add_u32 s3, s3, s60
    s_lshr_b32 s56, s32, 1
    s_and_b32 s56, s56, 1
    s_lshl_b32 s56, s56, 3
    s_and_b32 s60, s33, 7
    s_add_u32 s56, s56, s60
    s_and_b32 s57, s32, 1
    s_lshl_b32 s57, s57, 2
    s_lshr_b32 s60, s33, 3
    s_add_u32 s57, s57, s60
    s_lshr_b32 s58, s20, 1
    s_and_b32 s59, s20, 1
    s_waitcnt lgkmcnt(0)
    s_mov_b32 s4, s64
    s_mov_b32 s5, s65
    s_mov_b32 s6, 0x300000
    s_mov_b32 s7, 0x20000
    s_mov_b32 s44, s66
    s_mov_b32 s45, s67
    s_mov_b32 s46, 0xc00
    s_mov_b32 s47, 0x20000
    s_mov_b32 s8, s68
    s_mov_b32 s9, s69
    s_mov_b32 s10, 0x360000
    s_mov_b32 s11, 0x20000
    s_mov_b32 s12, s70
    s_mov_b32 s13, s71
    s_mov_b32 s14, 0x120000
    s_mov_b32 s15, 0x20000
    s_mov_b32 s16, s78
    s_mov_b32 s17, s79
    s_mov_b32 s18, 0x10000000
    s_mov_b32 s19, 0x20000
    v_mov_b32 v250, 262144
    buffer_load_dword v251, v250, s[16:19], 0 offen sc1
    s_mov_b32 s40, s72
    s_mov_b32 s41, s73
    s_mov_b32 s42, 0x6c0000
    s_mov_b32 s43, 0x20000
    s_mov_b32 s48, s74
    s_mov_b32 s49, s75
    s_mov_b32 s50, 0x300000
    s_mov_b32 s51, 0x20000
    s_mov_b32 s52, s76
    s_mov_b32 s53, s77
    s_mov_b32 s54, 0x100
    s_mov_b32 s55, 0x20000
    s_cmp_lt_u32 s33, 16
    s_cbranch_scc0 L_mh
    s_lshr_b32 s21, s32, 2
    s_lshr_b32 s22, s32, 1
    s_and_b32 s22, s22, 1
    s_lshl_b32 s60, s22, 2
    s_lshr_b32 s61, s33, 2
    s_add_u32 s22, s60, s61
    s_and_b32 s23, s32, 1
    s_lshl_b32 s60, s23, 2
    s_and_b32 s61, s33, 3
    s_add_u32 s23, s60, s61
    s_and_b32 s60, s33, 3
    s_lshr_b32 s61, s33, 2
    s_add_u32 s60, s60, s61
    s_and_b32 s60, s60, 3
    s_mul_i32 s24, s60, 3
    s_lshr_b32 s60, s32, 1
    s_xor_b32 s60, s60, s32
    s_and_b32 s60, s60, 1
    s_mul_i32 s60, s60, 1
    s_add_u32 s24, s24, s60
    v_lshrrev_b32 v1, 3, v255
    v_and_b32 v2, 7, v255
    v_lshrrev_b32 v3, 1, v1
    v_xor_b32 v2, v2, v3
    v_mul_u32_u24 v1, 4608, v1
    v_lshlrev_b32 v3, 4, v2
    v_add_u32 v4, v1, v3
    v_xor_b32 v3, 64, v3
    v_add_u32 v5, v1, v3
    s_mul_i32 s25, s22, 96*4608
    s_mul_i32 s60, s20, 24*4608
    s_add_u32 s25, s25, s60
    s_mul_i32 s60, s21, 3072
    s_add_u32 s25, s25, s60
    s_and_b32 s60, s20, 1
    s_cmp_eq_u32 s60, 0
    s_cselect_b64 vcc, -1, 0
    v_cndmask_b32 v6, v5, v4, vcc
    v_cndmask_b32 v7, v4, v5, vcc
    v_mov_b32 v8, v6
    v_add_u32 v7, 35840, v7
    v_add_u32 v8, 71680, v8
    s_cmp_eq_u32 s21, 0
    s_cbranch_scc0 w_setup2
    s_mul_i32 s26, s23, 96*4608
    s_mul_i32 s60, s20, 24*4608
    s_add_u32 s26, s26, s60
    s_add_u32 s26, s26, 1536
    v_mov_b32 v9, v6
    v_mov_b32 v10, v7
    v_mov_b32 v11, v8
    s_branch w_main0
w_setup2:
    v_add_u32 v12, 0, v255
    v_mul_u32_u24 v13, 43691, v12
    v_lshrrev_b32 v13, 19, v13
    v_mul_u32_u24 v14, 12, v13
    v_sub_u32 v14, v12, v14
    v_mul_u32_u24 v13, 1536, v13
    v_lshlrev_b32 v14, 4, v14
    v_add_u32 v9, v13, v14
    v_add_u32 v12, 64, v255
    v_mul_u32_u24 v13, 43691, v12
    v_lshrrev_b32 v13, 19, v13
    v_mul_u32_u24 v14, 12, v13
    v_sub_u32 v14, v12, v14
    v_mul_u32_u24 v13, 1536, v13
    v_lshlrev_b32 v14, 4, v14
    v_add_u32 v10, v13, v14
    v_subrev_u32 v10, 1024, v10
    v_add_u32 v12, 128, v255
    v_mul_u32_u24 v13, 43691, v12
    v_lshrrev_b32 v13, 19, v13
    v_mul_u32_u24 v14, 12, v13
    v_sub_u32 v14, v12, v14
    v_mul_u32_u24 v13, 1536, v13
    v_lshlrev_b32 v14, 4, v14
    v_add_u32 v11, v13, v14
    v_subrev_u32 v11, 2048, v11
    s_mul_i32 s26, s20, 16*1536
    s_mul_i32 s60, s23, 192
    s_add_u32 s26, s26, s60
    s_branch w_main1
w_main0:
    s_mul_i32 s27, s20, 3072
    s_lshl_b32 s28, s24, 7
    s_add_u32 s28, s28, s25
    s_add_u32 m0, s27, 0
    s_nop 0
    buffer_load_dwordx4 v6, s[8:11], s28 offen offset:0 lds
    buffer_load_dwordx4 v7, s[8:11], s28 offen offset:1024 lds
    buffer_load_dwordx4 v8, s[8:11], s28 offen offset:2048 lds
    s_mul_i32 s29, s24, 128
    s_add_u32 s29, s29, s26
    s_add_u32 m0, s27, 12288
    s_nop 0
    buffer_load_dwordx4 v9, s[8:11], s29 offen offset:0 lds
    buffer_load_dwordx4 v10, s[8:11], s29 offen offset:1024 lds
    buffer_load_dwordx4 v11, s[8:11], s29 offen offset:2048 lds
    s_add_u32 s24, s24, 1
    s_cmp_eq_u32 s24, 12
    s_cselect_b32 s24, 0, s24
    s_lshl_b32 s28, s24, 7
    s_add_u32 s28, s28, s25
    s_add_u32 m0, s27, 24576
    s_nop 0
    buffer_load_dwordx4 v6, s[8:11], s28 offen offset:0 lds
    buffer_load_dwordx4 v7, s[8:11], s28 offen offset:1024 lds
    buffer_load_dwordx4 v8, s[8:11], s28 offen offset:2048 lds
    s_mul_i32 s29, s24, 128
    s_add_u32 s29, s29, s26
    s_add_u32 m0, s27, 36864
    s_nop 0
    buffer_load_dwordx4 v9, s[8:11], s29 offen offset:0 lds
    buffer_load_dwordx4 v10, s[8:11], s29 offen offset:1024 lds
    buffer_load_dwordx4 v11, s[8:11], s29 offen offset:2048 lds
    s_add_u32 s24, s24, 1
    s_cmp_eq_u32 s24, 12
    s_cselect_b32 s24, 0, s24
    v_and_b32 v12, 31, v255
    v_lshrrev_b32 v13, 5, v255
    v_lshrrev_b32 v14, 1, v12
    v_and_b32 v14, 7, v14
    v_xor_b32 v14, v14, v13
    v_lshlrev_b32 v14, 4, v14
    v_lshlrev_b32 v12, 7, v12
    v_add_u32 v12, v12, v14
    v_xor_b32 v16, 0, v12
    v_xor_b32 v17, 32, v12
    v_xor_b32 v18, 64, v12
    v_xor_b32 v19, 96, v12
    s_lshl_b32 s60, s20, 12
    v_add_u32 v20, s60, v16
    v_add_u32 v21, s60, v17
    v_add_u32 v22, s60, v18
    v_add_u32 v23, s60, v19
    v_add_u32 v120, 0, v20
    v_add_u32 v132, 0, v16
    v_add_u32 v121, 0, v21
    v_add_u32 v133, 0, v17
    v_add_u32 v122, 0, v22
    v_add_u32 v134, 0, v18
    v_add_u32 v123, 0, v23
    v_add_u32 v135, 0, v19
    v_add_u32 v124, 65536, v20
    v_add_u32 v136, 65536, v16
    v_add_u32 v125, 65536, v21
    v_add_u32 v137, 65536, v17
    v_add_u32 v126, 65536, v22
    v_add_u32 v138, 65536, v18
    v_add_u32 v127, 65536, v23
    v_add_u32 v139, 65536, v19
    v_add_u32 v128, 131072, v20
    v_add_u32 v140, 131072, v16
    v_add_u32 v129, 131072, v21
    v_add_u32 v141, 131072, v17
    v_add_u32 v130, 131072, v22
    v_add_u32 v142, 131072, v18
    v_add_u32 v131, 131072, v23
    v_add_u32 v143, 131072, v19
    s_cmp_eq_u32 s20, 3
    s_cbranch_scc1 w_wave3_3
    s_waitcnt vmcnt(6)
    s_barrier
    ds_read_b128 v[24:27], v120 offset:0
    ds_read_b128 v[28:31], v132 offset:12288
    ds_read_b128 v[32:35], v132 offset:16384
    ds_read_b128 v[36:39], v132 offset:20480
    ds_read_b128 v[40:43], v121 offset:0
    ds_read_b128 v[44:47], v133 offset:12288
    ds_read_b128 v[48:51], v133 offset:16384
    ds_read_b128 v[52:55], v133 offset:20480
    s_waitcnt lgkmcnt(6)
    v_mfma_f32_32x32x16_bf16 v[72:87], v[24:27], v[28:31], 0
    ds_read_b128 v[56:59], v122 offset:0
    ds_read_b128 v[60:63], v134 offset:12288
    s_lshl_b32 s28, s24, 7
    s_add_u32 s28, s28, s25
    s_add_u32 m0, s27, 49152
    s_nop 0
    buffer_load_dwordx4 v6, s[8:11], s28 offen offset:0 lds
    s_waitcnt lgkmcnt(7)
    v_mfma_f32_32x32x16_bf16 v[88:103], v[24:27], v[32:35], 0
    ds_read_b128 v[64:67], v134 offset:16384
    s_waitcnt lgkmcnt(7)
    v_mfma_f32_32x32x16_bf16 v[104:119], v[24:27], v[36:39], 0
    ds_read_b128 v[68:71], v134 offset:20480
    buffer_load_dwordx4 v7, s[8:11], s28 offen offset:1024 lds
    s_waitcnt lgkmcnt(6)
    v_mfma_f32_32x32x16_bf16 v[72:87], v[40:43], v[44:47], v[72:87]
    ds_read_b128 v[24:27], v123 offset:0
    ds_read_b128 v[28:31], v135 offset:12288
    s_waitcnt lgkmcnt(7)
    v_mfma_f32_32x32x16_bf16 v[88:103], v[40:43], v[48:51], v[88:103]
    ds_read_b128 v[32:35], v135 offset:16384
    buffer_load_dwordx4 v8, s[8:11], s28 offen offset:2048 lds
    s_add_u32 s24, s24, 1
    s_cmp_eq_u32 s24, 12
    s_cselect_b32 s24, 0, s24
    s_waitcnt lgkmcnt(7)
    v_mfma_f32_32x32x16_bf16 v[104:119], v[40:43], v[52:55], v[104:119]
    ds_read_b128 v[36:39], v135 offset:20480
    s_waitcnt vmcnt(3)
    s_barrier
    s_waitcnt lgkmcnt(6)
    v_mfma_f32_32x32x16_bf16 v[72:87], v[56:59], v[60:63], v[72:87]
    ds_read_b128 v[40:43], v120 offset:24576
    ds_read_b128 v[44:47], v132 offset:36864
    s_lshl_b32 s28, s24, 7
    s_add_u32 s28, s28, s25
    s_add_u32 m0, s27, 73728
    s_nop 0
    buffer_load_dwordx4 v6, s[8:11], s28 offen offset:0 lds
    s_waitcnt lgkmcnt(7)
    v_mfma_f32_32x32x16_bf16 v[88:103], v[56:59], v[64:67], v[88:103]
    ds_read_b128 v[48:51], v132 offset:40960
    s_waitcnt lgkmcnt(7)
    v_mfma_f32_32x32x16_bf16 v[104:119], v[56:59], v[68:71], v[104:119]
    ds_read_b128 v[52:55], v132 offset:45056
    buffer_load_dwordx4 v7, s[8:11], s28 offen offset:1024 lds
    s_waitcnt lgkmcnt(6)
    v_mfma_f32_32x32x16_bf16 v[72:87], v[24:27], v[28:31], v[72:87]
    ds_read_b128 v[56:59], v121 offset:24576
    ds_read_b128 v[60:63], v133 offset:36864
    s_waitcnt lgkmcnt(7)
    v_mfma_f32_32x32x16_bf16 v[88:103], v[24:27], v[32:35], v[88:103]
    ds_read_b128 v[64:67], v133 offset:40960
    buffer_load_dwordx4 v8, s[8:11], s28 offen offset:2048 lds
    s_add_u32 s24, s24, 1
    s_cmp_eq_u32 s24, 12
    s_cselect_b32 s24, 0, s24
    s_waitcnt lgkmcnt(7)
    v_mfma_f32_32x32x16_bf16 v[104:119], v[24:27], v[36:39], v[104:119]
    ds_read_b128 v[68:71], v133 offset:45056
    s_waitcnt lgkmcnt(6)
    v_mfma_f32_32x32x16_bf16 v[72:87], v[40:43], v[44:47], v[72:87]
    ds_read_b128 v[24:27], v122 offset:24576
    ds_read_b128 v[28:31], v134 offset:36864
    s_waitcnt lgkmcnt(7)
    v_mfma_f32_32x32x16_bf16 v[88:103], v[40:43], v[48:51], v[88:103]
    ds_read_b128 v[32:35], v134 offset:40960
    s_waitcnt lgkmcnt(7)
    v_mfma_f32_32x32x16_bf16 v[104:119], v[40:43], v[52:55], v[104:119]
    ds_read_b128 v[36:39], v134 offset:45056
    s_waitcnt lgkmcnt(6)
    v_mfma_f32_32x32x16_bf16 v[72:87], v[56:59], v[60:63], v[72:87]
    ds_read_b128 v[40:43], v123 offset:24576
    ds_read_b128 v[44:47], v135 offset:36864
    s_waitcnt lgkmcnt(7)
    v_mfma_f32_32x32x16_bf16 v[88:103], v[56:59], v[64:67], v[88:103]
    ds_read_b128 v[48:51], v135 offset:40960
    s_waitcnt lgkmcnt(7)
    v_mfma_f32_32x32x16_bf16 v[104:119], v[56:59], v[68:71], v[104:119]
    ds_read_b128 v[52:55], v135 offset:45056
    s_waitcnt vmcnt(3)
    s_barrier
    s_waitcnt lgkmcnt(6)
    v_mfma_f32_32x32x16_bf16 v[72:87], v[24:27], v[28:31], v[72:87]
    ds_read_b128 v[56:59], v120 offset:49152
    ds_read_b128 v[60:63], v132 offset:61440
    s_lshl_b32 s28, s24, 7
    s_add_u32 s28, s28, s25
    s_add_u32 m0, s27, 98304
    s_nop 0
    buffer_load_dwordx4 v6, s[8:11], s28 offen offset:0 lds
    s_waitcnt lgkmcnt(7)
    v_mfma_f32_32x32x16_bf16 v[88:103], v[24:27], v[32:35], v[88:103]
    ds_read_b128 v[64:67], v136 offset:0
    s_waitcnt lgkmcnt(7)
    v_mfma_f32_32x32x16_bf16 v[104:119], v[24:27], v[36:39], v[104:119]
    ds_read_b128 v[68:71], v136 offset:4096
    buffer_load_dwordx4 v7, s[8:11], s28 offen offset:1024 lds
    s_waitcnt lgkmcnt(6)
    v_mfma_f32_32x32x16_bf16 v[72:87], v[40:43], v[44:47], v[72:87]
    ds_read_b128 v[24:27], v121 offset:49152
    ds_read_b128 v[28:31], v133 offset:61440
    s_waitcnt lgkmcnt(7)
    v_mfma_f32_32x32x16_bf16 v[88:103], v[40:43], v[48:51], v[88:103]
    ds_read_b128 v[32:35], v137 offset:0
    buffer_load_dwordx4 v8, s[8:11], s28 offen offset:2048 lds
    s_add_u32 s24, s24, 1
    s_cmp_eq_u32 s24, 12
    s_cselect_b32 s24, 0, s24
    s_waitcnt lgkmcnt(7)
    v_mfma_f32_32x32x16_bf16 v[104:119], v[40:43], v[52:55], v[104:119]
    ds_read_b128 v[36:39], v137 offset:4096
    s_waitcnt lgkmcnt(6)
    v_mfma_f32_32x32x16_bf16 v[72:87], v[56:59], v[60:63], v[72:87]
    ds_read_b128 v[40:43], v122 offset:49152
    ds_read_b128 v[44:47], v134 offset:61440
    s_waitcnt lgkmcnt(7)
    v_mfma_f32_32x32x16_bf16 v[88:103], v[56:59], v[64:67], v[88:103]
    ds_read_b128 v[48:51], v138 offset:0
    s_waitcnt lgkmcnt(7)
    v_mfma_f32_32x32x16_bf16 v[104:119], v[56:59], v[68:71], v[104:119]
    ds_read_b128 v[52:55], v138 offset:4096
    s_waitcnt lgkmcnt(6)
    v_mfma_f32_32x32x16_bf16 v[72:87], v[24:27], v[28:31], v[72:87]
    ds_read_b128 v[56:59], v123 offset:49152
    ds_read_b128 v[60:63], v135 offset:61440
    s_waitcnt lgkmcnt(7)
    v_mfma_f32_32x32x16_bf16 v[88:103], v[24:27], v[32:35], v[88:103]
    ds_read_b128 v[64:67], v139 offset:0
    s_waitcnt lgkmcnt(7)
    v_mfma_f32_32x32x16_bf16 v[104:119], v[24:27], v[36:39], v[104:119]
    ds_read_b128 v[68:71], v139 offset:4096
    s_waitcnt vmcnt(3)
    s_barrier
    s_waitcnt lgkmcnt(6)
    v_mfma_f32_32x32x16_bf16 v[72:87], v[40:43], v[44:47], v[72:87]
    ds_read_b128 v[24:27], v124 offset:8192
    ds_read_b128 v[28:31], v136 offset:20480
    s_lshl_b32 s28, s24, 7
    s_add_u32 s28, s28, s25
    s_add_u32 m0, s27, 122880
    s_nop 0
    buffer_load_dwordx4 v6, s[8:11], s28 offen offset:0 lds
    s_waitcnt lgkmcnt(7)
    v_mfma_f32_32x32x16_bf16 v[88:103], v[40:43], v[48:51], v[88:103]
    ds_read_b128 v[32:35], v136 offset:24576
    s_waitcnt lgkmcnt(7)
    v_mfma_f32_32x32x16_bf16 v[104:119], v[40:43], v[52:55], v[104:119]
    ds_read_b128 v[36:39], v136 offset:28672
    buffer_load_dwordx4 v7, s[8:11], s28 offen offset:1024 lds
    s_waitcnt lgkmcnt(6)
    v_mfma_f32_32x32x16_bf16 v[72:87], v[56:59], v[60:63], v[72:87]
    ds_read_b128 v[40:43], v125 offset:8192
    ds_read_b128 v[44:47], v137 offset:20480
    s_waitcnt lgkmcnt(7)
    v_mfma_f32_32x32x16_bf16 v[88:103], v[56:59], v[64:67], v[88:103]
    ds_read_b128 v[48:51], v137 offset:24576
    buffer_load_dwordx4 v8, s[8:11], s28 offen offset:2048 lds
    s_add_u32 s24, s24, 1
    s_cmp_eq_u32 s24, 12
    s_cselect_b32 s24, 0, s24
    s_waitcnt lgkmcnt(7)
    v_mfma_f32_32x32x16_bf16 v[104:119], v[56:59], v[68:71], v[104:119]
    ds_read_b128 v[52:55], v137 offset:28672
    s_waitcnt lgkmcnt(6)
    v_mfma_f32_32x32x16_bf16 v[72:87], v[24:27], v[28:31], v[72:87]
    ds_read_b128 v[56:59], v126 offset:8192
    ds_read_b128 v[60:63], v138 offset:20480
    s_waitcnt lgkmcnt(7)
    v_mfma_f32_32x32x16_bf16 v[88:103], v[24:27], v[32:35], v[88:103]
    ds_read_b128 v[64:67], v138 offset:24576
    s_waitcnt lgkmcnt(7)
    v_mfma_f32_32x32x16_bf16 v[104:119], v[24:27], v[36:39], v[104:119]
    ds_read_b128 v[68:71], v138 offset:28672
    s_waitcnt lgkmcnt(6)
    v_mfma_f32_32x32x16_bf16 v[72:87], v[40:43], v[44:47], v[72:87]
    ds_read_b128 v[24:27], v127 offset:8192
    ds_read_b128 v[28:31], v139 offset:20480
    s_waitcnt lgkmcnt(7)
    v_mfma_f32_32x32x16_bf16 v[88:103], v[40:43], v[48:51], v[88:103]
    ds_read_b128 v[32:35], v139 offset:24576
    s_waitcnt lgkmcnt(7)
    v_mfma_f32_32x32x16_bf16 v[104:119], v[40:43], v[52:55], v[104:119]
    ds_read_b128 v[36:39], v139 offset:28672
    s_waitcnt vmcnt(3)
    s_barrier
    s_waitcnt lgkmcnt(6)
    v_mfma_f32_32x32x16_bf16 v[72:87], v[56:59], v[60:63], v[72:87]
    ds_read_b128 v[40:43], v124 offset:32768
    ds_read_b128 v[44:47], v136 offset:45056
    s_lshl_b32 s28, s24, 7
    s_add_u32 s28, s28, s25
    s_add_u32 m0, s27, 0
    s_nop 0
    buffer_load_dwordx4 v6, s[8:11], s28 offen offset:0 lds
    s_waitcnt lgkmcnt(7)
    v_mfma_f32_32x32x16_bf16 v[88:103], v[56:59], v[64:67], v[88:103]
    ds_read_b128 v[48:51], v136 offset:49152
    s_waitcnt lgkmcnt(7)
    v_mfma_f32_32x32x16_bf16 v[104:119], v[56:59], v[68:71], v[104:119]
    ds_read_b128 v[52:55], v136 offset:53248
    buffer_load_dwordx4 v7, s[8:11], s28 offen offset:1024 lds
    s_waitcnt lgkmcnt(6)
    v_mfma_f32_32x32x16_bf16 v[72:87], v[24:27], v[28:31], v[72:87]
    ds_read_b128 v[56:59], v125 offset:32768
    ds_read_b128 v[60:63], v137 offset:45056
    s_waitcnt lgkmcnt(7)
    v_mfma_f32_32x32x16_bf16 v[88:103], v[24:27], v[32:35], v[88:103]
    ds_read_b128 v[64:67], v137 offset:49152
    buffer_load_dwordx4 v8, s[8:11], s28 offen offset:2048 lds
    s_add_u32 s24, s24, 1
    s_cmp_eq_u32 s24, 12
    s_cselect_b32 s24, 0, s24
    s_waitcnt lgkmcnt(7)
    v_mfma_f32_32x32x16_bf16 v[104:119], v[24:27], v[36:39], v[104:119]
    ds_read_b128 v[68:71], v137 offset:53248
    s_waitcnt lgkmcnt(6)
    v_mfma_f32_32x32x16_bf16 v[72:87], v[40:43], v[44:47], v[72:87]
    ds_read_b128 v[24:27], v126 offset:32768
    ds_read_b128 v[28:31], v138 offset:45056
    s_waitcnt lgkmcnt(7)
    v_mfma_f32_32x32x16_bf16 v[88:103], v[40:43], v[48:51], v[88:103]
    ds_read_b128 v[32:35], v138 offset:49152
    s_waitcnt lgkmcnt(7)
    v_mfma_f32_32x32x16_bf16 v[104:119], v[40:43], v[52:55], v[104:119]
    ds_read_b128 v[36:39], v138 offset:53248
    s_waitcnt lgkmcnt(6)
    v_mfma_f32_32x32x16_bf16 v[72:87], v[56:59], v[60:63], v[72:87]
    ds_read_b128 v[40:43], v127 offset:32768
    ds_read_b128 v[44:47], v139 offset:45056
    s_waitcnt lgkmcnt(7)
    v_mfma_f32_32x32x16_bf16 v[88:103], v[56:59], v[64:67], v[88:103]
    ds_read_b128 v[48:51], v139 offset:49152
    s_waitcnt lgkmcnt(7)
    v_mfma_f32_32x32x16_bf16 v[104:119], v[56:59], v[68:71], v[104:119]
    ds_read_b128 v[52:55], v139 offset:53248
    s_waitcnt vmcnt(3)
    s_barrier
    s_waitcnt lgkmcnt(6)
    v_mfma_f32_32x32x16_bf16 v[72:87], v[24:27], v[28:31], v[72:87]
    ds_read_b128 v[56:59], v124 offset:57344
    ds_read_b128 v[60:63], v140 offset:4096
    s_lshl_b32 s28, s24, 7
    s_add_u32 s28, s28, s25
    s_add_u32 m0, s27, 24576
    s_nop 0
    buffer_load_dwordx4 v6, s[8:11], s28 offen offset:0 lds
    s_waitcnt lgkmcnt(7)
    v_mfma_f32_32x32x16_bf16 v[88:103], v[24:27], v[32:35], v[88:103]
    ds_read_b128 v[64:67], v140 offset:8192
    s_waitcnt lgkmcnt(7)
    v_mfma_f32_32x32x16_bf16 v[104:119], v[24:27], v[36:39], v[104:119]
    ds_read_b128 v[68:71], v140 offset:12288
    buffer_load_dwordx4 v7, s[8:11], s28 offen offset:1024 lds
    s_waitcnt lgkmcnt(6)
    v_mfma_f32_32x32x16_bf16 v[72:87], v[40:43], v[44:47], v[72:87]
    ds_read_b128 v[24:27], v125 offset:57344
    ds_read_b128 v[28:31], v141 offset:4096
    s_waitcnt lgkmcnt(7)
    v_mfma_f32_32x32x16_bf16 v[88:103], v[40:43], v[48:51], v[88:103]
    ds_read_b128 v[32:35], v141 offset:8192
    buffer_load_dwordx4 v8, s[8:11], s28 offen offset:2048 lds
    s_add_u32 s24, s24, 1
    s_cmp_eq_u32 s24, 12
    s_cselect_b32 s24, 0, s24
    s_waitcnt lgkmcnt(7)
    v_mfma_f32_32x32x16_bf16 v[104:119], v[40:43], v[52:55], v[104:119]
    ds_read_b128 v[36:39], v141 offset:12288
    s_waitcnt lgkmcnt(6)
    v_mfma_f32_32x32x16_bf16 v[72:87], v[56:59], v[60:63], v[72:87]
    ds_read_b128 v[40:43], v126 offset:57344
    ds_read_b128 v[44:47], v142 offset:4096
    s_waitcnt lgkmcnt(7)
    v_mfma_f32_32x32x16_bf16 v[88:103], v[56:59], v[64:67], v[88:103]
    ds_read_b128 v[48:51], v142 offset:8192
    s_waitcnt lgkmcnt(7)
    v_mfma_f32_32x32x16_bf16 v[104:119], v[56:59], v[68:71], v[104:119]
    ds_read_b128 v[52:55], v142 offset:12288
    s_waitcnt lgkmcnt(6)
    v_mfma_f32_32x32x16_bf16 v[72:87], v[24:27], v[28:31], v[72:87]
    ds_read_b128 v[56:59], v127 offset:57344
    ds_read_b128 v[60:63], v143 offset:4096
    s_waitcnt lgkmcnt(7)
    v_mfma_f32_32x32x16_bf16 v[88:103], v[24:27], v[32:35], v[88:103]
    ds_read_b128 v[64:67], v143 offset:8192
    s_waitcnt lgkmcnt(7)
    v_mfma_f32_32x32x16_bf16 v[104:119], v[24:27], v[36:39], v[104:119]
    ds_read_b128 v[68:71], v143 offset:12288
    s_waitcnt vmcnt(3)
    s_barrier
    s_waitcnt lgkmcnt(6)
    v_mfma_f32_32x32x16_bf16 v[72:87], v[40:43], v[44:47], v[72:87]
    ds_read_b128 v[24:27], v120 offset:0
    ds_read_b128 v[28:31], v132 offset:12288
    s_lshl_b32 s28, s24, 7
    s_add_u32 s28, s28, s25
    s_add_u32 m0, s27, 49152
    s_nop 0
    buffer_load_dwordx4 v6, s[8:11], s28 offen offset:0 lds
    s_waitcnt lgkmcnt(7)
    v_mfma_f32_32x32x16_bf16 v[88:103], v[40:43], v[48:51], v[88:103]
    ds_read_b128 v[32:35], v132 offset:16384
    s_waitcnt lgkmcnt(7)
    v_mfma_f32_32x32x16_bf16 v[104:119], v[40:43], v[52:55], v[104:119]
    ds_read_b128 v[36:39], v132 offset:20480
    buffer_load_dwordx4 v7, s[8:11], s28 offen offset:1024 lds
    s_waitcnt lgkmcnt(6)
    v_mfma_f32_32x32x16_bf16 v[72:87], v[56:59], v[60:63], v[72:87]
    ds_read_b128 v[40:43], v121 offset:0
    ds_read_b128 v[44:47], v133 offset:12288
    s_waitcnt lgkmcnt(7)
    v_mfma_f32_32x32x16_bf16 v[88:103], v[56:59], v[64:67], v[88:103]
    ds_read_b128 v[48:51], v133 offset:16384
    buffer_load_dwordx4 v8, s[8:11], s28 offen offset:2048 lds
    s_add_u32 s24, s24, 1
    s_cmp_eq_u32 s24, 12
    s_cselect_b32 s24, 0, s24
    s_waitcnt lgkmcnt(7)
    v_mfma_f32_32x32x16_bf16 v[104:119], v[56:59], v[68:71], v[104:119]
    ds_read_b128 v[52:55], v133 offset:20480
    s_waitcnt lgkmcnt(6)
    v_mfma_f32_32x32x16_bf16 v[72:87], v[24:27], v[28:31], v[72:87]
    ds_read_b128 v[56:59], v122 offset:0
    ds_read_b128 v[60:63], v134 offset:12288
    s_waitcnt lgkmcnt(7)
    v_mfma_f32_32x32x16_bf16 v[88:103], v[24:27], v[32:35], v[88:103]
    ds_read_b128 v[64:67], v134 offset:16384
    s_waitcnt lgkmcnt(7)
    v_mfma_f32_32x32x16_bf16 v[104:119], v[24:27], v[36:39], v[104:119]
    ds_read_b128 v[68:71], v134 offset:20480
    s_waitcnt lgkmcnt(6)
    v_mfma_f32_32x32x16_bf16 v[72:87], v[40:43], v[44:47], v[72:87]
    ds_read_b128 v[24:27], v123 offset:0
    ds_read_b128 v[28:31], v135 offset:12288
    s_waitcnt lgkmcnt(7)
    v_mfma_f32_32x32x16_bf16 v[88:103], v[40:43], v[48:51], v[88:103]
    ds_read_b128 v[32:35], v135 offset:16384
    s_waitcnt lgkmcnt(7)
    v_mfma_f32_32x32x16_bf16 v[104:119], v[40:43], v[52:55], v[104:119]
    ds_read_b128 v[36:39], v135 offset:20480
    s_waitcnt vmcnt(3)
    s_barrier
    s_waitcnt lgkmcnt(6)
    v_mfma_f32_32x32x16_bf16 v[72:87], v[56:59], v[60:63], v[72:87]
    ds_read_b128 v[40:43], v120 offset:24576
    ds_read_b128 v[44:47], v132 offset:36864
    s_lshl_b32 s28, s24, 7
    s_add_u32 s28, s28, s25
    s_add_u32 m0, s27, 73728
    s_nop 0
    buffer_load_dwordx4 v6, s[8:11], s28 offen offset:0 lds
    s_waitcnt lgkmcnt(7)
    v_mfma_f32_32x32x16_bf16 v[88:103], v[56:59], v[64:67], v[88:103]
    ds_read_b128 v[48:51], v132 offset:40960
    s_waitcnt lgkmcnt(7)
    v_mfma_f32_32x32x16_bf16 v[104:119], v[56:59], v[68:71], v[104:119]
    ds_read_b128 v[52:55], v132 offset:45056
    buffer_load_dwordx4 v7, s[8:11], s28 offen offset:1024 lds
    s_waitcnt lgkmcnt(6)
    v_mfma_f32_32x32x16_bf16 v[72:87], v[24:27], v[28:31], v[72:87]
    ds_read_b128 v[56:59], v121 offset:24576
    ds_read_b128 v[60:63], v133 offset:36864
    s_waitcnt lgkmcnt(7)
    v_mfma_f32_32x32x16_bf16 v[88:103], v[24:27], v[32:35], v[88:103]
    ds_read_b128 v[64:67], v133 offset:40960
    buffer_load_dwordx4 v8, s[8:11], s28 offen offset:2048 lds
    s_add_u32 s24, s24, 1
    s_cmp_eq_u32 s24, 12
    s_cselect_b32 s24, 0, s24
    s_waitcnt lgkmcnt(7)
    v_mfma_f32_32x32x16_bf16 v[104:119], v[24:27], v[36:39], v[104:119]
    ds_read_b128 v[68:71], v133 offset:45056
    s_waitcnt lgkmcnt(6)
    v_mfma_f32_32x32x16_bf16 v[72:87], v[40:43], v[44:47], v[72:87]
    ds_read_b128 v[24:27], v122 offset:24576
    ds_read_b128 v[28:31], v134 offset:36864
    s_waitcnt lgkmcnt(7)
    v_mfma_f32_32x32x16_bf16 v[88:103], v[40:43], v[48:51], v[88:103]
    ds_read_b128 v[32:35], v134 offset:40960
    s_waitcnt lgkmcnt(7)
    v_mfma_f32_32x32x16_bf16 v[104:119], v[40:43], v[52:55], v[104:119]
    ds_read_b128 v[36:39], v134 offset:45056
    s_waitcnt lgkmcnt(6)
    v_mfma_f32_32x32x16_bf16 v[72:87], v[56:59], v[60:63], v[72:87]
    ds_read_b128 v[40:43], v123 offset:24576
    ds_read_b128 v[44:47], v135 offset:36864
    s_waitcnt lgkmcnt(7)
    v_mfma_f32_32x32x16_bf16 v[88:103], v[56:59], v[64:67], v[88:103]
    ds_read_b128 v[48:51], v135 offset:40960
    s_waitcnt lgkmcnt(7)
    v_mfma_f32_32x32x16_bf16 v[104:119], v[56:59], v[68:71], v[104:119]
    ds_read_b128 v[52:55], v135 offset:45056
    s_waitcnt vmcnt(3)
    s_barrier
    s_waitcnt lgkmcnt(6)
    v_mfma_f32_32x32x16_bf16 v[72:87], v[24:27], v[28:31], v[72:87]
    ds_read_b128 v[56:59], v120 offset:49152
    ds_read_b128 v[60:63], v132 offset:61440
    s_lshl_b32 s28, s24, 7
    s_add_u32 s28, s28, s25
    s_add_u32 m0, s27, 98304
    s_nop 0
    buffer_load_dwordx4 v6, s[8:11], s28 offen offset:0 lds
    s_waitcnt lgkmcnt(7)
    v_mfma_f32_32x32x16_bf16 v[88:103], v[24:27], v[32:35], v[88:103]
    ds_read_b128 v[64:67], v136 offset:0
    s_waitcnt lgkmcnt(7)
    v_mfma_f32_32x32x16_bf16 v[104:119], v[24:27], v[36:39], v[104:119]
    ds_read_b128 v[68:71], v136 offset:4096
    buffer_load_dwordx4 v7, s[8:11], s28 offen offset:1024 lds
    s_waitcnt lgkmcnt(6)
    v_mfma_f32_32x32x16_bf16 v[72:87], v[40:43], v[44:47], v[72:87]
    ds_read_b128 v[24:27], v121 offset:49152
    ds_read_b128 v[28:31], v133 offset:61440
    s_waitcnt lgkmcnt(7)
    v_mfma_f32_32x32x16_bf16 v[88:103], v[40:43], v[48:51], v[88:103]
    ds_read_b128 v[32:35], v137 offset:0
    buffer_load_dwordx4 v8, s[8:11], s28 offen offset:2048 lds
    s_add_u32 s24, s24, 1
    s_cmp_eq_u32 s24, 12
    s_cselect_b32 s24, 0, s24
    s_waitcnt lgkmcnt(7)
    v_mfma_f32_32x32x16_bf16 v[104:119], v[40:43], v[52:55], v[104:119]
    ds_read_b128 v[36:39], v137 offset:4096
    s_waitcnt lgkmcnt(6)
    v_mfma_f32_32x32x16_bf16 v[72:87], v[56:59], v[60:63], v[72:87]
    ds_read_b128 v[40:43], v122 offset:49152
    ds_read_b128 v[44:47], v134 offset:61440
    s_waitcnt lgkmcnt(7)
    v_mfma_f32_32x32x16_bf16 v[88:103], v[56:59], v[64:67], v[88:103]
    ds_read_b128 v[48:51], v138 offset:0
    s_waitcnt lgkmcnt(7)
    v_mfma_f32_32x32x16_bf16 v[104:119], v[56:59], v[68:71], v[104:119]
    ds_read_b128 v[52:55], v138 offset:4096
    s_waitcnt lgkmcnt(6)
    v_mfma_f32_32x32x16_bf16 v[72:87], v[24:27], v[28:31], v[72:87]
    ds_read_b128 v[56:59], v123 offset:49152
    ds_read_b128 v[60:63], v135 offset:61440
    s_waitcnt lgkmcnt(7)
    v_mfma_f32_32x32x16_bf16 v[88:103], v[24:27], v[32:35], v[88:103]
    ds_read_b128 v[64:67], v139 offset:0
    s_waitcnt lgkmcnt(7)
    v_mfma_f32_32x32x16_bf16 v[104:119], v[24:27], v[36:39], v[104:119]
    ds_read_b128 v[68:71], v139 offset:4096
    s_waitcnt vmcnt(3)
    s_barrier
    s_waitcnt lgkmcnt(6)
    v_mfma_f32_32x32x16_bf16 v[72:87], v[40:43], v[44:47], v[72:87]
    ds_read_b128 v[24:27], v124 offset:8192
    ds_read_b128 v[28:31], v136 offset:20480
    s_lshl_b32 s28, s24, 7
    s_add_u32 s28, s28, s25
    s_add_u32 m0, s27, 122880
    s_nop 0
    buffer_load_dwordx4 v6, s[8:11], s28 offen offset:0 lds
    s_waitcnt lgkmcnt(7)
    v_mfma_f32_32x32x16_bf16 v[88:103], v[40:43], v[48:51], v[88:103]
    ds_read_b128 v[32:35], v136 offset:24576
    s_waitcnt lgkmcnt(7)
    v_mfma_f32_32x32x16_bf16 v[104:119], v[40:43], v[52:55], v[104:119]
    ds_read_b128 v[36:39], v136 offset:28672
    buffer_load_dwordx4 v7, s[8:11], s28 offen offset:1024 lds
    s_waitcnt lgkmcnt(6)
    v_mfma_f32_32x32x16_bf16 v[72:87], v[56:59], v[60:63], v[72:87]
    ds_read_b128 v[40:43], v125 offset:8192
    ds_read_b128 v[44:47], v137 offset:20480
    s_waitcnt lgkmcnt(7)
    v_mfma_f32_32x32x16_bf16 v[88:103], v[56:59], v[64:67], v[88:103]
    ds_read_b128 v[48:51], v137 offset:24576
    buffer_load_dwordx4 v8, s[8:11], s28 offen offset:2048 lds
    s_add_u32 s24, s24, 1
    s_cmp_eq_u32 s24, 12
    s_cselect_b32 s24, 0, s24
    s_waitcnt lgkmcnt(7)
    v_mfma_f32_32x32x16_bf16 v[104:119], v[56:59], v[68:71], v[104:119]
    ds_read_b128 v[52:55], v137 offset:28672
    s_waitcnt lgkmcnt(6)
    v_mfma_f32_32x32x16_bf16 v[72:87], v[24:27], v[28:31], v[72:87]
    ds_read_b128 v[56:59], v126 offset:8192
    ds_read_b128 v[60:63], v138 offset:20480
    s_waitcnt lgkmcnt(7)
    v_mfma_f32_32x32x16_bf16 v[88:103], v[24:27], v[32:35], v[88:103]
    ds_read_b128 v[64:67], v138 offset:24576
    s_waitcnt lgkmcnt(7)
    v_mfma_f32_32x32x16_bf16 v[104:119], v[24:27], v[36:39], v[104:119]
    ds_read_b128 v[68:71], v138 offset:28672
    s_waitcnt lgkmcnt(6)
    v_mfma_f32_32x32x16_bf16 v[72:87], v[40:43], v[44:47], v[72:87]
    ds_read_b128 v[24:27], v127 offset:8192
    ds_read_b128 v[28:31], v139 offset:20480
    s_waitcnt lgkmcnt(7)
    v_mfma_f32_32x32x16_bf16 v[88:103], v[40:43], v[48:51], v[88:103]
    ds_read_b128 v[32:35], v139 offset:24576
    s_waitcnt lgkmcnt(7)
    v_mfma_f32_32x32x16_bf16 v[104:119], v[40:43], v[52:55], v[104:119]
    ds_read_b128 v[36:39], v139 offset:28672
    s_waitcnt vmcnt(3)
    s_barrier
    s_waitcnt lgkmcnt(6)
    v_mfma_f32_32x32x16_bf16 v[72:87], v[56:59], v[60:63], v[72:87]
    ds_read_b128 v[40:43], v124 offset:32768
    ds_read_b128 v[44:47], v136 offset:45056
    s_waitcnt lgkmcnt(7)
    v_mfma_f32_32x32x16_bf16 v[88:103], v[56:59], v[64:67], v[88:103]
    ds_read_b128 v[48:51], v136 offset:49152
    s_waitcnt lgkmcnt(7)
    v_mfma_f32_32x32x16_bf16 v[104:119], v[56:59], v[68:71], v[104:119]
    ds_read_b128 v[52:55], v136 offset:53248
    s_waitcnt lgkmcnt(6)
    v_mfma_f32_32x32x16_bf16 v[72:87], v[24:27], v[28:31], v[72:87]
    ds_read_b128 v[56:59], v125 offset:32768
    ds_read_b128 v[60:63], v137 offset:45056
    s_waitcnt lgkmcnt(7)
    v_mfma_f32_32x32x16_bf16 v[88:103], v[24:27], v[32:35], v[88:103]
    ds_read_b128 v[64:67], v137 offset:49152
    s_waitcnt lgkmcnt(7)
    v_mfma_f32_32x32x16_bf16 v[104:119], v[24:27], v[36:39], v[104:119]
    ds_read_b128 v[68:71], v137 offset:53248
    s_waitcnt lgkmcnt(6)
    v_mfma_f32_32x32x16_bf16 v[72:87], v[40:43], v[44:47], v[72:87]
    ds_read_b128 v[24:27], v126 offset:32768
    ds_read_b128 v[28:31], v138 offset:45056
    s_waitcnt lgkmcnt(7)
    v_mfma_f32_32x32x16_bf16 v[88:103], v[40:43], v[48:51], v[88:103]
    ds_read_b128 v[32:35], v138 offset:49152
    s_waitcnt lgkmcnt(7)
    v_mfma_f32_32x32x16_bf16 v[104:119], v[40:43], v[52:55], v[104:119]
    ds_read_b128 v[36:39], v138 offset:53248
    s_waitcnt lgkmcnt(6)
    v_mfma_f32_32x32x16_bf16 v[72:87], v[56:59], v[60:63], v[72:87]
    ds_read_b128 v[40:43], v127 offset:32768
    ds_read_b128 v[44:47], v139 offset:45056
    s_waitcnt lgkmcnt(7)
    v_mfma_f32_32x32x16_bf16 v[88:103], v[56:59], v[64:67], v[88:103]
    ds_read_b128 v[48:51], v139 offset:49152
    s_waitcnt lgkmcnt(7)
    v_mfma_f32_32x32x16_bf16 v[104:119], v[56:59], v[68:71], v[104:119]
    ds_read_b128 v[52:55], v139 offset:53248
    s_waitcnt vmcnt(0)
    s_barrier
    s_waitcnt lgkmcnt(6)
    v_mfma_f32_32x32x16_bf16 v[72:87], v[24:27], v[28:31], v[72:87]
    ds_read_b128 v[148:151], v124 offset:57344
    ds_read_b128 v[152:155], v140 offset:4096
    s_waitcnt lgkmcnt(7)
    v_mfma_f32_32x32x16_bf16 v[88:103], v[24:27], v[32:35], v[88:103]
    ds_read_b128 v[156:159], v140 offset:8192
    s_waitcnt lgkmcnt(7)
    v_mfma_f32_32x32x16_bf16 v[104:119], v[24:27], v[36:39], v[104:119]
    ds_read_b128 v[160:163], v140 offset:12288
    s_waitcnt lgkmcnt(6)
    v_mfma_f32_32x32x16_bf16 v[72:87], v[40:43], v[44:47], v[72:87]
    ds_read_b128 v[164:167], v125 offset:57344
    ds_read_b128 v[168:171], v141 offset:4096
    s_waitcnt lgkmcnt(7)
    v_mfma_f32_32x32x16_bf16 v[88:103], v[40:43], v[48:51], v[88:103]
    ds_read_b128 v[172:175], v141 offset:8192
    s_waitcnt lgkmcnt(7)
    v_mfma_f32_32x32x16_bf16 v[104:119], v[40:43], v[52:55], v[104:119]
    ds_read_b128 v[176:179], v141 offset:12288
    ds_read_b128 v[180:183], v126 offset:57344
    ds_read_b128 v[184:187], v142 offset:4096
    ds_read_b128 v[188:191], v142 offset:8192
    ds_read_b128 v[192:195], v142 offset:12288
    ds_read_b128 v[196:199], v127 offset:57344
    ds_read_b128 v[200:203], v143 offset:4096
    ds_read_b128 v[204:207], v143 offset:8192
    ds_read_b128 v[208:211], v143 offset:12288
    s_mul_i32 s25, s21, 24
    s_mul_i32 s60, s23, 3
    s_add_u32 s25, s25, s60
    s_mul_i32 s25, s25, 48*1024
    s_mul_i32 s60, s22, 3
    s_add_u32 s60, s60, s20
    s_lshl_b32 s60, s60, 11
    s_add_u32 s25, s25, s60
    s_add_u32 s25, s25, 4194304
    s_waitcnt lgkmcnt(14)
    v_mfma_f32_32x32x16_bf16 v[72:87], v[148:151], v[152:155], v[72:87]
    s_waitcnt lgkmcnt(10)
    v_mfma_f32_32x32x16_bf16 v[72:87], v[164:167], v[168:171], v[72:87]
    s_waitcnt lgkmcnt(6)
    v_mfma_f32_32x32x16_bf16 v[72:87], v[180:183], v[184:187], v[72:87]
    s_waitcnt lgkmcnt(2)
    v_mfma_f32_32x32x16_bf16 v[72:87], v[196:199], v[200:203], v[72:87]
    v_mfma_f32_32x32x16_bf16 v[88:103], v[148:151], v[156:159], v[88:103]
    v_mfma_f32_32x32x16_bf16 v[88:103], v[164:167], v[172:175], v[88:103]
    s_nop 1
    v_cvt_pk_bf16_f32 v24, v72, v73
    v_cvt_pk_bf16_f32 v25, v74, v75
    v_cvt_pk_bf16_f32 v26, v76, v77
    v_cvt_pk_bf16_f32 v27, v78, v79
    v_mfma_f32_32x32x16_bf16 v[88:103], v[180:183], v[188:191], v[88:103]
    buffer_store_dwordx4 v[24:27], v254, s[16:19], s25 offen offset:0 sc1
    v_cvt_pk_bf16_f32 v28, v80, v81
    v_cvt_pk_bf16_f32 v29, v82, v83
    v_cvt_pk_bf16_f32 v30, v84, v85
    s_waitcnt lgkmcnt(1)
    v_mfma_f32_32x32x16_bf16 v[88:103], v[196:199], v[204:207], v[88:103]
    v_cvt_pk_bf16_f32 v31, v86, v87
    buffer_store_dwordx4 v[28:31], v254, s[16:19], s25 offen offset:1024 sc1
    s_add_u32 s25, s25, 49152
    v_mfma_f32_32x32x16_bf16 v[104:119], v[148:151], v[160:163], v[104:119]
    v_mfma_f32_32x32x16_bf16 v[104:119], v[164:167], v[176:179], v[104:119]
    s_nop 1
    v_cvt_pk_bf16_f32 v32, v88, v89
    v_cvt_pk_bf16_f32 v33, v90, v91
    v_cvt_pk_bf16_f32 v34, v92, v93
    v_cvt_pk_bf16_f32 v35, v94, v95
    v_mfma_f32_32x32x16_bf16 v[104:119], v[180:183], v[192:195], v[104:119]
    buffer_store_dwordx4 v[32:35], v254, s[16:19], s25 offen offset:0 sc1
    v_cvt_pk_bf16_f32 v36, v96, v97
    v_cvt_pk_bf16_f32 v37, v98, v99
    v_cvt_pk_bf16_f32 v38, v100, v101
    s_waitcnt lgkmcnt(0)
    v_mfma_f32_32x32x16_bf16 v[104:119], v[196:199], v[208:211], v[104:119]
    v_cvt_pk_bf16_f32 v39, v102, v103
    buffer_store_dwordx4 v[36:39], v254, s[16:19], s25 offen offset:1024 sc1
    s_add_u32 s25, s25, 49152
    v_readfirstlane_b32 s60, v251
    s_nop 3
    s_and_b32 s60, s60, 0xfffffffc
    s_add_u32 s37, s60, 5
    s_nop 7
    s_nop 3
    v_cvt_pk_bf16_f32 v40, v104, v105
    v_cvt_pk_bf16_f32 v41, v106, v107
    v_cvt_pk_bf16_f32 v42, v108, v109
    v_cvt_pk_bf16_f32 v43, v110, v111
    buffer_store_dwordx4 v[40:43], v254, s[16:19], s25 offen offset:0 sc1
    v_cvt_pk_bf16_f32 v44, v112, v113
    v_cvt_pk_bf16_f32 v45, v114, v115
    v_cvt_pk_bf16_f32 v46, v116, v117
    v_cvt_pk_bf16_f32 v47, v118, v119
    buffer_store_dwordx4 v[44:47], v254, s[16:19], s25 offen offset:1024 sc1
    s_add_u32 s25, s25, 49152
    s_waitcnt vmcnt(0)
    s_branch w_join_4
w_wave3_3:
    v_mov_b32 v144, v4
    v_add_u32 v145, 35840, v5
    v_add_u32 v146, 71680, v4
    s_cmp_eq_u32 s20, 3
    s_cbranch_scc0 cpf_5
    s_getpc_b64 s[60:61]
cpf_pc_6:
    s_sub_u32 s60, s60, cpf_pc_6-standalone__dit_adaln_block__diffusion_kernel
    s_subb_u32 s61, s61, 0
    s_lshl_b32 s62, s33, 12
    s_add_u32 s62, s62, 0
    v_lshlrev_b32 v228, 6, v255
    v_add_u32 v228, s62, v228
    v_min_u32 v228, (L_codeend-standalone__dit_adaln_block__diffusion_kernel)-64, v228
    v_mov_b32 v229, s61
    v_add_co_u32 v228, vcc, s60, v228
    v_addc_co_u32 v229, vcc, 0, v229, vcc
    global_load_dword v230, v[228:229], off
cpf_5:
    s_waitcnt vmcnt(7)
    s_barrier
    s_lshl_b32 s28, s24, 7
    s_add_u32 s28, s28, s25
    s_add_u32 m0, s27, 49152
    s_nop 0
    buffer_load_dwordx4 v6, s[8:11], s28 offen offset:0 lds
    buffer_load_dwordx4 v7, s[8:11], s28 offen offset:1024 lds
    buffer_load_dwordx4 v8, s[8:11], s28 offen offset:2048 lds
    s_mul_i32 s29, s24, 128
    s_add_u32 s29, s29, s26
    s_sub_u32 s29, s29, 331776
    s_mov_b32 m0, 61440
    s_nop 0
    buffer_load_dwordx4 v144, s[8:11], s29 offen offset:0 lds
    buffer_load_dwordx4 v145, s[8:11], s29 offen offset:1024 lds
    buffer_load_dwordx4 v146, s[8:11], s29 offen offset:2048 lds
    s_add_u32 s29, s29, 110592
    s_mov_b32 m0, 64512
    s_nop 0
    buffer_load_dwordx4 v9, s[8:11], s29 offen offset:0 lds
    buffer_load_dwordx4 v10, s[8:11], s29 offen offset:1024 lds
    buffer_load_dwordx4 v11, s[8:11], s29 offen offset:2048 lds
    s_add_u32 s29, s29, 110592
    s_mov_b32 m0, 67584
    s_nop 0
    buffer_load_dwordx4 v144, s[8:11], s29 offen offset:0 lds
    buffer_load_dwordx4 v145, s[8:11], s29 offen offset:1024 lds
    buffer_load_dwordx4 v146, s[8:11], s29 offen offset:2048 lds
    s_add_u32 s29, s29, 110592
    s_mov_b32 m0, 70656
    s_nop 0
    buffer_load_dwordx4 v9, s[8:11], s29 offen offset:0 lds
    buffer_load_dwordx4 v10, s[8:11], s29 offen offset:1024 lds
    buffer_load_dwordx4 v11, s[8:11], s29 offen offset:2048 lds
    s_add_u32 s24, s24, 1
    s_cmp_eq_u32 s24, 12
    s_cselect_b32 s24, 0, s24
    s_waitcnt vmcnt(16)
    s_barrier
    s_lshl_b32 s28, s24, 7
    s_add_u32 s28, s28, s25
    s_add_u32 m0, s27, 73728
    s_nop 0
    buffer_load_dwordx4 v6, s[8:11], s28 offen offset:0 lds
    buffer_load_dwordx4 v7, s[8:11], s28 offen offset:1024 lds
    buffer_load_dwordx4 v8, s[8:11], s28 offen offset:2048 lds
    s_mul_i32 s29, s24, 128
    s_add_u32 s29, s29, s26
    s_sub_u32 s29, s29, 331776
    s_mov_b32 m0, 86016
    s_nop 0
    buffer_load_dwordx4 v144, s[8:11], s29 offen offset:0 lds
    buffer_load_dwordx4 v145, s[8:11], s29 offen offset:1024 lds
    buffer_load_dwordx4 v146, s[8:11], s29 offen offset:2048 lds
    s_add_u32 s29, s29, 110592
    s_mov_b32 m0, 89088
    s_nop 0
    buffer_load_dwordx4 v9, s[8:11], s29 offen offset:0 lds
    buffer_load_dwordx4 v10, s[8:11], s29 offen offset:1024 lds
    buffer_load_dwordx4 v11, s[8:11], s29 offen offset:2048 lds
    s_add_u32 s29, s29, 110592
    s_mov_b32 m0, 92160
    s_nop 0
    buffer_load_dwordx4 v144, s[8:11], s29 offen offset:0 lds
    buffer_load_dwordx4 v145, s[8:11], s29 offen offset:1024 lds
    buffer_load_dwordx4 v146, s[8:11], s29 offen offset:2048 lds
    s_add_u32 s29, s29, 110592
    s_mov_b32 m0, 95232
    s_nop 0
    buffer_load_dwordx4 v9, s[8:11], s29 offen offset:0 lds
    buffer_load_dwordx4 v10, s[8:11], s29 offen offset:1024 lds
    buffer_load_dwordx4 v11, s[8:11], s29 offen offset:2048 lds
    s_add_u32 s24, s24, 1
    s_cmp_eq_u32 s24, 12
    s_cselect_b32 s24, 0, s24
    s_waitcnt vmcnt(15)
    s_barrier
    s_lshl_b32 s28, s24, 7
    s_add_u32 s28, s28, s25
    s_add_u32 m0, s27, 98304
    s_nop 0
    buffer_load_dwordx4 v6, s[8:11], s28 offen offset:0 lds
    buffer_load_dwordx4 v7, s[8:11], s28 offen offset:1024 lds
    buffer_load_dwordx4 v8, s[8:11], s28 offen offset:2048 lds
    s_mul_i32 s29, s24, 128
    s_add_u32 s29, s29, s26
    s_sub_u32 s29, s29, 331776
    s_mov_b32 m0, 110592
    s_nop 0
    buffer_load_dwordx4 v144, s[8:11], s29 offen offset:0 lds
    buffer_load_dwordx4 v145, s[8:11], s29 offen offset:1024 lds
    buffer_load_dwordx4 v146, s[8:11], s29 offen offset:2048 lds
    s_add_u32 s29, s29, 110592
    s_mov_b32 m0, 113664
    s_nop 0
    buffer_load_dwordx4 v9, s[8:11], s29 offen offset:0 lds
    buffer_load_dwordx4 v10, s[8:11], s29 offen offset:1024 lds
    buffer_load_dwordx4 v11, s[8:11], s29 offen offset:2048 lds
    s_add_u32 s29, s29, 110592
    s_mov_b32 m0, 116736
    s_nop 0
    buffer_load_dwordx4 v144, s[8:11], s29 offen offset:0 lds
    buffer_load_dwordx4 v145, s[8:11], s29 offen offset:1024 lds
    buffer_load_dwordx4 v146, s[8:11], s29 offen offset:2048 lds
    s_add_u32 s29, s29, 110592
    s_mov_b32 m0, 119808
    s_nop 0
    buffer_load_dwordx4 v9, s[8:11], s29 offen offset:0 lds
    buffer_load_dwordx4 v10, s[8:11], s29 offen offset:1024 lds
    buffer_load_dwordx4 v11, s[8:11], s29 offen offset:2048 lds
    s_add_u32 s24, s24, 1
    s_cmp_eq_u32 s24, 12
    s_cselect_b32 s24, 0, s24
    s_waitcnt vmcnt(15)
    s_barrier
    s_lshl_b32 s28, s24, 7
    s_add_u32 s28, s28, s25
    s_add_u32 m0, s27, 122880
    s_nop 0
    buffer_load_dwordx4 v6, s[8:11], s28 offen offset:0 lds
    buffer_load_dwordx4 v7, s[8:11], s28 offen offset:1024 lds
    buffer_load_dwordx4 v8, s[8:11], s28 offen offset:2048 lds
    s_mul_i32 s29, s24, 128
    s_add_u32 s29, s29, s26
    s_sub_u32 s29, s29, 331776
    s_mov_b32 m0, 135168
    s_nop 0
    buffer_load_dwordx4 v144, s[8:11], s29 offen offset:0 lds
    buffer_load_dwordx4 v145, s[8:11], s29 offen offset:1024 lds
    buffer_load_dwordx4 v146, s[8:11], s29 offen offset:2048 lds
    s_add_u32 s29, s29, 110592
    s_mov_b32 m0, 138240
    s_nop 0
    buffer_load_dwordx4 v9, s[8:11], s29 offen offset:0 lds
    buffer_load_dwordx4 v10, s[8:11], s29 offen offset:1024 lds
    buffer_load_dwordx4 v11, s[8:11], s29 offen offset:2048 lds
    s_add_u32 s29, s29, 110592
    s_mov_b32 m0, 141312
    s_nop 0
    buffer_load_dwordx4 v144, s[8:11], s29 offen offset:0 lds
    buffer_load_dwordx4 v145, s[8:11], s29 offen offset:1024 lds
    buffer_load_dwordx4 v146, s[8:11], s29 offen offset:2048 lds
    s_add_u32 s29, s29, 110592
    s_mov_b32 m0, 144384
    s_nop 0
    buffer_load_dwordx4 v9, s[8:11], s29 offen offset:0 lds
    buffer_load_dwordx4 v10, s[8:11], s29 offen offset:1024 lds
    buffer_load_dwordx4 v11, s[8:11], s29 offen offset:2048 lds
    s_add_u32 s24, s24, 1
    s_cmp_eq_u32 s24, 12
    s_cselect_b32 s24, 0, s24
    s_waitcnt vmcnt(15)
    s_barrier
    s_lshl_b32 s28, s24, 7
    s_add_u32 s28, s28, s25
    s_add_u32 m0, s27, 0
    s_nop 0
    buffer_load_dwordx4 v6, s[8:11], s28 offen offset:0 lds
    buffer_load_dwordx4 v7, s[8:11], s28 offen offset:1024 lds
    buffer_load_dwordx4 v8, s[8:11], s28 offen offset:2048 lds
    s_mul_i32 s29, s24, 128
    s_add_u32 s29, s29, s26
    s_sub_u32 s29, s29, 331776
    s_mov_b32 m0, 12288
    s_nop 0
    buffer_load_dwordx4 v144, s[8:11], s29 offen offset:0 lds
    buffer_load_dwordx4 v145, s[8:11], s29 offen offset:1024 lds
    buffer_load_dwordx4 v146, s[8:11], s29 offen offset:2048 lds
    s_add_u32 s29, s29, 110592
    s_mov_b32 m0, 15360
    s_nop 0
    buffer_load_dwordx4 v9, s[8:11], s29 offen offset:0 lds
    buffer_load_dwordx4 v10, s[8:11], s29 offen offset:1024 lds
    buffer_load_dwordx4 v11, s[8:11], s29 offen offset:2048 lds
    s_add_u32 s29, s29, 110592
    s_mov_b32 m0, 18432
    s_nop 0
    buffer_load_dwordx4 v144, s[8:11], s29 offen offset:0 lds
    buffer_load_dwordx4 v145, s[8:11], s29 offen offset:1024 lds
    buffer_load_dwordx4 v146, s[8:11], s29 offen offset:2048 lds
    s_add_u32 s29, s29, 110592
    s_mov_b32 m0, 21504
    s_nop 0
    buffer_load_dwordx4 v9, s[8:11], s29 offen offset:0 lds
    buffer_load_dwordx4 v10, s[8:11], s29 offen offset:1024 lds
    buffer_load_dwordx4 v11, s[8:11], s29 offen offset:2048 lds
    s_add_u32 s24, s24, 1
    s_cmp_eq_u32 s24, 12
    s_cselect_b32 s24, 0, s24
    s_waitcnt vmcnt(15)
    s_barrier
    s_lshl_b32 s28, s24, 7
    s_add_u32 s28, s28, s25
    s_add_u32 m0, s27, 24576
    s_nop 0
    buffer_load_dwordx4 v6, s[8:11], s28 offen offset:0 lds
    buffer_load_dwordx4 v7, s[8:11], s28 offen offset:1024 lds
    buffer_load_dwordx4 v8, s[8:11], s28 offen offset:2048 lds
    s_mul_i32 s29, s24, 128
    s_add_u32 s29, s29, s26
    s_sub_u32 s29, s29, 331776
    s_mov_b32 m0, 36864
    s_nop 0
    buffer_load_dwordx4 v144, s[8:11], s29 offen offset:0 lds
    buffer_load_dwordx4 v145, s[8:11], s29 offen offset:1024 lds
    buffer_load_dwordx4 v146, s[8:11], s29 offen offset:2048 lds
    s_add_u32 s29, s29, 110592
    s_mov_b32 m0, 39936
    s_nop 0
    buffer_load_dwordx4 v9, s[8:11], s29 offen offset:0 lds
    buffer_load_dwordx4 v10, s[8:11], s29 offen offset:1024 lds
    buffer_load_dwordx4 v11, s[8:11], s29 offen offset:2048 lds
    s_add_u32 s29, s29, 110592
    s_mov_b32 m0, 43008
    s_nop 0
    buffer_load_dwordx4 v144, s[8:11], s29 offen offset:0 lds
    buffer_load_dwordx4 v145, s[8:11], s29 offen offset:1024 lds
    buffer_load_dwordx4 v146, s[8:11], s29 offen offset:2048 lds
    s_add_u32 s29, s29, 110592
    s_mov_b32 m0, 46080
    s_nop 0
    buffer_load_dwordx4 v9, s[8:11], s29 offen offset:0 lds
    buffer_load_dwordx4 v10, s[8:11], s29 offen offset:1024 lds
    buffer_load_dwordx4 v11, s[8:11], s29 offen offset:2048 lds
    s_add_u32 s24, s24, 1
    s_cmp_eq_u32 s24, 12
    s_cselect_b32 s24, 0, s24
    s_waitcnt vmcnt(15)
    s_barrier
    s_lshl_b32 s28, s24, 7
    s_add_u32 s28, s28, s25
    s_add_u32 m0, s27, 49152
    s_nop 0
    buffer_load_dwordx4 v6, s[8:11], s28 offen offset:0 lds
    buffer_load_dwordx4 v7, s[8:11], s28 offen offset:1024 lds
    buffer_load_dwordx4 v8, s[8:11], s28 offen offset:2048 lds
    s_mul_i32 s29, s24, 128
    s_add_u32 s29, s29, s26
    s_sub_u32 s29, s29, 331776
    s_mov_b32 m0, 61440
    s_nop 0
    buffer_load_dwordx4 v144, s[8:11], s29 offen offset:0 lds
    buffer_load_dwordx4 v145, s[8:11], s29 offen offset:1024 lds
    buffer_load_dwordx4 v146, s[8:11], s29 offen offset:2048 lds
    s_add_u32 s29, s29, 110592
    s_mov_b32 m0, 64512
    s_nop 0
    buffer_load_dwordx4 v9, s[8:11], s29 offen offset:0 lds
    buffer_load_dwordx4 v10, s[8:11], s29 offen offset:1024 lds
    buffer_load_dwordx4 v11, s[8:11], s29 offen offset:2048 lds
    s_add_u32 s29, s29, 110592
    s_mov_b32 m0, 67584
    s_nop 0
    buffer_load_dwordx4 v144, s[8:11], s29 offen offset:0 lds
    buffer_load_dwordx4 v145, s[8:11], s29 offen offset:1024 lds
    buffer_load_dwordx4 v146, s[8:11], s29 offen offset:2048 lds
    s_add_u32 s29, s29, 110592
    s_mov_b32 m0, 70656
    s_nop 0
    buffer_load_dwordx4 v9, s[8:11], s29 offen offset:0 lds
    buffer_load_dwordx4 v10, s[8:11], s29 offen offset:1024 lds
    buffer_load_dwordx4 v11, s[8:11], s29 offen offset:2048 lds
    s_add_u32 s24, s24, 1
    s_cmp_eq_u32 s24, 12
    s_cselect_b32 s24, 0, s24
    s_waitcnt vmcnt(15)
    s_barrier
    s_lshl_b32 s28, s24, 7
    s_add_u32 s28, s28, s25
    s_add_u32 m0, s27, 73728
    s_nop 0
    buffer_load_dwordx4 v6, s[8:11], s28 offen offset:0 lds
    buffer_load_dwordx4 v7, s[8:11], s28 offen offset:1024 lds
    buffer_load_dwordx4 v8, s[8:11], s28 offen offset:2048 lds
    s_mul_i32 s29, s24, 128
    s_add_u32 s29, s29, s26
    s_sub_u32 s29, s29, 331776
    s_mov_b32 m0, 86016
    s_nop 0
    buffer_load_dwordx4 v144, s[8:11], s29 offen offset:0 lds
    buffer_load_dwordx4 v145, s[8:11], s29 offen offset:1024 lds
    buffer_load_dwordx4 v146, s[8:11], s29 offen offset:2048 lds
    s_add_u32 s29, s29, 110592
    s_mov_b32 m0, 89088
    s_nop 0
    buffer_load_dwordx4 v9, s[8:11], s29 offen offset:0 lds
    buffer_load_dwordx4 v10, s[8:11], s29 offen offset:1024 lds
    buffer_load_dwordx4 v11, s[8:11], s29 offen offset:2048 lds
    s_add_u32 s29, s29, 110592
    s_mov_b32 m0, 92160
    s_nop 0
    buffer_load_dwordx4 v144, s[8:11], s29 offen offset:0 lds
    buffer_load_dwordx4 v145, s[8:11], s29 offen offset:1024 lds
    buffer_load_dwordx4 v146, s[8:11], s29 offen offset:2048 lds
    s_add_u32 s29, s29, 110592
    s_mov_b32 m0, 95232
    s_nop 0
    buffer_load_dwordx4 v9, s[8:11], s29 offen offset:0 lds
    buffer_load_dwordx4 v10, s[8:11], s29 offen offset:1024 lds
    buffer_load_dwordx4 v11, s[8:11], s29 offen offset:2048 lds
    s_add_u32 s24, s24, 1
    s_cmp_eq_u32 s24, 12
    s_cselect_b32 s24, 0, s24
    s_waitcnt vmcnt(15)
    s_barrier
    s_lshl_b32 s28, s24, 7
    s_add_u32 s28, s28, s25
    s_add_u32 m0, s27, 98304
    s_nop 0
    buffer_load_dwordx4 v6, s[8:11], s28 offen offset:0 lds
    buffer_load_dwordx4 v7, s[8:11], s28 offen offset:1024 lds
    buffer_load_dwordx4 v8, s[8:11], s28 offen offset:2048 lds
    s_mul_i32 s29, s24, 128
    s_add_u32 s29, s29, s26
    s_sub_u32 s29, s29, 331776
    s_mov_b32 m0, 110592
    s_nop 0
    buffer_load_dwordx4 v144, s[8:11], s29 offen offset:0 lds
    buffer_load_dwordx4 v145, s[8:11], s29 offen offset:1024 lds
    buffer_load_dwordx4 v146, s[8:11], s29 offen offset:2048 lds
    s_add_u32 s29, s29, 110592
    s_mov_b32 m0, 113664
    s_nop 0
    buffer_load_dwordx4 v9, s[8:11], s29 offen offset:0 lds
    buffer_load_dwordx4 v10, s[8:11], s29 offen offset:1024 lds
    buffer_load_dwordx4 v11, s[8:11], s29 offen offset:2048 lds
    s_add_u32 s29, s29, 110592
    s_mov_b32 m0, 116736
    s_nop 0
    buffer_load_dwordx4 v144, s[8:11], s29 offen offset:0 lds
    buffer_load_dwordx4 v145, s[8:11], s29 offen offset:1024 lds
    buffer_load_dwordx4 v146, s[8:11], s29 offen offset:2048 lds
    s_add_u32 s29, s29, 110592
    s_mov_b32 m0, 119808
    s_nop 0
    buffer_load_dwordx4 v9, s[8:11], s29 offen offset:0 lds
    buffer_load_dwordx4 v10, s[8:11], s29 offen offset:1024 lds
    buffer_load_dwordx4 v11, s[8:11], s29 offen offset:2048 lds
    s_add_u32 s24, s24, 1
    s_cmp_eq_u32 s24, 12
    s_cselect_b32 s24, 0, s24
    s_waitcnt vmcnt(15)
    s_barrier
    s_lshl_b32 s28, s24, 7
    s_add_u32 s28, s28, s25
    s_add_u32 m0, s27, 122880
    s_nop 0
    buffer_load_dwordx4 v6, s[8:11], s28 offen offset:0 lds
    buffer_load_dwordx4 v7, s[8:11], s28 offen offset:1024 lds
    buffer_load_dwordx4 v8, s[8:11], s28 offen offset:2048 lds
    s_mul_i32 s29, s24, 128
    s_add_u32 s29, s29, s26
    s_sub_u32 s29, s29, 331776
    s_mov_b32 m0, 135168
    s_nop 0
    buffer_load_dwordx4 v144, s[8:11], s29 offen offset:0 lds
    buffer_load_dwordx4 v145, s[8:11], s29 offen offset:1024 lds
    buffer_load_dwordx4 v146, s[8:11], s29 offen offset:2048 lds
    s_add_u32 s29, s29, 110592
    s_mov_b32 m0, 138240
    s_nop 0
    buffer_load_dwordx4 v9, s[8:11], s29 offen offset:0 lds
    buffer_load_dwordx4 v10, s[8:11], s29 offen offset:1024 lds
    buffer_load_dwordx4 v11, s[8:11], s29 offen offset:2048 lds
    s_add_u32 s29, s29, 110592
    s_mov_b32 m0, 141312
    s_nop 0
    buffer_load_dwordx4 v144, s[8:11], s29 offen offset:0 lds
    buffer_load_dwordx4 v145, s[8:11], s29 offen offset:1024 lds
    buffer_load_dwordx4 v146, s[8:11], s29 offen offset:2048 lds
    s_add_u32 s29, s29, 110592
    s_mov_b32 m0, 144384
    s_nop 0
    buffer_load_dwordx4 v9, s[8:11], s29 offen offset:0 lds
    buffer_load_dwordx4 v10, s[8:11], s29 offen offset:1024 lds
    buffer_load_dwordx4 v11, s[8:11], s29 offen offset:2048 lds
    s_add_u32 s24, s24, 1
    s_cmp_eq_u32 s24, 12
    s_cselect_b32 s24, 0, s24
    s_waitcnt vmcnt(15)
    s_barrier
    s_waitcnt vmcnt(0)
    s_barrier
    v_readfirstlane_b32 s60, v251
    s_nop 3
    s_and_b32 s60, s60, 0xfffffffc
    s_add_u32 s37, s60, 5
    s_waitcnt vmcnt(0)
w_join_4:
    s_lshl_b32 s60, s21, 3
    s_add_u32 s60, s60, s23
    s_mul_i32 s60, s60, 1024
    s_lshl_b32 s61, s22, 2
    s_add_u32 s60, s60, s61
    s_add_u32 s64, s60, 18890752
    s_barrier
    s_cmp_eq_u32 s20, 1
    s_cbranch_scc0 pub_skip_7
    v_mov_b32 v1, s37
    v_lshlrev_b32 v2, 7, v255
    s_mov_b64 s[62:63], exec
    s_mov_b64 exec, 255
    buffer_store_dword v1, v2, s[16:19], s64 offen sc1
    s_mov_b64 exec, s[62:63]
pub_skip_7:
    s_branch L_phaseB
w_main1:
    s_mul_i32 s27, s20, 3072
    s_lshl_b32 s28, s24, 7
    s_add_u32 s28, s28, s25
    s_add_u32 m0, s27, 0
    s_nop 0
    buffer_load_dwordx4 v6, s[8:11], s28 offen offset:0 lds
    buffer_load_dwordx4 v7, s[8:11], s28 offen offset:1024 lds
    buffer_load_dwordx4 v8, s[8:11], s28 offen offset:2048 lds
    s_mul_i32 s29, s24, 98304
    s_add_u32 s29, s29, s26
    s_add_u32 m0, s27, 12288
    s_nop 0
    buffer_load_dwordx4 v9, s[12:15], s29 offen offset:0 lds
    buffer_load_dwordx4 v10, s[12:15], s29 offen offset:1024 lds
    buffer_load_dwordx4 v11, s[12:15], s29 offen offset:2048 lds
    s_add_u32 s24, s24, 1
    s_cmp_eq_u32 s24, 12
    s_cselect_b32 s24, 0, s24
    s_lshl_b32 s28, s24, 7
    s_add_u32 s28, s28, s25
    s_add_u32 m0, s27, 24576
    s_nop 0
    buffer_load_dwordx4 v6, s[8:11], s28 offen offset:0 lds
    buffer_load_dwordx4 v7, s[8:11], s28 offen offset:1024 lds
    buffer_load_dwordx4 v8, s[8:11], s28 offen offset:2048 lds
    s_mul_i32 s29, s24, 98304
    s_add_u32 s29, s29, s26
    s_add_u32 m0, s27, 36864
    s_nop 0
    buffer_load_dwordx4 v9, s[12:15], s29 offen offset:0 lds
    buffer_load_dwordx4 v10, s[12:15], s29 offen offset:1024 lds
    buffer_load_dwordx4 v11, s[12:15], s29 offen offset:2048 lds
    s_add_u32 s24, s24, 1
    s_cmp_eq_u32 s24, 12
    s_cselect_b32 s24, 0, s24
    v_and_b32 v12, 31, v255
    v_lshrrev_b32 v13, 5, v255
    v_lshrrev_b32 v14, 1, v12
    v_and_b32 v14, 7, v14
    v_xor_b32 v14, v14, v13
    v_lshlrev_b32 v14, 4, v14
    v_lshlrev_b32 v12, 7, v12
    v_add_u32 v12, v12, v14
    v_xor_b32 v16, 0, v12
    v_xor_b32 v17, 32, v12
    v_xor_b32 v18, 64, v12
    v_xor_b32 v19, 96, v12
    s_lshl_b32 s60, s20, 12
    v_add_u32 v20, s60, v16
    v_add_u32 v21, s60, v17
    v_add_u32 v22, s60, v18
    v_add_u32 v23, s60, v19
    v_lshrrev_b32 v13, 4, v255
    v_and_b32 v14, 15, v255
    v_lshrrev_b32 v14, 2, v14
    v_lshrrev_b32 v15, 1, v13
    v_lshlrev_b32 v15, 3, v15
    v_add_u32 v14, v14, v15
    v_mul_u32_u24 v14, 192, v14
    v_and_b32 v13, 1, v13
    v_lshlrev_b32 v13, 5, v13
    v_and_b32 v15, 3, v255
    v_lshlrev_b32 v15, 3, v15
    v_add3_u32 v16, v14, v13, v15
    v_add_u32 v120, 0, v20
    v_add_u32 v121, 0, v21
    v_add_u32 v122, 0, v22
    v_add_u32 v123, 0, v23
    v_add_u32 v132, 0, v16
    v_add_u32 v124, 65536, v20
    v_add_u32 v125, 65536, v21
    v_add_u32 v126, 65536, v22
    v_add_u32 v127, 65536, v23
    v_add_u32 v133, 65536, v16
    v_add_u32 v128, 131072, v20
    v_add_u32 v129, 131072, v21
    v_add_u32 v130, 131072, v22
    v_add_u32 v131, 131072, v23
    v_add_u32 v134, 131072, v16
    s_cmp_eq_u32 s20, 3
    s_cbranch_scc1 w_wave3_8
    s_waitcnt vmcnt(6)
    s_barrier
    ds_read_b128 v[24:27], v120 offset:0
    ds_read_b64_tr_b16 v[28:29], v132 offset:12288
    ds_read_b64_tr_b16 v[30:31], v132 offset:13056
    ds_read_b64_tr_b16 v[32:33], v132 offset:12352
    ds_read_b64_tr_b16 v[34:35], v132 offset:13120
    ds_read_b64_tr_b16 v[36:37], v132 offset:12416
    ds_read_b64_tr_b16 v[38:39], v132 offset:13184
    ds_read_b128 v[40:43], v121 offset:0
    ds_read_b64_tr_b16 v[44:45], v132 offset:15360
    ds_read_b64_tr_b16 v[46:47], v132 offset:16128
    ds_read_b64_tr_b16 v[48:49], v132 offset:15424
    ds_read_b64_tr_b16 v[50:51], v132 offset:16192
    ds_read_b64_tr_b16 v[52:53], v132 offset:15488
    ds_read_b64_tr_b16 v[54:55], v132 offset:16256
    s_waitcnt lgkmcnt(11)
    v_mfma_f32_32x32x16_bf16 v[72:87], v[24:27], v[28:31], 0
    ds_read_b128 v[56:59], v122 offset:0
    ds_read_b64_tr_b16 v[60:61], v132 offset:18432
    ds_read_b64_tr_b16 v[62:63], v132 offset:19200
    s_lshl_b32 s28, s24, 7
    s_add_u32 s28, s28, s25
    s_add_u32 m0, s27, 49152
    s_nop 0
    buffer_load_dwordx4 v6, s[8:11], s28 offen offset:0 lds
    s_waitcnt lgkmcnt(12)
    v_mfma_f32_32x32x16_bf16 v[88:103], v[24:27], v[32:35], 0
    ds_read_b64_tr_b16 v[64:65], v132 offset:18496
    ds_read_b64_tr_b16 v[66:67], v132 offset:19264
    s_waitcnt lgkmcnt(12)
    v_mfma_f32_32x32x16_bf16 v[104:119], v[24:27], v[36:39], 0
    ds_read_b64_tr_b16 v[68:69], v132 offset:18560
    ds_read_b64_tr_b16 v[70:71], v132 offset:19328
    buffer_load_dwordx4 v7, s[8:11], s28 offen offset:1024 lds
    s_waitcnt lgkmcnt(11)
    v_mfma_f32_32x32x16_bf16 v[72:87], v[40:43], v[44:47], v[72:87]
    ds_read_b128 v[24:27], v123 offset:0
    ds_read_b64_tr_b16 v[28:29], v132 offset:21504
    ds_read_b64_tr_b16 v[30:31], v132 offset:22272
    s_waitcnt lgkmcnt(12)
    v_mfma_f32_32x32x16_bf16 v[88:103], v[40:43], v[48:51], v[88:103]
    ds_read_b64_tr_b16 v[32:33], v132 offset:21568
    ds_read_b64_tr_b16 v[34:35], v132 offset:22336
    buffer_load_dwordx4 v8, s[8:11], s28 offen offset:2048 lds
    s_add_u32 s24, s24, 1
    s_cmp_eq_u32 s24, 12
    s_cselect_b32 s24, 0, s24
    s_waitcnt lgkmcnt(12)
    v_mfma_f32_32x32x16_bf16 v[104:119], v[40:43], v[52:55], v[104:119]
    ds_read_b64_tr_b16 v[36:37], v132 offset:21632
    ds_read_b64_tr_b16 v[38:39], v132 offset:22400
    s_waitcnt vmcnt(3)
    s_barrier
    s_waitcnt lgkmcnt(11)
    v_mfma_f32_32x32x16_bf16 v[72:87], v[56:59], v[60:63], v[72:87]
    ds_read_b128 v[40:43], v120 offset:24576
    ds_read_b64_tr_b16 v[44:45], v132 offset:36864
    ds_read_b64_tr_b16 v[46:47], v132 offset:37632
    s_lshl_b32 s28, s24, 7
    s_add_u32 s28, s28, s25
    s_add_u32 m0, s27, 73728
    s_nop 0
    buffer_load_dwordx4 v6, s[8:11], s28 offen offset:0 lds
    s_waitcnt lgkmcnt(12)
    v_mfma_f32_32x32x16_bf16 v[88:103], v[56:59], v[64:67], v[88:103]
    ds_read_b64_tr_b16 v[48:49], v132 offset:36928
    ds_read_b64_tr_b16 v[50:51], v132 offset:37696
    s_waitcnt lgkmcnt(12)
    v_mfma_f32_32x32x16_bf16 v[104:119], v[56:59], v[68:71], v[104:119]
    ds_read_b64_tr_b16 v[52:53], v132 offset:36992
    ds_read_b64_tr_b16 v[54:55], v132 offset:37760
    buffer_load_dwordx4 v7, s[8:11], s28 offen offset:1024 lds
    s_waitcnt lgkmcnt(11)
    v_mfma_f32_32x32x16_bf16 v[72:87], v[24:27], v[28:31], v[72:87]
    ds_read_b128 v[56:59], v121 offset:24576
    ds_read_b64_tr_b16 v[60:61], v132 offset:39936
    ds_read_b64_tr_b16 v[62:63], v132 offset:40704
    s_waitcnt lgkmcnt(12)
    v_mfma_f32_32x32x16_bf16 v[88:103], v[24:27], v[32:35], v[88:103]
    ds_read_b64_tr_b16 v[64:65], v132 offset:40000
    ds_read_b64_tr_b16 v[66:67], v132 offset:40768
    buffer_load_dwordx4 v8, s[8:11], s28 offen offset:2048 lds
    s_add_u32 s24, s24, 1
    s_cmp_eq_u32 s24, 12
    s_cselect_b32 s24, 0, s24
    s_waitcnt lgkmcnt(12)
    v_mfma_f32_32x32x16_bf16 v[104:119], v[24:27], v[36:39], v[104:119]
    ds_read_b64_tr_b16 v[68:69], v132 offset:40064
    ds_read_b64_tr_b16 v[70:71], v132 offset:40832
    s_waitcnt lgkmcnt(11)
    v_mfma_f32_32x32x16_bf16 v[72:87], v[40:43], v[44:47], v[72:87]
    ds_read_b128 v[24:27], v122 offset:24576
    ds_read_b64_tr_b16 v[28:29], v132 offset:43008
    ds_read_b64_tr_b16 v[30:31], v132 offset:43776
    s_waitcnt lgkmcnt(12)
    v_mfma_f32_32x32x16_bf16 v[88:103], v[40:43], v[48:51], v[88:103]
    ds_read_b64_tr_b16 v[32:33], v132 offset:43072
    ds_read_b64_tr_b16 v[34:35], v132 offset:43840
    s_waitcnt lgkmcnt(12)
    v_mfma_f32_32x32x16_bf16 v[104:119], v[40:43], v[52:55], v[104:119]
    ds_read_b64_tr_b16 v[36:37], v132 offset:43136
    ds_read_b64_tr_b16 v[38:39], v132 offset:43904
    s_waitcnt lgkmcnt(11)
    v_mfma_f32_32x32x16_bf16 v[72:87], v[56:59], v[60:63], v[72:87]
    ds_read_b128 v[40:43], v123 offset:24576
    ds_read_b64_tr_b16 v[44:45], v132 offset:46080
    ds_read_b64_tr_b16 v[46:47], v132 offset:46848
    s_waitcnt lgkmcnt(12)
    v_mfma_f32_32x32x16_bf16 v[88:103], v[56:59], v[64:67], v[88:103]
    ds_read_b64_tr_b16 v[48:49], v132 offset:46144
    ds_read_b64_tr_b16 v[50:51], v132 offset:46912
    s_waitcnt lgkmcnt(12)
    v_mfma_f32_32x32x16_bf16 v[104:119], v[56:59], v[68:71], v[104:119]
    ds_read_b64_tr_b16 v[52:53], v132 offset:46208
    ds_read_b64_tr_b16 v[54:55], v132 offset:46976
    s_waitcnt vmcnt(3)
    s_barrier
    s_waitcnt lgkmcnt(11)
    v_mfma_f32_32x32x16_bf16 v[72:87], v[24:27], v[28:31], v[72:87]
    ds_read_b128 v[56:59], v120 offset:49152
    ds_read_b64_tr_b16 v[60:61], v132 offset:61440
    ds_read_b64_tr_b16 v[62:63], v132 offset:62208
    s_lshl_b32 s28, s24, 7
    s_add_u32 s28, s28, s25
    s_add_u32 m0, s27, 98304
    s_nop 0
    buffer_load_dwordx4 v6, s[8:11], s28 offen offset:0 lds
    s_waitcnt lgkmcnt(12)
    v_mfma_f32_32x32x16_bf16 v[88:103], v[24:27], v[32:35], v[88:103]
    ds_read_b64_tr_b16 v[64:65], v132 offset:61504
    ds_read_b64_tr_b16 v[66:67], v132 offset:62272
    s_waitcnt lgkmcnt(12)
    v_mfma_f32_32x32x16_bf16 v[104:119], v[24:27], v[36:39], v[104:119]
    ds_read_b64_tr_b16 v[68:69], v132 offset:61568
    ds_read_b64_tr_b16 v[70:71], v132 offset:62336
    buffer_load_dwordx4 v7, s[8:11], s28 offen offset:1024 lds
    s_waitcnt lgkmcnt(11)
    v_mfma_f32_32x32x16_bf16 v[72:87], v[40:43], v[44:47], v[72:87]
    ds_read_b128 v[24:27], v121 offset:49152
    ds_read_b64_tr_b16 v[28:29], v132 offset:64512
    ds_read_b64_tr_b16 v[30:31], v132 offset:65280
    s_waitcnt lgkmcnt(12)
    v_mfma_f32_32x32x16_bf16 v[88:103], v[40:43], v[48:51], v[88:103]
    ds_read_b64_tr_b16 v[32:33], v132 offset:64576
    ds_read_b64_tr_b16 v[34:35], v132 offset:65344
    buffer_load_dwordx4 v8, s[8:11], s28 offen offset:2048 lds
    s_add_u32 s24, s24, 1
    s_cmp_eq_u32 s24, 12
    s_cselect_b32 s24, 0, s24
    s_waitcnt lgkmcnt(12)
    v_mfma_f32_32x32x16_bf16 v[104:119], v[40:43], v[52:55], v[104:119]
    ds_read_b64_tr_b16 v[36:37], v132 offset:64640
    ds_read_b64_tr_b16 v[38:39], v132 offset:65408
    s_waitcnt lgkmcnt(11)
    v_mfma_f32_32x32x16_bf16 v[72:87], v[56:59], v[60:63], v[72:87]
    ds_read_b128 v[40:43], v122 offset:49152
    ds_read_b64_tr_b16 v[44:45], v133 offset:2048
    ds_read_b64_tr_b16 v[46:47], v133 offset:2816
    s_waitcnt lgkmcnt(12)
    v_mfma_f32_32x32x16_bf16 v[88:103], v[56:59], v[64:67], v[88:103]
    ds_read_b64_tr_b16 v[48:49], v133 offset:2112
    ds_read_b64_tr_b16 v[50:51], v133 offset:2880
    s_waitcnt lgkmcnt(12)
    v_mfma_f32_32x32x16_bf16 v[104:119], v[56:59], v[68:71], v[104:119]
    ds_read_b64_tr_b16 v[52:53], v133 offset:2176
    ds_read_b64_tr_b16 v[54:55], v133 offset:2944
    s_waitcnt lgkmcnt(11)
    v_mfma_f32_32x32x16_bf16 v[72:87], v[24:27], v[28:31], v[72:87]
    ds_read_b128 v[56:59], v123 offset:49152
    ds_read_b64_tr_b16 v[60:61], v133 offset:5120
    ds_read_b64_tr_b16 v[62:63], v133 offset:5888
    s_waitcnt lgkmcnt(12)
    v_mfma_f32_32x32x16_bf16 v[88:103], v[24:27], v[32:35], v[88:103]
    ds_read_b64_tr_b16 v[64:65], v133 offset:5184
    ds_read_b64_tr_b16 v[66:67], v133 offset:5952
    s_waitcnt lgkmcnt(12)
    v_mfma_f32_32x32x16_bf16 v[104:119], v[24:27], v[36:39], v[104:119]
    ds_read_b64_tr_b16 v[68:69], v133 offset:5248
    ds_read_b64_tr_b16 v[70:71], v133 offset:6016
    s_waitcnt vmcnt(3)
    s_barrier
    s_waitcnt lgkmcnt(11)
    v_mfma_f32_32x32x16_bf16 v[72:87], v[40:43], v[44:47], v[72:87]
    ds_read_b128 v[24:27], v124 offset:8192
    ds_read_b64_tr_b16 v[28:29], v133 offset:20480
    ds_read_b64_tr_b16 v[30:31], v133 offset:21248
    s_lshl_b32 s28, s24, 7
    s_add_u32 s28, s28, s25
    s_add_u32 m0, s27, 122880
    s_nop 0
    buffer_load_dwordx4 v6, s[8:11], s28 offen offset:0 lds
    s_waitcnt lgkmcnt(12)
    v_mfma_f32_32x32x16_bf16 v[88:103], v[40:43], v[48:51], v[88:103]
    ds_read_b64_tr_b16 v[32:33], v133 offset:20544
    ds_read_b64_tr_b16 v[34:35], v133 offset:21312
    s_waitcnt lgkmcnt(12)
    v_mfma_f32_32x32x16_bf16 v[104:119], v[40:43], v[52:55], v[104:119]
    ds_read_b64_tr_b16 v[36:37], v133 offset:20608
    ds_read_b64_tr_b16 v[38:39], v133 offset:21376
    buffer_load_dwordx4 v7, s[8:11], s28 offen offset:1024 lds
    s_waitcnt lgkmcnt(11)
    v_mfma_f32_32x32x16_bf16 v[72:87], v[56:59], v[60:63], v[72:87]
    ds_read_b128 v[40:43], v125 offset:8192
    ds_read_b64_tr_b16 v[44:45], v133 offset:23552
    ds_read_b64_tr_b16 v[46:47], v133 offset:24320
    s_waitcnt lgkmcnt(12)
    v_mfma_f32_32x32x16_bf16 v[88:103], v[56:59], v[64:67], v[88:103]
    ds_read_b64_tr_b16 v[48:49], v133 offset:23616
    ds_read_b64_tr_b16 v[50:51], v133 offset:24384
    buffer_load_dwordx4 v8, s[8:11], s28 offen offset:2048 lds
    s_add_u32 s24, s24, 1
    s_cmp_eq_u32 s24, 12
    s_cselect_b32 s24, 0, s24
    s_waitcnt lgkmcnt(12)
    v_mfma_f32_32x32x16_bf16 v[104:119], v[56:59], v[68:71], v[104:119]
    ds_read_b64_tr_b16 v[52:53], v133 offset:23680
    ds_read_b64_tr_b16 v[54:55], v133 offset:24448
    s_waitcnt lgkmcnt(11)
    v_mfma_f32_32x32x16_bf16 v[72:87], v[24:27], v[28:31], v[72:87]
    ds_read_b128 v[56:59], v126 offset:8192
    ds_read_b64_tr_b16 v[60:61], v133 offset:26624
    ds_read_b64_tr_b16 v[62:63], v133 offset:27392
    s_waitcnt lgkmcnt(12)
    v_mfma_f32_32x32x16_bf16 v[88:103], v[24:27], v[32:35], v[88:103]
    ds_read_b64_tr_b16 v[64:65], v133 offset:26688
    ds_read_b64_tr_b16 v[66:67], v133 offset:27456
    s_waitcnt lgkmcnt(12)
    v_mfma_f32_32x32x16_bf16 v[104:119], v[24:27], v[36:39], v[104:119]
    ds_read_b64_tr_b16 v[68:69], v133 offset:26752
    ds_read_b64_tr_b16 v[70:71], v133 offset:27520
    s_waitcnt lgkmcnt(11)
    v_mfma_f32_32x32x16_bf16 v[72:87], v[40:43], v[44:47], v[72:87]
    ds_read_b128 v[24:27], v127 offset:8192
    ds_read_b64_tr_b16 v[28:29], v133 offset:29696
    ds_read_b64_tr_b16 v[30:31], v133 offset:30464
    s_waitcnt lgkmcnt(12)
    v_mfma_f32_32x32x16_bf16 v[88:103], v[40:43], v[48:51], v[88:103]
    ds_read_b64_tr_b16 v[32:33], v133 offset:29760
    ds_read_b64_tr_b16 v[34:35], v133 offset:30528
    s_waitcnt lgkmcnt(12)
    v_mfma_f32_32x32x16_bf16 v[104:119], v[40:43], v[52:55], v[104:119]
    ds_read_b64_tr_b16 v[36:37], v133 offset:29824
    ds_read_b64_tr_b16 v[38:39], v133 offset:30592
    s_waitcnt vmcnt(3)
    s_barrier
    s_waitcnt lgkmcnt(11)
    v_mfma_f32_32x32x16_bf16 v[72:87], v[56:59], v[60:63], v[72:87]
    ds_read_b128 v[40:43], v124 offset:32768
    ds_read_b64_tr_b16 v[44:45], v133 offset:45056
    ds_read_b64_tr_b16 v[46:47], v133 offset:45824
    s_lshl_b32 s28, s24, 7
    s_add_u32 s28, s28, s25
    s_add_u32 m0, s27, 0
    s_nop 0
    buffer_load_dwordx4 v6, s[8:11], s28 offen offset:0 lds
    s_waitcnt lgkmcnt(12)
    v_mfma_f32_32x32x16_bf16 v[88:103], v[56:59], v[64:67], v[88:103]
    ds_read_b64_tr_b16 v[48:49], v133 offset:45120
    ds_read_b64_tr_b16 v[50:51], v133 offset:45888
    s_waitcnt lgkmcnt(12)
    v_mfma_f32_32x32x16_bf16 v[104:119], v[56:59], v[68:71], v[104:119]
    ds_read_b64_tr_b16 v[52:53], v133 offset:45184
    ds_read_b64_tr_b16 v[54:55], v133 offset:45952
    buffer_load_dwordx4 v7, s[8:11], s28 offen offset:1024 lds
    s_waitcnt lgkmcnt(11)
    v_mfma_f32_32x32x16_bf16 v[72:87], v[24:27], v[28:31], v[72:87]
    ds_read_b128 v[56:59], v125 offset:32768
    ds_read_b64_tr_b16 v[60:61], v133 offset:48128
    ds_read_b64_tr_b16 v[62:63], v133 offset:48896
    s_waitcnt lgkmcnt(12)
    v_mfma_f32_32x32x16_bf16 v[88:103], v[24:27], v[32:35], v[88:103]
    ds_read_b64_tr_b16 v[64:65], v133 offset:48192
    ds_read_b64_tr_b16 v[66:67], v133 offset:48960
    buffer_load_dwordx4 v8, s[8:11], s28 offen offset:2048 lds
    s_add_u32 s24, s24, 1
    s_cmp_eq_u32 s24, 12
    s_cselect_b32 s24, 0, s24
    s_waitcnt lgkmcnt(12)
    v_mfma_f32_32x32x16_bf16 v[104:119], v[24:27], v[36:39], v[104:119]
    ds_read_b64_tr_b16 v[68:69], v133 offset:48256
    ds_read_b64_tr_b16 v[70:71], v133 offset:49024
    s_waitcnt lgkmcnt(11)
    v_mfma_f32_32x32x16_bf16 v[72:87], v[40:43], v[44:47], v[72:87]
    ds_read_b128 v[24:27], v126 offset:32768
    ds_read_b64_tr_b16 v[28:29], v133 offset:51200
    ds_read_b64_tr_b16 v[30:31], v133 offset:51968
    s_waitcnt lgkmcnt(12)
    v_mfma_f32_32x32x16_bf16 v[88:103], v[40:43], v[48:51], v[88:103]
    ds_read_b64_tr_b16 v[32:33], v133 offset:51264
    ds_read_b64_tr_b16 v[34:35], v133 offset:52032
    s_waitcnt lgkmcnt(12)
    v_mfma_f32_32x32x16_bf16 v[104:119], v[40:43], v[52:55], v[104:119]
    ds_read_b64_tr_b16 v[36:37], v133 offset:51328
    ds_read_b64_tr_b16 v[38:39], v133 offset:52096
    s_waitcnt lgkmcnt(11)
    v_mfma_f32_32x32x16_bf16 v[72:87], v[56:59], v[60:63], v[72:87]
    ds_read_b128 v[40:43], v127 offset:32768
    ds_read_b64_tr_b16 v[44:45], v133 offset:54272
    ds_read_b64_tr_b16 v[46:47], v133 offset:55040
    s_waitcnt lgkmcnt(12)
    v_mfma_f32_32x32x16_bf16 v[88:103], v[56:59], v[64:67], v[88:103]
    ds_read_b64_tr_b16 v[48:49], v133 offset:54336
    ds_read_b64_tr_b16 v[50:51], v133 offset:55104
    s_waitcnt lgkmcnt(12)
    v_mfma_f32_32x32x16_bf16 v[104:119], v[56:59], v[68:71], v[104:119]
    ds_read_b64_tr_b16 v[52:53], v133 offset:54400
    ds_read_b64_tr_b16 v[54:55], v133 offset:55168
    s_waitcnt vmcnt(3)
    s_barrier
    s_waitcnt lgkmcnt(11)
    v_mfma_f32_32x32x16_bf16 v[72:87], v[24:27], v[28:31], v[72:87]
    ds_read_b128 v[56:59], v124 offset:57344
    ds_read_b64_tr_b16 v[60:61], v134 offset:4096
    ds_read_b64_tr_b16 v[62:63], v134 offset:4864
    s_lshl_b32 s28, s24, 7
    s_add_u32 s28, s28, s25
    s_add_u32 m0, s27, 24576
    s_nop 0
    buffer_load_dwordx4 v6, s[8:11], s28 offen offset:0 lds
    s_waitcnt lgkmcnt(12)
    v_mfma_f32_32x32x16_bf16 v[88:103], v[24:27], v[32:35], v[88:103]
    ds_read_b64_tr_b16 v[64:65], v134 offset:4160
    ds_read_b64_tr_b16 v[66:67], v134 offset:4928
    s_waitcnt lgkmcnt(12)
    v_mfma_f32_32x32x16_bf16 v[104:119], v[24:27], v[36:39], v[104:119]
    ds_read_b64_tr_b16 v[68:69], v134 offset:4224
    ds_read_b64_tr_b16 v[70:71], v134 offset:4992
    buffer_load_dwordx4 v7, s[8:11], s28 offen offset:1024 lds
    s_waitcnt lgkmcnt(11)
    v_mfma_f32_32x32x16_bf16 v[72:87], v[40:43], v[44:47], v[72:87]
    ds_read_b128 v[24:27], v125 offset:57344
    ds_read_b64_tr_b16 v[28:29], v134 offset:7168
    ds_read_b64_tr_b16 v[30:31], v134 offset:7936
    s_waitcnt lgkmcnt(12)
    v_mfma_f32_32x32x16_bf16 v[88:103], v[40:43], v[48:51], v[88:103]
    ds_read_b64_tr_b16 v[32:33], v134 offset:7232
    ds_read_b64_tr_b16 v[34:35], v134 offset:8000
    buffer_load_dwordx4 v8, s[8:11], s28 offen offset:2048 lds
    s_add_u32 s24, s24, 1
    s_cmp_eq_u32 s24, 12
    s_cselect_b32 s24, 0, s24
    s_waitcnt lgkmcnt(12)
    v_mfma_f32_32x32x16_bf16 v[104:119], v[40:43], v[52:55], v[104:119]
    ds_read_b64_tr_b16 v[36:37], v134 offset:7296
    ds_read_b64_tr_b16 v[38:39], v134 offset:8064
    s_waitcnt lgkmcnt(11)
    v_mfma_f32_32x32x16_bf16 v[72:87], v[56:59], v[60:63], v[72:87]
    ds_read_b128 v[40:43], v126 offset:57344
    ds_read_b64_tr_b16 v[44:45], v134 offset:10240
    ds_read_b64_tr_b16 v[46:47], v134 offset:11008
    s_waitcnt lgkmcnt(12)
    v_mfma_f32_32x32x16_bf16 v[88:103], v[56:59], v[64:67], v[88:103]
    ds_read_b64_tr_b16 v[48:49], v134 offset:10304
    ds_read_b64_tr_b16 v[50:51], v134 offset:11072
    s_waitcnt lgkmcnt(12)
    v_mfma_f32_32x32x16_bf16 v[104:119], v[56:59], v[68:71], v[104:119]
    ds_read_b64_tr_b16 v[52:53], v134 offset:10368
    ds_read_b64_tr_b16 v[54:55], v134 offset:11136
    s_waitcnt lgkmcnt(11)
    v_mfma_f32_32x32x16_bf16 v[72:87], v[24:27], v[28:31], v[72:87]
    ds_read_b128 v[56:59], v127 offset:57344
    ds_read_b64_tr_b16 v[60:61], v134 offset:13312
    ds_read_b64_tr_b16 v[62:63], v134 offset:14080
    s_waitcnt lgkmcnt(12)
    v_mfma_f32_32x32x16_bf16 v[88:103], v[24:27], v[32:35], v[88:103]
    ds_read_b64_tr_b16 v[64:65], v134 offset:13376
    ds_read_b64_tr_b16 v[66:67], v134 offset:14144
    s_waitcnt lgkmcnt(12)
    v_mfma_f32_32x32x16_bf16 v[104:119], v[24:27], v[36:39], v[104:119]
    ds_read_b64_tr_b16 v[68:69], v134 offset:13440
    ds_read_b64_tr_b16 v[70:71], v134 offset:14208
    s_waitcnt vmcnt(3)
    s_barrier
    s_waitcnt lgkmcnt(11)
    v_mfma_f32_32x32x16_bf16 v[72:87], v[40:43], v[44:47], v[72:87]
    ds_read_b128 v[24:27], v120 offset:0
    ds_read_b64_tr_b16 v[28:29], v132 offset:12288
    ds_read_b64_tr_b16 v[30:31], v132 offset:13056
    s_lshl_b32 s28, s24, 7
    s_add_u32 s28, s28, s25
    s_add_u32 m0, s27, 49152
    s_nop 0
    buffer_load_dwordx4 v6, s[8:11], s28 offen offset:0 lds
    s_waitcnt lgkmcnt(12)
    v_mfma_f32_32x32x16_bf16 v[88:103], v[40:43], v[48:51], v[88:103]
    ds_read_b64_tr_b16 v[32:33], v132 offset:12352
    ds_read_b64_tr_b16 v[34:35], v132 offset:13120
    s_waitcnt lgkmcnt(12)
    v_mfma_f32_32x32x16_bf16 v[104:119], v[40:43], v[52:55], v[104:119]
    ds_read_b64_tr_b16 v[36:37], v132 offset:12416
    ds_read_b64_tr_b16 v[38:39], v132 offset:13184
    buffer_load_dwordx4 v7, s[8:11], s28 offen offset:1024 lds
    s_waitcnt lgkmcnt(11)
    v_mfma_f32_32x32x16_bf16 v[72:87], v[56:59], v[60:63], v[72:87]
    ds_read_b128 v[40:43], v121 offset:0
    ds_read_b64_tr_b16 v[44:45], v132 offset:15360
    ds_read_b64_tr_b16 v[46:47], v132 offset:16128
    s_waitcnt lgkmcnt(12)
    v_mfma_f32_32x32x16_bf16 v[88:103], v[56:59], v[64:67], v[88:103]
    ds_read_b64_tr_b16 v[48:49], v132 offset:15424
    ds_read_b64_tr_b16 v[50:51], v132 offset:16192
    buffer_load_dwordx4 v8, s[8:11], s28 offen offset:2048 lds
    s_add_u32 s24, s24, 1
    s_cmp_eq_u32 s24, 12
    s_cselect_b32 s24, 0, s24
    s_waitcnt lgkmcnt(12)
    v_mfma_f32_32x32x16_bf16 v[104:119], v[56:59], v[68:71], v[104:119]
    ds_read_b64_tr_b16 v[52:53], v132 offset:15488
    ds_read_b64_tr_b16 v[54:55], v132 offset:16256
    s_waitcnt lgkmcnt(11)
    v_mfma_f32_32x32x16_bf16 v[72:87], v[24:27], v[28:31], v[72:87]
    ds_read_b128 v[56:59], v122 offset:0
    ds_read_b64_tr_b16 v[60:61], v132 offset:18432
    ds_read_b64_tr_b16 v[62:63], v132 offset:19200
    s_waitcnt lgkmcnt(12)
    v_mfma_f32_32x32x16_bf16 v[88:103], v[24:27], v[32:35], v[88:103]
    ds_read_b64_tr_b16 v[64:65], v132 offset:18496
    ds_read_b64_tr_b16 v[66:67], v132 offset:19264
    s_waitcnt lgkmcnt(12)
    v_mfma_f32_32x32x16_bf16 v[104:119], v[24:27], v[36:39], v[104:119]
    ds_read_b64_tr_b16 v[68:69], v132 offset:18560
    ds_read_b64_tr_b16 v[70:71], v132 offset:19328
    s_waitcnt lgkmcnt(11)
    v_mfma_f32_32x32x16_bf16 v[72:87], v[40:43], v[44:47], v[72:87]
    ds_read_b128 v[24:27], v123 offset:0
    ds_read_b64_tr_b16 v[28:29], v132 offset:21504
    ds_read_b64_tr_b16 v[30:31], v132 offset:22272
    s_waitcnt lgkmcnt(12)
    v_mfma_f32_32x32x16_bf16 v[88:103], v[40:43], v[48:51], v[88:103]
    ds_read_b64_tr_b16 v[32:33], v132 offset:21568
    ds_read_b64_tr_b16 v[34:35], v132 offset:22336
    s_waitcnt lgkmcnt(12)
    v_mfma_f32_32x32x16_bf16 v[104:119], v[40:43], v[52:55], v[104:119]
    ds_read_b64_tr_b16 v[36:37], v132 offset:21632
    ds_read_b64_tr_b16 v[38:39], v132 offset:22400
    s_waitcnt vmcnt(3)
    s_barrier
    s_waitcnt lgkmcnt(11)
    v_mfma_f32_32x32x16_bf16 v[72:87], v[56:59], v[60:63], v[72:87]
    ds_read_b128 v[40:43], v120 offset:24576
    ds_read_b64_tr_b16 v[44:45], v132 offset:36864
    ds_read_b64_tr_b16 v[46:47], v132 offset:37632
    s_lshl_b32 s28, s24, 7
    s_add_u32 s28, s28, s25
    s_add_u32 m0, s27, 73728
    s_nop 0
    buffer_load_dwordx4 v6, s[8:11], s28 offen offset:0 lds
    s_waitcnt lgkmcnt(12)
    v_mfma_f32_32x32x16_bf16 v[88:103], v[56:59], v[64:67], v[88:103]
    ds_read_b64_tr_b16 v[48:49], v132 offset:36928
    ds_read_b64_tr_b16 v[50:51], v132 offset:37696
    s_waitcnt lgkmcnt(12)
    v_mfma_f32_32x32x16_bf16 v[104:119], v[56:59], v[68:71], v[104:119]
    ds_read_b64_tr_b16 v[52:53], v132 offset:36992
    ds_read_b64_tr_b16 v[54:55], v132 offset:37760
    buffer_load_dwordx4 v7, s[8:11], s28 offen offset:1024 lds
    s_waitcnt lgkmcnt(11)
    v_mfma_f32_32x32x16_bf16 v[72:87], v[24:27], v[28:31], v[72:87]
    ds_read_b128 v[56:59], v121 offset:24576
    ds_read_b64_tr_b16 v[60:61], v132 offset:39936
    ds_read_b64_tr_b16 v[62:63], v132 offset:40704
    s_waitcnt lgkmcnt(12)
    v_mfma_f32_32x32x16_bf16 v[88:103], v[24:27], v[32:35], v[88:103]
    ds_read_b64_tr_b16 v[64:65], v132 offset:40000
    ds_read_b64_tr_b16 v[66:67], v132 offset:40768
    buffer_load_dwordx4 v8, s[8:11], s28 offen offset:2048 lds
    s_add_u32 s24, s24, 1
    s_cmp_eq_u32 s24, 12
    s_cselect_b32 s24, 0, s24
    s_waitcnt lgkmcnt(12)
    v_mfma_f32_32x32x16_bf16 v[104:119], v[24:27], v[36:39], v[104:119]
    ds_read_b64_tr_b16 v[68:69], v132 offset:40064
    ds_read_b64_tr_b16 v[70:71], v132 offset:40832
    s_waitcnt lgkmcnt(11)
    v_mfma_f32_32x32x16_bf16 v[72:87], v[40:43], v[44:47], v[72:87]
    ds_read_b128 v[24:27], v122 offset:24576
    ds_read_b64_tr_b16 v[28:29], v132 offset:43008
    ds_read_b64_tr_b16 v[30:31], v132 offset:43776
    s_waitcnt lgkmcnt(12)
    v_mfma_f32_32x32x16_bf16 v[88:103], v[40:43], v[48:51], v[88:103]
    ds_read_b64_tr_b16 v[32:33], v132 offset:43072
    ds_read_b64_tr_b16 v[34:35], v132 offset:43840
    s_waitcnt lgkmcnt(12)
    v_mfma_f32_32x32x16_bf16 v[104:119], v[40:43], v[52:55], v[104:119]
    ds_read_b64_tr_b16 v[36:37], v132 offset:43136
    ds_read_b64_tr_b16 v[38:39], v132 offset:43904
    s_waitcnt lgkmcnt(11)
    v_mfma_f32_32x32x16_bf16 v[72:87], v[56:59], v[60:63], v[72:87]
    ds_read_b128 v[40:43], v123 offset:24576
    ds_read_b64_tr_b16 v[44:45], v132 offset:46080
    ds_read_b64_tr_b16 v[46:47], v132 offset:46848
    s_waitcnt lgkmcnt(12)
    v_mfma_f32_32x32x16_bf16 v[88:103], v[56:59], v[64:67], v[88:103]
    ds_read_b64_tr_b16 v[48:49], v132 offset:46144
    ds_read_b64_tr_b16 v[50:51], v132 offset:46912
    s_waitcnt lgkmcnt(12)
    v_mfma_f32_32x32x16_bf16 v[104:119], v[56:59], v[68:71], v[104:119]
    ds_read_b64_tr_b16 v[52:53], v132 offset:46208
    ds_read_b64_tr_b16 v[54:55], v132 offset:46976
    s_waitcnt vmcnt(3)
    s_barrier
    s_waitcnt lgkmcnt(11)
    v_mfma_f32_32x32x16_bf16 v[72:87], v[24:27], v[28:31], v[72:87]
    ds_read_b128 v[56:59], v120 offset:49152
    ds_read_b64_tr_b16 v[60:61], v132 offset:61440
    ds_read_b64_tr_b16 v[62:63], v132 offset:62208
    s_lshl_b32 s28, s24, 7
    s_add_u32 s28, s28, s25
    s_add_u32 m0, s27, 98304
    s_nop 0
    buffer_load_dwordx4 v6, s[8:11], s28 offen offset:0 lds
    s_waitcnt lgkmcnt(12)
    v_mfma_f32_32x32x16_bf16 v[88:103], v[24:27], v[32:35], v[88:103]
    ds_read_b64_tr_b16 v[64:65], v132 offset:61504
    ds_read_b64_tr_b16 v[66:67], v132 offset:62272
    s_waitcnt lgkmcnt(12)
    v_mfma_f32_32x32x16_bf16 v[104:119], v[24:27], v[36:39], v[104:119]
    ds_read_b64_tr_b16 v[68:69], v132 offset:61568
    ds_read_b64_tr_b16 v[70:71], v132 offset:62336
    buffer_load_dwordx4 v7, s[8:11], s28 offen offset:1024 lds
    s_waitcnt lgkmcnt(11)
    v_mfma_f32_32x32x16_bf16 v[72:87], v[40:43], v[44:47], v[72:87]
    ds_read_b128 v[24:27], v121 offset:49152
    ds_read_b64_tr_b16 v[28:29], v132 offset:64512
    ds_read_b64_tr_b16 v[30:31], v132 offset:65280
    s_waitcnt lgkmcnt(12)
    v_mfma_f32_32x32x16_bf16 v[88:103], v[40:43], v[48:51], v[88:103]
    ds_read_b64_tr_b16 v[32:33], v132 offset:64576
    ds_read_b64_tr_b16 v[34:35], v132 offset:65344
    buffer_load_dwordx4 v8, s[8:11], s28 offen offset:2048 lds
    s_add_u32 s24, s24, 1
    s_cmp_eq_u32 s24, 12
    s_cselect_b32 s24, 0, s24
    s_waitcnt lgkmcnt(12)
    v_mfma_f32_32x32x16_bf16 v[104:119], v[40:43], v[52:55], v[104:119]
    ds_read_b64_tr_b16 v[36:37], v132 offset:64640
    ds_read_b64_tr_b16 v[38:39], v132 offset:65408
    s_waitcnt lgkmcnt(11)
    v_mfma_f32_32x32x16_bf16 v[72:87], v[56:59], v[60:63], v[72:87]
    ds_read_b128 v[40:43], v122 offset:49152
    ds_read_b64_tr_b16 v[44:45], v133 offset:2048
    ds_read_b64_tr_b16 v[46:47], v133 offset:2816
    s_waitcnt lgkmcnt(12)
    v_mfma_f32_32x32x16_bf16 v[88:103], v[56:59], v[64:67], v[88:103]
    ds_read_b64_tr_b16 v[48:49], v133 offset:2112
    ds_read_b64_tr_b16 v[50:51], v133 offset:2880
    s_waitcnt lgkmcnt(12)
    v_mfma_f32_32x32x16_bf16 v[104:119], v[56:59], v[68:71], v[104:119]
    ds_read_b64_tr_b16 v[52:53], v133 offset:2176
    ds_read_b64_tr_b16 v[54:55], v133 offset:2944
    s_waitcnt lgkmcnt(11)
    v_mfma_f32_32x32x16_bf16 v[72:87], v[24:27], v[28:31], v[72:87]
    ds_read_b128 v[56:59], v123 offset:49152
    ds_read_b64_tr_b16 v[60:61], v133 offset:5120
    ds_read_b64_tr_b16 v[62:63], v133 offset:5888
    s_waitcnt lgkmcnt(12)
    v_mfma_f32_32x32x16_bf16 v[88:103], v[24:27], v[32:35], v[88:103]
    ds_read_b64_tr_b16 v[64:65], v133 offset:5184
    ds_read_b64_tr_b16 v[66:67], v133 offset:5952
    s_waitcnt lgkmcnt(12)
    v_mfma_f32_32x32x16_bf16 v[104:119], v[24:27], v[36:39], v[104:119]
    ds_read_b64_tr_b16 v[68:69], v133 offset:5248
    ds_read_b64_tr_b16 v[70:71], v133 offset:6016
    s_waitcnt vmcnt(3)
    s_barrier
    s_waitcnt lgkmcnt(11)
    v_mfma_f32_32x32x16_bf16 v[72:87], v[40:43], v[44:47], v[72:87]
    ds_read_b128 v[24:27], v124 offset:8192
    ds_read_b64_tr_b16 v[28:29], v133 offset:20480
    ds_read_b64_tr_b16 v[30:31], v133 offset:21248
    s_lshl_b32 s28, s24, 7
    s_add_u32 s28, s28, s25
    s_add_u32 m0, s27, 122880
    s_nop 0
    buffer_load_dwordx4 v6, s[8:11], s28 offen offset:0 lds
    s_waitcnt lgkmcnt(12)
    v_mfma_f32_32x32x16_bf16 v[88:103], v[40:43], v[48:51], v[88:103]
    ds_read_b64_tr_b16 v[32:33], v133 offset:20544
    ds_read_b64_tr_b16 v[34:35], v133 offset:21312
    s_waitcnt lgkmcnt(12)
    v_mfma_f32_32x32x16_bf16 v[104:119], v[40:43], v[52:55], v[104:119]
    ds_read_b64_tr_b16 v[36:37], v133 offset:20608
    ds_read_b64_tr_b16 v[38:39], v133 offset:21376
    buffer_load_dwordx4 v7, s[8:11], s28 offen offset:1024 lds
    s_waitcnt lgkmcnt(11)
    v_mfma_f32_32x32x16_bf16 v[72:87], v[56:59], v[60:63], v[72:87]
    ds_read_b128 v[40:43], v125 offset:8192
    ds_read_b64_tr_b16 v[44:45], v133 offset:23552
    ds_read_b64_tr_b16 v[46:47], v133 offset:24320
    s_waitcnt lgkmcnt(12)
    v_mfma_f32_32x32x16_bf16 v[88:103], v[56:59], v[64:67], v[88:103]
    ds_read_b64_tr_b16 v[48:49], v133 offset:23616
    ds_read_b64_tr_b16 v[50:51], v133 offset:24384
    buffer_load_dwordx4 v8, s[8:11], s28 offen offset:2048 lds
    s_add_u32 s24, s24, 1
    s_cmp_eq_u32 s24, 12
    s_cselect_b32 s24, 0, s24
    s_waitcnt lgkmcnt(12)
    v_mfma_f32_32x32x16_bf16 v[104:119], v[56:59], v[68:71], v[104:119]
    ds_read_b64_tr_b16 v[52:53], v133 offset:23680
    ds_read_b64_tr_b16 v[54:55], v133 offset:24448
    s_waitcnt lgkmcnt(11)
    v_mfma_f32_32x32x16_bf16 v[72:87], v[24:27], v[28:31], v[72:87]
    ds_read_b128 v[56:59], v126 offset:8192
    ds_read_b64_tr_b16 v[60:61], v133 offset:26624
    ds_read_b64_tr_b16 v[62:63], v133 offset:27392
    s_waitcnt lgkmcnt(12)
    v_mfma_f32_32x32x16_bf16 v[88:103], v[24:27], v[32:35], v[88:103]
    ds_read_b64_tr_b16 v[64:65], v133 offset:26688
    ds_read_b64_tr_b16 v[66:67], v133 offset:27456
    s_waitcnt lgkmcnt(12)
    v_mfma_f32_32x32x16_bf16 v[104:119], v[24:27], v[36:39], v[104:119]
    ds_read_b64_tr_b16 v[68:69], v133 offset:26752
    ds_read_b64_tr_b16 v[70:71], v133 offset:27520
    s_waitcnt lgkmcnt(11)
    v_mfma_f32_32x32x16_bf16 v[72:87], v[40:43], v[44:47], v[72:87]
    ds_read_b128 v[24:27], v127 offset:8192
    ds_read_b64_tr_b16 v[28:29], v133 offset:29696
    ds_read_b64_tr_b16 v[30:31], v133 offset:30464
    s_waitcnt lgkmcnt(12)
    v_mfma_f32_32x32x16_bf16 v[88:103], v[40:43], v[48:51], v[88:103]
    ds_read_b64_tr_b16 v[32:33], v133 offset:29760
    ds_read_b64_tr_b16 v[34:35], v133 offset:30528
    s_waitcnt lgkmcnt(12)
    v_mfma_f32_32x32x16_bf16 v[104:119], v[40:43], v[52:55], v[104:119]
    ds_read_b64_tr_b16 v[36:37], v133 offset:29824
    ds_read_b64_tr_b16 v[38:39], v133 offset:30592
    s_waitcnt vmcnt(3)
    s_barrier
    s_waitcnt lgkmcnt(11)
    v_mfma_f32_32x32x16_bf16 v[72:87], v[56:59], v[60:63], v[72:87]
    ds_read_b128 v[40:43], v124 offset:32768
    ds_read_b64_tr_b16 v[44:45], v133 offset:45056
    ds_read_b64_tr_b16 v[46:47], v133 offset:45824
    s_waitcnt lgkmcnt(12)
    v_mfma_f32_32x32x16_bf16 v[88:103], v[56:59], v[64:67], v[88:103]
    ds_read_b64_tr_b16 v[48:49], v133 offset:45120
    ds_read_b64_tr_b16 v[50:51], v133 offset:45888
    s_waitcnt lgkmcnt(12)
    v_mfma_f32_32x32x16_bf16 v[104:119], v[56:59], v[68:71], v[104:119]
    ds_read_b64_tr_b16 v[52:53], v133 offset:45184
    ds_read_b64_tr_b16 v[54:55], v133 offset:45952
    s_waitcnt lgkmcnt(11)
    v_mfma_f32_32x32x16_bf16 v[72:87], v[24:27], v[28:31], v[72:87]
    ds_read_b128 v[56:59], v125 offset:32768
    ds_read_b64_tr_b16 v[60:61], v133 offset:48128
    ds_read_b64_tr_b16 v[62:63], v133 offset:48896
    s_waitcnt lgkmcnt(12)
    v_mfma_f32_32x32x16_bf16 v[88:103], v[24:27], v[32:35], v[88:103]
    ds_read_b64_tr_b16 v[64:65], v133 offset:48192
    ds_read_b64_tr_b16 v[66:67], v133 offset:48960
    s_waitcnt lgkmcnt(12)
    v_mfma_f32_32x32x16_bf16 v[104:119], v[24:27], v[36:39], v[104:119]
    ds_read_b64_tr_b16 v[68:69], v133 offset:48256
    ds_read_b64_tr_b16 v[70:71], v133 offset:49024
    s_waitcnt lgkmcnt(11)
    v_mfma_f32_32x32x16_bf16 v[72:87], v[40:43], v[44:47], v[72:87]
    ds_read_b128 v[24:27], v126 offset:32768
    ds_read_b64_tr_b16 v[28:29], v133 offset:51200
    ds_read_b64_tr_b16 v[30:31], v133 offset:51968
    s_waitcnt lgkmcnt(12)
    v_mfma_f32_32x32x16_bf16 v[88:103], v[40:43], v[48:51], v[88:103]
    ds_read_b64_tr_b16 v[32:33], v133 offset:51264
    ds_read_b64_tr_b16 v[34:35], v133 offset:52032
    s_waitcnt lgkmcnt(12)
    v_mfma_f32_32x32x16_bf16 v[104:119], v[40:43], v[52:55], v[104:119]
    ds_read_b64_tr_b16 v[36:37], v133 offset:51328
    ds_read_b64_tr_b16 v[38:39], v133 offset:52096
    s_waitcnt lgkmcnt(11)
    v_mfma_f32_32x32x16_bf16 v[72:87], v[56:59], v[60:63], v[72:87]
    ds_read_b128 v[40:43], v127 offset:32768
    ds_read_b64_tr_b16 v[44:45], v133 offset:54272
    ds_read_b64_tr_b16 v[46:47], v133 offset:55040
    s_waitcnt lgkmcnt(12)
    v_mfma_f32_32x32x16_bf16 v[88:103], v[56:59], v[64:67], v[88:103]
    ds_read_b64_tr_b16 v[48:49], v133 offset:54336
    ds_read_b64_tr_b16 v[50:51], v133 offset:55104
    s_waitcnt lgkmcnt(12)
    v_mfma_f32_32x32x16_bf16 v[104:119], v[56:59], v[68:71], v[104:119]
    ds_read_b64_tr_b16 v[52:53], v133 offset:54400
    ds_read_b64_tr_b16 v[54:55], v133 offset:55168
    s_waitcnt vmcnt(0)
    s_barrier
    s_waitcnt lgkmcnt(11)
    v_mfma_f32_32x32x16_bf16 v[72:87], v[24:27], v[28:31], v[72:87]
    ds_read_b128 v[148:151], v124 offset:57344
    ds_read_b64_tr_b16 v[152:153], v134 offset:4096
    ds_read_b64_tr_b16 v[154:155], v134 offset:4864
    s_waitcnt lgkmcnt(12)
    v_mfma_f32_32x32x16_bf16 v[88:103], v[24:27], v[32:35], v[88:103]
    ds_read_b64_tr_b16 v[156:157], v134 offset:4160
    ds_read_b64_tr_b16 v[158:159], v134 offset:4928
    s_waitcnt lgkmcnt(12)
    v_mfma_f32_32x32x16_bf16 v[104:119], v[24:27], v[36:39], v[104:119]
    ds_read_b64_tr_b16 v[160:161], v134 offset:4224
    ds_read_b64_tr_b16 v[162:163], v134 offset:4992
    s_waitcnt lgkmcnt(11)
    v_mfma_f32_32x32x16_bf16 v[72:87], v[40:43], v[44:47], v[72:87]
    ds_read_b128 v[164:167], v125 offset:57344
    ds_read_b64_tr_b16 v[168:169], v134 offset:7168
    ds_read_b64_tr_b16 v[170:171], v134 offset:7936
    s_waitcnt lgkmcnt(12)
    v_mfma_f32_32x32x16_bf16 v[88:103], v[40:43], v[48:51], v[88:103]
    ds_read_b64_tr_b16 v[172:173], v134 offset:7232
    ds_read_b64_tr_b16 v[174:175], v134 offset:8000
    s_waitcnt lgkmcnt(12)
    v_mfma_f32_32x32x16_bf16 v[104:119], v[40:43], v[52:55], v[104:119]
    ds_read_b64_tr_b16 v[176:177], v134 offset:7296
    ds_read_b64_tr_b16 v[178:179], v134 offset:8064
    ds_read_b128 v[180:183], v126 offset:57344
    ds_read_b64_tr_b16 v[184:185], v134 offset:10240
    ds_read_b64_tr_b16 v[186:187], v134 offset:11008
    ds_read_b64_tr_b16 v[188:189], v134 offset:10304
    ds_read_b64_tr_b16 v[190:191], v134 offset:11072
    ds_read_b64_tr_b16 v[192:193], v134 offset:10368
    ds_read_b64_tr_b16 v[194:195], v134 offset:11136
    ds_read_b128 v[196:199], v127 offset:57344
    ds_read_b64_tr_b16 v[200:201], v134 offset:13312
    ds_read_b64_tr_b16 v[202:203], v134 offset:14080
    ds_read_b64_tr_b16 v[204:205], v134 offset:13376
    ds_read_b64_tr_b16 v[206:207], v134 offset:14144
    ds_read_b64_tr_b16 v[208:209], v134 offset:13440
    ds_read_b64_tr_b16 v[210:211], v134 offset:14208
    s_mul_i32 s25, s21, 24
    s_mul_i32 s60, s23, 3
    s_add_u32 s25, s25, s60
    s_mul_i32 s25, s25, 48*1024
    s_mul_i32 s60, s22, 3
    s_add_u32 s60, s60, s20
    s_lshl_b32 s60, s60, 11
    s_add_u32 s25, s25, s60
    s_add_u32 s25, s25, 4194304
    s_waitcnt lgkmcnt(15)
    v_mfma_f32_32x32x16_bf16 v[72:87], v[148:151], v[152:155], v[72:87]
    v_mfma_f32_32x32x16_bf16 v[72:87], v[164:167], v[168:171], v[72:87]
    s_waitcnt lgkmcnt(11)
    v_mfma_f32_32x32x16_bf16 v[72:87], v[180:183], v[184:187], v[72:87]
    s_waitcnt lgkmcnt(4)
    v_mfma_f32_32x32x16_bf16 v[72:87], v[196:199], v[200:203], v[72:87]
    v_mfma_f32_32x32x16_bf16 v[88:103], v[148:151], v[156:159], v[88:103]
    v_mfma_f32_32x32x16_bf16 v[88:103], v[164:167], v[172:175], v[88:103]
    s_nop 1
    v_cvt_pk_bf16_f32 v24, v72, v73
    v_cvt_pk_bf16_f32 v25, v74, v75
    v_cvt_pk_bf16_f32 v26, v76, v77
    v_cvt_pk_bf16_f32 v27, v78, v79
    v_mfma_f32_32x32x16_bf16 v[88:103], v[180:183], v[188:191], v[88:103]
    buffer_store_dwordx4 v[24:27], v254, s[16:19], s25 offen offset:0 sc1
    v_cvt_pk_bf16_f32 v28, v80, v81
    v_cvt_pk_bf16_f32 v29, v82, v83
    v_cvt_pk_bf16_f32 v30, v84, v85
    s_waitcnt lgkmcnt(2)
    v_mfma_f32_32x32x16_bf16 v[88:103], v[196:199], v[204:207], v[88:103]
    v_cvt_pk_bf16_f32 v31, v86, v87
    buffer_store_dwordx4 v[28:31], v254, s[16:19], s25 offen offset:1024 sc1
    s_add_u32 s25, s25, 49152
    v_mfma_f32_32x32x16_bf16 v[104:119], v[148:151], v[160:163], v[104:119]
    v_mfma_f32_32x32x16_bf16 v[104:119], v[164:167], v[176:179], v[104:119]
    s_nop 1
    v_cvt_pk_bf16_f32 v32, v88, v89
    v_cvt_pk_bf16_f32 v33, v90, v91
    v_cvt_pk_bf16_f32 v34, v92, v93
    v_cvt_pk_bf16_f32 v35, v94, v95
    v_mfma_f32_32x32x16_bf16 v[104:119], v[180:183], v[192:195], v[104:119]
    buffer_store_dwordx4 v[32:35], v254, s[16:19], s25 offen offset:0 sc1
    v_cvt_pk_bf16_f32 v36, v96, v97
    v_cvt_pk_bf16_f32 v37, v98, v99
    v_cvt_pk_bf16_f32 v38, v100, v101
    s_waitcnt lgkmcnt(0)
    v_mfma_f32_32x32x16_bf16 v[104:119], v[196:199], v[208:211], v[104:119]
    v_cvt_pk_bf16_f32 v39, v102, v103
    buffer_store_dwordx4 v[36:39], v254, s[16:19], s25 offen offset:1024 sc1
    s_add_u32 s25, s25, 49152
    v_readfirstlane_b32 s60, v251
    s_nop 3
    s_and_b32 s60, s60, 0xfffffffc
    s_add_u32 s37, s60, 5
    s_nop 7
    s_nop 3
    v_cvt_pk_bf16_f32 v40, v104, v105
    v_cvt_pk_bf16_f32 v41, v106, v107
    v_cvt_pk_bf16_f32 v42, v108, v109
    v_cvt_pk_bf16_f32 v43, v110, v111
    buffer_store_dwordx4 v[40:43], v254, s[16:19], s25 offen offset:0 sc1
    v_cvt_pk_bf16_f32 v44, v112, v113
    v_cvt_pk_bf16_f32 v45, v114, v115
    v_cvt_pk_bf16_f32 v46, v116, v117
    v_cvt_pk_bf16_f32 v47, v118, v119
    buffer_store_dwordx4 v[44:47], v254, s[16:19], s25 offen offset:1024 sc1
    s_add_u32 s25, s25, 49152
    s_waitcnt vmcnt(0)
    s_branch w_join_9
w_wave3_8:
    s_cmp_eq_u32 s20, 3
    s_cbranch_scc0 cpf_10
    s_getpc_b64 s[60:61]
cpf_pc_11:
    s_sub_u32 s60, s60, cpf_pc_11-standalone__dit_adaln_block__diffusion_kernel
    s_subb_u32 s61, s61, 0
    s_lshl_b32 s62, s33, 12
    s_add_u32 s62, s62, 0
    v_lshlrev_b32 v228, 6, v255
    v_add_u32 v228, s62, v228
    v_min_u32 v228, (L_codeend-standalone__dit_adaln_block__diffusion_kernel)-64, v228
    v_mov_b32 v229, s61
    v_add_co_u32 v228, vcc, s60, v228
    v_addc_co_u32 v229, vcc, 0, v229, vcc
    global_load_dword v230, v[228:229], off
cpf_10:
    s_waitcnt vmcnt(7)
    s_barrier
    s_lshl_b32 s28, s24, 7
    s_add_u32 s28, s28, s25
    s_add_u32 m0, s27, 49152
    s_nop 0
    buffer_load_dwordx4 v6, s[8:11], s28 offen offset:0 lds
    buffer_load_dwordx4 v7, s[8:11], s28 offen offset:1024 lds
    buffer_load_dwordx4 v8, s[8:11], s28 offen offset:2048 lds
    s_mul_i32 s29, s24, 98304
    s_add_u32 s29, s29, s26
    s_sub_u32 s29, s29, 73728
    s_mov_b32 m0, 61440
    s_nop 0
    buffer_load_dwordx4 v9, s[12:15], s29 offen offset:0 lds
    buffer_load_dwordx4 v10, s[12:15], s29 offen offset:1024 lds
    buffer_load_dwordx4 v11, s[12:15], s29 offen offset:2048 lds
    s_add_u32 s29, s29, 24576
    s_mov_b32 m0, 64512
    s_nop 0
    buffer_load_dwordx4 v9, s[12:15], s29 offen offset:0 lds
    buffer_load_dwordx4 v10, s[12:15], s29 offen offset:1024 lds
    buffer_load_dwordx4 v11, s[12:15], s29 offen offset:2048 lds
    s_add_u32 s29, s29, 24576
    s_mov_b32 m0, 67584
    s_nop 0
    buffer_load_dwordx4 v9, s[12:15], s29 offen offset:0 lds
    buffer_load_dwordx4 v10, s[12:15], s29 offen offset:1024 lds
    buffer_load_dwordx4 v11, s[12:15], s29 offen offset:2048 lds
    s_add_u32 s29, s29, 24576
    s_mov_b32 m0, 70656
    s_nop 0
    buffer_load_dwordx4 v9, s[12:15], s29 offen offset:0 lds
    buffer_load_dwordx4 v10, s[12:15], s29 offen offset:1024 lds
    buffer_load_dwordx4 v11, s[12:15], s29 offen offset:2048 lds
    s_add_u32 s24, s24, 1
    s_cmp_eq_u32 s24, 12
    s_cselect_b32 s24, 0, s24
    s_waitcnt vmcnt(16)
    s_barrier
    s_lshl_b32 s28, s24, 7
    s_add_u32 s28, s28, s25
    s_add_u32 m0, s27, 73728
    s_nop 0
    buffer_load_dwordx4 v6, s[8:11], s28 offen offset:0 lds
    buffer_load_dwordx4 v7, s[8:11], s28 offen offset:1024 lds
    buffer_load_dwordx4 v8, s[8:11], s28 offen offset:2048 lds
    s_mul_i32 s29, s24, 98304
    s_add_u32 s29, s29, s26
    s_sub_u32 s29, s29, 73728
    s_mov_b32 m0, 86016
    s_nop 0
    buffer_load_dwordx4 v9, s[12:15], s29 offen offset:0 lds
    buffer_load_dwordx4 v10, s[12:15], s29 offen offset:1024 lds
    buffer_load_dwordx4 v11, s[12:15], s29 offen offset:2048 lds
    s_add_u32 s29, s29, 24576
    s_mov_b32 m0, 89088
    s_nop 0
    buffer_load_dwordx4 v9, s[12:15], s29 offen offset:0 lds
    buffer_load_dwordx4 v10, s[12:15], s29 offen offset:1024 lds
    buffer_load_dwordx4 v11, s[12:15], s29 offen offset:2048 lds
    s_add_u32 s29, s29, 24576
    s_mov_b32 m0, 92160
    s_nop 0
    buffer_load_dwordx4 v9, s[12:15], s29 offen offset:0 lds
    buffer_load_dwordx4 v10, s[12:15], s29 offen offset:1024 lds
    buffer_load_dwordx4 v11, s[12:15], s29 offen offset:2048 lds
    s_add_u32 s29, s29, 24576
    s_mov_b32 m0, 95232
    s_nop 0
    buffer_load_dwordx4 v9, s[12:15], s29 offen offset:0 lds
    buffer_load_dwordx4 v10, s[12:15], s29 offen offset:1024 lds
    buffer_load_dwordx4 v11, s[12:15], s29 offen offset:2048 lds
    s_add_u32 s24, s24, 1
    s_cmp_eq_u32 s24, 12
    s_cselect_b32 s24, 0, s24
    s_waitcnt vmcnt(15)
    s_barrier
    s_lshl_b32 s28, s24, 7
    s_add_u32 s28, s28, s25
    s_add_u32 m0, s27, 98304
    s_nop 0
    buffer_load_dwordx4 v6, s[8:11], s28 offen offset:0 lds
    buffer_load_dwordx4 v7, s[8:11], s28 offen offset:1024 lds
    buffer_load_dwordx4 v8, s[8:11], s28 offen offset:2048 lds
    s_mul_i32 s29, s24, 98304
    s_add_u32 s29, s29, s26
    s_sub_u32 s29, s29, 73728
    s_mov_b32 m0, 110592
    s_nop 0
    buffer_load_dwordx4 v9, s[12:15], s29 offen offset:0 lds
    buffer_load_dwordx4 v10, s[12:15], s29 offen offset:1024 lds
    buffer_load_dwordx4 v11, s[12:15], s29 offen offset:2048 lds
    s_add_u32 s29, s29, 24576
    s_mov_b32 m0, 113664
    s_nop 0
    buffer_load_dwordx4 v9, s[12:15], s29 offen offset:0 lds
    buffer_load_dwordx4 v10, s[12:15], s29 offen offset:1024 lds
    buffer_load_dwordx4 v11, s[12:15], s29 offen offset:2048 lds
    s_add_u32 s29, s29, 24576
    s_mov_b32 m0, 116736
    s_nop 0
    buffer_load_dwordx4 v9, s[12:15], s29 offen offset:0 lds
    buffer_load_dwordx4 v10, s[12:15], s29 offen offset:1024 lds
    buffer_load_dwordx4 v11, s[12:15], s29 offen offset:2048 lds
    s_add_u32 s29, s29, 24576
    s_mov_b32 m0, 119808
    s_nop 0
    buffer_load_dwordx4 v9, s[12:15], s29 offen offset:0 lds
    buffer_load_dwordx4 v10, s[12:15], s29 offen offset:1024 lds
    buffer_load_dwordx4 v11, s[12:15], s29 offen offset:2048 lds
    s_add_u32 s24, s24, 1
    s_cmp_eq_u32 s24, 12
    s_cselect_b32 s24, 0, s24
    s_waitcnt vmcnt(15)
    s_barrier
    s_lshl_b32 s28, s24, 7
    s_add_u32 s28, s28, s25
    s_add_u32 m0, s27, 122880
    s_nop 0
    buffer_load_dwordx4 v6, s[8:11], s28 offen offset:0 lds
    buffer_load_dwordx4 v7, s[8:11], s28 offen offset:1024 lds
    buffer_load_dwordx4 v8, s[8:11], s28 offen offset:2048 lds
    s_mul_i32 s29, s24, 98304
    s_add_u32 s29, s29, s26
    s_sub_u32 s29, s29, 73728
    s_mov_b32 m0, 135168
    s_nop 0
    buffer_load_dwordx4 v9, s[12:15], s29 offen offset:0 lds
    buffer_load_dwordx4 v10, s[12:15], s29 offen offset:1024 lds
    buffer_load_dwordx4 v11, s[12:15], s29 offen offset:2048 lds
    s_add_u32 s29, s29, 24576
    s_mov_b32 m0, 138240
    s_nop 0
    buffer_load_dwordx4 v9, s[12:15], s29 offen offset:0 lds
    buffer_load_dwordx4 v10, s[12:15], s29 offen offset:1024 lds
    buffer_load_dwordx4 v11, s[12:15], s29 offen offset:2048 lds
    s_add_u32 s29, s29, 24576
    s_mov_b32 m0, 141312
    s_nop 0
    buffer_load_dwordx4 v9, s[12:15], s29 offen offset:0 lds
    buffer_load_dwordx4 v10, s[12:15], s29 offen offset:1024 lds
    buffer_load_dwordx4 v11, s[12:15], s29 offen offset:2048 lds
    s_add_u32 s29, s29, 24576
    s_mov_b32 m0, 144384
    s_nop 0
    buffer_load_dwordx4 v9, s[12:15], s29 offen offset:0 lds
    buffer_load_dwordx4 v10, s[12:15], s29 offen offset:1024 lds
    buffer_load_dwordx4 v11, s[12:15], s29 offen offset:2048 lds
    s_add_u32 s24, s24, 1
    s_cmp_eq_u32 s24, 12
    s_cselect_b32 s24, 0, s24
    s_waitcnt vmcnt(15)
    s_barrier
    s_lshl_b32 s28, s24, 7
    s_add_u32 s28, s28, s25
    s_add_u32 m0, s27, 0
    s_nop 0
    buffer_load_dwordx4 v6, s[8:11], s28 offen offset:0 lds
    buffer_load_dwordx4 v7, s[8:11], s28 offen offset:1024 lds
    buffer_load_dwordx4 v8, s[8:11], s28 offen offset:2048 lds
    s_mul_i32 s29, s24, 98304
    s_add_u32 s29, s29, s26
    s_sub_u32 s29, s29, 73728
    s_mov_b32 m0, 12288
    s_nop 0
    buffer_load_dwordx4 v9, s[12:15], s29 offen offset:0 lds
    buffer_load_dwordx4 v10, s[12:15], s29 offen offset:1024 lds
    buffer_load_dwordx4 v11, s[12:15], s29 offen offset:2048 lds
    s_add_u32 s29, s29, 24576
    s_mov_b32 m0, 15360
    s_nop 0
    buffer_load_dwordx4 v9, s[12:15], s29 offen offset:0 lds
    buffer_load_dwordx4 v10, s[12:15], s29 offen offset:1024 lds
    buffer_load_dwordx4 v11, s[12:15], s29 offen offset:2048 lds
    s_add_u32 s29, s29, 24576
    s_mov_b32 m0, 18432
    s_nop 0
    buffer_load_dwordx4 v9, s[12:15], s29 offen offset:0 lds
    buffer_load_dwordx4 v10, s[12:15], s29 offen offset:1024 lds
    buffer_load_dwordx4 v11, s[12:15], s29 offen offset:2048 lds
    s_add_u32 s29, s29, 24576
    s_mov_b32 m0, 21504
    s_nop 0
    buffer_load_dwordx4 v9, s[12:15], s29 offen offset:0 lds
    buffer_load_dwordx4 v10, s[12:15], s29 offen offset:1024 lds
    buffer_load_dwordx4 v11, s[12:15], s29 offen offset:2048 lds
    s_add_u32 s24, s24, 1
    s_cmp_eq_u32 s24, 12
    s_cselect_b32 s24, 0, s24
    s_waitcnt vmcnt(15)
    s_barrier
    s_lshl_b32 s28, s24, 7
    s_add_u32 s28, s28, s25
    s_add_u32 m0, s27, 24576
    s_nop 0
    buffer_load_dwordx4 v6, s[8:11], s28 offen offset:0 lds
    buffer_load_dwordx4 v7, s[8:11], s28 offen offset:1024 lds
    buffer_load_dwordx4 v8, s[8:11], s28 offen offset:2048 lds
    s_mul_i32 s29, s24, 98304
    s_add_u32 s29, s29, s26
    s_sub_u32 s29, s29, 73728
    s_mov_b32 m0, 36864
    s_nop 0
    buffer_load_dwordx4 v9, s[12:15], s29 offen offset:0 lds
    buffer_load_dwordx4 v10, s[12:15], s29 offen offset:1024 lds
    buffer_load_dwordx4 v11, s[12:15], s29 offen offset:2048 lds
    s_add_u32 s29, s29, 24576
    s_mov_b32 m0, 39936
    s_nop 0
    buffer_load_dwordx4 v9, s[12:15], s29 offen offset:0 lds
    buffer_load_dwordx4 v10, s[12:15], s29 offen offset:1024 lds
    buffer_load_dwordx4 v11, s[12:15], s29 offen offset:2048 lds
    s_add_u32 s29, s29, 24576
    s_mov_b32 m0, 43008
    s_nop 0
    buffer_load_dwordx4 v9, s[12:15], s29 offen offset:0 lds
    buffer_load_dwordx4 v10, s[12:15], s29 offen offset:1024 lds
    buffer_load_dwordx4 v11, s[12:15], s29 offen offset:2048 lds
    s_add_u32 s29, s29, 24576
    s_mov_b32 m0, 46080
    s_nop 0
    buffer_load_dwordx4 v9, s[12:15], s29 offen offset:0 lds
    buffer_load_dwordx4 v10, s[12:15], s29 offen offset:1024 lds
    buffer_load_dwordx4 v11, s[12:15], s29 offen offset:2048 lds
    s_add_u32 s24, s24, 1
    s_cmp_eq_u32 s24, 12
    s_cselect_b32 s24, 0, s24
    s_waitcnt vmcnt(15)
    s_barrier
    s_lshl_b32 s28, s24, 7
    s_add_u32 s28, s28, s25
    s_add_u32 m0, s27, 49152
    s_nop 0
    buffer_load_dwordx4 v6, s[8:11], s28 offen offset:0 lds
    buffer_load_dwordx4 v7, s[8:11], s28 offen offset:1024 lds
    buffer_load_dwordx4 v8, s[8:11], s28 offen offset:2048 lds
    s_mul_i32 s29, s24, 98304
    s_add_u32 s29, s29, s26
    s_sub_u32 s29, s29, 73728
    s_mov_b32 m0, 61440
    s_nop 0
    buffer_load_dwordx4 v9, s[12:15], s29 offen offset:0 lds
    buffer_load_dwordx4 v10, s[12:15], s29 offen offset:1024 lds
    buffer_load_dwordx4 v11, s[12:15], s29 offen offset:2048 lds
    s_add_u32 s29, s29, 24576
    s_mov_b32 m0, 64512
    s_nop 0
    buffer_load_dwordx4 v9, s[12:15], s29 offen offset:0 lds
    buffer_load_dwordx4 v10, s[12:15], s29 offen offset:1024 lds
    buffer_load_dwordx4 v11, s[12:15], s29 offen offset:2048 lds
    s_add_u32 s29, s29, 24576
    s_mov_b32 m0, 67584
    s_nop 0
    buffer_load_dwordx4 v9, s[12:15], s29 offen offset:0 lds
    buffer_load_dwordx4 v10, s[12:15], s29 offen offset:1024 lds
    buffer_load_dwordx4 v11, s[12:15], s29 offen offset:2048 lds
    s_add_u32 s29, s29, 24576
    s_mov_b32 m0, 70656
    s_nop 0
    buffer_load_dwordx4 v9, s[12:15], s29 offen offset:0 lds
    buffer_load_dwordx4 v10, s[12:15], s29 offen offset:1024 lds
    buffer_load_dwordx4 v11, s[12:15], s29 offen offset:2048 lds
    s_add_u32 s24, s24, 1
    s_cmp_eq_u32 s24, 12
    s_cselect_b32 s24, 0, s24
    s_waitcnt vmcnt(15)
    s_barrier
    s_lshl_b32 s28, s24, 7
    s_add_u32 s28, s28, s25
    s_add_u32 m0, s27, 73728
    s_nop 0
    buffer_load_dwordx4 v6, s[8:11], s28 offen offset:0 lds
    buffer_load_dwordx4 v7, s[8:11], s28 offen offset:1024 lds
    buffer_load_dwordx4 v8, s[8:11], s28 offen offset:2048 lds
    s_mul_i32 s29, s24, 98304
    s_add_u32 s29, s29, s26
    s_sub_u32 s29, s29, 73728
    s_mov_b32 m0, 86016
    s_nop 0
    buffer_load_dwordx4 v9, s[12:15], s29 offen offset:0 lds
    buffer_load_dwordx4 v10, s[12:15], s29 offen offset:1024 lds
    buffer_load_dwordx4 v11, s[12:15], s29 offen offset:2048 lds
    s_add_u32 s29, s29, 24576
    s_mov_b32 m0, 89088
    s_nop 0
    buffer_load_dwordx4 v9, s[12:15], s29 offen offset:0 lds
    buffer_load_dwordx4 v10, s[12:15], s29 offen offset:1024 lds
    buffer_load_dwordx4 v11, s[12:15], s29 offen offset:2048 lds
    s_add_u32 s29, s29, 24576
    s_mov_b32 m0, 92160
    s_nop 0
    buffer_load_dwordx4 v9, s[12:15], s29 offen offset:0 lds
    buffer_load_dwordx4 v10, s[12:15], s29 offen offset:1024 lds
    buffer_load_dwordx4 v11, s[12:15], s29 offen offset:2048 lds
    s_add_u32 s29, s29, 24576
    s_mov_b32 m0, 95232
    s_nop 0
    buffer_load_dwordx4 v9, s[12:15], s29 offen offset:0 lds
    buffer_load_dwordx4 v10, s[12:15], s29 offen offset:1024 lds
    buffer_load_dwordx4 v11, s[12:15], s29 offen offset:2048 lds
    s_add_u32 s24, s24, 1
    s_cmp_eq_u32 s24, 12
    s_cselect_b32 s24, 0, s24
    s_waitcnt vmcnt(15)
    s_barrier
    s_lshl_b32 s28, s24, 7
    s_add_u32 s28, s28, s25
    s_add_u32 m0, s27, 98304
    s_nop 0
    buffer_load_dwordx4 v6, s[8:11], s28 offen offset:0 lds
    buffer_load_dwordx4 v7, s[8:11], s28 offen offset:1024 lds
    buffer_load_dwordx4 v8, s[8:11], s28 offen offset:2048 lds
    s_mul_i32 s29, s24, 98304
    s_add_u32 s29, s29, s26
    s_sub_u32 s29, s29, 73728
    s_mov_b32 m0, 110592
    s_nop 0
    buffer_load_dwordx4 v9, s[12:15], s29 offen offset:0 lds
    buffer_load_dwordx4 v10, s[12:15], s29 offen offset:1024 lds
    buffer_load_dwordx4 v11, s[12:15], s29 offen offset:2048 lds
    s_add_u32 s29, s29, 24576
    s_mov_b32 m0, 113664
    s_nop 0
    buffer_load_dwordx4 v9, s[12:15], s29 offen offset:0 lds
    buffer_load_dwordx4 v10, s[12:15], s29 offen offset:1024 lds
    buffer_load_dwordx4 v11, s[12:15], s29 offen offset:2048 lds
    s_add_u32 s29, s29, 24576
    s_mov_b32 m0, 116736
    s_nop 0
    buffer_load_dwordx4 v9, s[12:15], s29 offen offset:0 lds
    buffer_load_dwordx4 v10, s[12:15], s29 offen offset:1024 lds
    buffer_load_dwordx4 v11, s[12:15], s29 offen offset:2048 lds
    s_add_u32 s29, s29, 24576
    s_mov_b32 m0, 119808
    s_nop 0
    buffer_load_dwordx4 v9, s[12:15], s29 offen offset:0 lds
    buffer_load_dwordx4 v10, s[12:15], s29 offen offset:1024 lds
    buffer_load_dwordx4 v11, s[12:15], s29 offen offset:2048 lds
    s_add_u32 s24, s24, 1
    s_cmp_eq_u32 s24, 12
    s_cselect_b32 s24, 0, s24
    s_waitcnt vmcnt(15)
    s_barrier
    s_lshl_b32 s28, s24, 7
    s_add_u32 s28, s28, s25
    s_add_u32 m0, s27, 122880
    s_nop 0
    buffer_load_dwordx4 v6, s[8:11], s28 offen offset:0 lds
    buffer_load_dwordx4 v7, s[8:11], s28 offen offset:1024 lds
    buffer_load_dwordx4 v8, s[8:11], s28 offen offset:2048 lds
    s_mul_i32 s29, s24, 98304
    s_add_u32 s29, s29, s26
    s_sub_u32 s29, s29, 73728
    s_mov_b32 m0, 135168
    s_nop 0
    buffer_load_dwordx4 v9, s[12:15], s29 offen offset:0 lds
    buffer_load_dwordx4 v10, s[12:15], s29 offen offset:1024 lds
    buffer_load_dwordx4 v11, s[12:15], s29 offen offset:2048 lds
    s_add_u32 s29, s29, 24576
    s_mov_b32 m0, 138240
    s_nop 0
    buffer_load_dwordx4 v9, s[12:15], s29 offen offset:0 lds
    buffer_load_dwordx4 v10, s[12:15], s29 offen offset:1024 lds
    buffer_load_dwordx4 v11, s[12:15], s29 offen offset:2048 lds
    s_add_u32 s29, s29, 24576
    s_mov_b32 m0, 141312
    s_nop 0
    buffer_load_dwordx4 v9, s[12:15], s29 offen offset:0 lds
    buffer_load_dwordx4 v10, s[12:15], s29 offen offset:1024 lds
    buffer_load_dwordx4 v11, s[12:15], s29 offen offset:2048 lds
    s_add_u32 s29, s29, 24576
    s_mov_b32 m0, 144384
    s_nop 0
    buffer_load_dwordx4 v9, s[12:15], s29 offen offset:0 lds
    buffer_load_dwordx4 v10, s[12:15], s29 offen offset:1024 lds
    buffer_load_dwordx4 v11, s[12:15], s29 offen offset:2048 lds
    s_add_u32 s24, s24, 1
    s_cmp_eq_u32 s24, 12
    s_cselect_b32 s24, 0, s24
    s_waitcnt vmcnt(15)
    s_barrier
    s_waitcnt vmcnt(0)
    s_barrier
    v_readfirstlane_b32 s60, v251
    s_nop 3
    s_and_b32 s60, s60, 0xfffffffc
    s_add_u32 s37, s60, 5
    s_waitcnt vmcnt(0)
w_join_9:
    s_lshl_b32 s60, s21, 3
    s_add_u32 s60, s60, s23
    s_mul_i32 s60, s60, 1024
    s_lshl_b32 s61, s22, 2
    s_add_u32 s60, s60, s61
    s_add_u32 s64, s60, 18890752
    s_barrier
    s_cmp_eq_u32 s20, 1
    s_cbranch_scc0 pub_skip_12
    v_mov_b32 v1, s37
    v_lshlrev_b32 v2, 7, v255
    s_mov_b64 s[62:63], exec
    s_mov_b64 exec, 255
    buffer_store_dword v1, v2, s[16:19], s64 offen sc1
    s_mov_b64 exec, s[62:63]
pub_skip_12:
    s_branch L_phaseB
L_mh:
    s_sub_u32 s39, s33, 16
    s_lshl_b32 s38, s32, 4
    s_add_u32 s38, s38, s39
    v_and_b32 v240, 15, v0
    v_lshrrev_b32 v241, 4, v0
    s_mul_i32 s28, s38, 16*1536
    v_mul_u32_u24 v242, 1536, v240
    v_lshlrev_b32 v243, 4, v241
    v_add_u32 v242, v242, v243
    s_cmp_lt_u32 s39, 12
    s_cbranch_scc0 mh_notu
    s_mul_i32 s30, s32, 6
    s_lshr_b32 s60, s39, 1
    s_add_u32 s30, s30, s60
    s_and_b32 s31, s39, 1
    s_mul_i32 s31, s31, 384
    v_lshrrev_b32 v26, 2, v255
    v_mul_u32_u24 v26, 9216, v26
    v_and_b32 v27, 3, v255
    v_lshlrev_b32 v27, 4, v27
    v_add_u32 v26, v26, v27
    s_mul_i32 s22, s20, 96
    s_add_u32 s22, s22, s31
    s_mul_i32 s22, s22, 9216
    s_lshl_b32 s60, s30, 6
    s_add_u32 s22, s22, s60
    s_mul_i32 s23, s20, 6144
    v_and_b32 v247, 127, v0
    v_mul_u32_u24 v247, 12, v247
    v_lshrrev_b32 v4, 7, v0
    v_mul_u32_u24 v4, 1536, v4
    v_add_u32 v247, v247, v4
    buffer_load_dwordx3 v[244:246], v247, s[44:47], 0 offen
    s_mov_b32 m0, s23
    s_add_u32 s23, s23, 1024
    buffer_load_dwordx4 v26, s[40:43], s22 offen nt lds
    s_add_u32 s22, s22, 147456
    s_mov_b32 m0, s23
    s_add_u32 s23, s23, 1024
    buffer_load_dwordx4 v26, s[40:43], s22 offen nt lds
    s_add_u32 s22, s22, 147456
    s_mov_b32 m0, s23
    s_add_u32 s23, s23, 1024
    buffer_load_dwordx4 v26, s[40:43], s22 offen nt lds
    s_add_u32 s22, s22, 147456
    s_mov_b32 m0, s23
    s_add_u32 s23, s23, 1024
    buffer_load_dwordx4 v26, s[40:43], s22 offen nt lds
    s_add_u32 s22, s22, 147456
    s_mov_b32 m0, s23
    s_add_u32 s23, s23, 1024
    buffer_load_dwordx4 v26, s[40:43], s22 offen nt lds
    s_add_u32 s22, s22, 147456
    s_mov_b32 m0, s23
    s_add_u32 s23, s23, 1024
    buffer_load_dwordx4 v26, s[40:43], s22 offen nt lds
    s_add_u32 s22, s22, 147456
    s_waitcnt vmcnt(6)
    v_lshlrev_b32 v12, 16, v244
    v_and_b32 v13, 0xffff0000, v244
    v_lshlrev_b32 v14, 16, v245
    v_and_b32 v15, 0xffff0000, v245
    v_lshlrev_b32 v16, 16, v246
    v_and_b32 v17, 0xffff0000, v246
    s_mov_b32 s24, 0xbfb8aa3b
    v_mul_f32 v20, s24, v12
    v_mul_f32 v21, s24, v13
    v_mul_f32 v22, s24, v14
    v_mul_f32 v23, s24, v15
    v_mul_f32 v24, s24, v16
    v_mul_f32 v25, s24, v17
    v_exp_f32 v20, v20
    v_exp_f32 v21, v21
    v_exp_f32 v22, v22
    v_exp_f32 v23, v23
    v_exp_f32 v24, v24
    v_exp_f32 v25, v25
    s_nop 0
    v_add_f32 v20, 1.0, v20
    v_add_f32 v21, 1.0, v21
    v_add_f32 v22, 1.0, v22
    v_add_f32 v23, 1.0, v23
    v_add_f32 v24, 1.0, v24
    v_add_f32 v25, 1.0, v25
    v_rcp_f32 v20, v20
    v_rcp_f32 v21, v21
    v_rcp_f32 v22, v22
    v_rcp_f32 v23, v23
    v_rcp_f32 v24, v24
    v_rcp_f32 v25, v25
    s_nop 0
    v_mul_f32 v20, v20, v12
    v_mul_f32 v21, v21, v13
    v_mul_f32 v22, v22, v14
    v_mul_f32 v23, v23, v15
    v_mul_f32 v24, v24, v16
    v_mul_f32 v25, v25, v17
    v_cvt_pk_bf16_f32 v28, v20, v21
    v_cvt_pk_bf16_f32 v29, v22, v23
    v_cvt_pk_bf16_f32 v30, v24, v25
    v_add_u32 v3, 49152, v247
    ds_write_b32 v3, v28 offset:0
    ds_write_b32 v3, v29 offset:4
    ds_write_b32 v3, v30 offset:8
    v_lshrrev_b32 v4, 4, v255
    v_and_b32 v5, 1, v255
    v_mul_u32_u24 v5, 1536, v5
    v_lshlrev_b32 v6, 4, v4
    v_add_u32 v5, v5, v6
    s_mul_i32 s24, s20, 96
    s_add_u32 s24, s24, s31
    s_lshl_b32 s24, s24, 1
    s_add_u32 s24, s24, 49152
    v_add_u32 v5, s24, v5
    v_and_b32 v6, 15, v255
    v_lshrrev_b32 v6, 2, v6
    v_lshlrev_b32 v7, 3, v4
    v_add_u32 v6, v6, v7
    v_lshlrev_b32 v6, 6, v6
    v_and_b32 v7, 3, v255
    v_lshlrev_b32 v7, 3, v7
    v_add_u32 v6, v6, v7
    s_mul_i32 s24, s20, 6144
    v_add_u32 v6, s24, v6
    v_and_b32 v17, 15, v255
    v_lshlrev_b32 v17, 3, v17
    s_lshl_b32 s24, s20, 8
    s_add_u32 s24, s24, 52224
    v_add_u32 v17, s24, v17
    v_and_b32 v18, 31, v255
    v_lshrrev_b32 v19, 5, v255
    v_lshrrev_b32 v29, 4, v18
    v_lshlrev_b32 v29, 7, v29
    v_and_b32 v30, 15, v18
    v_lshlrev_b32 v30, 3, v30
    v_lshlrev_b32 v31, 2, v19
    v_add3_u32 v29, v29, v30, v31
    v_add_u32 v29, 52224, v29
    v_mul_u32_u24 v19, 2304*8, v19
    v_lshlrev_b32 v18, 3, v18
    v_add_u32 v18, v19, v18
    s_lshl_b32 s25, s30, 8
    s_add_u32 s25, s25, 131072
    s_cmp_eq_u32 s31, 0
    s_cselect_b32 s60, 0, 36864
    s_add_u32 s25, s25, s60
    s_sub_u32 s29, s30, 24
    s_add_u32 s29, s29, s31
    s_cmp_lt_u32 s29, 24
    s_cselect_b32 s29, 1.0, 0
    v_readfirstlane_b32 s60, v251
    s_nop 3
    s_and_b32 s60, s60, 0xfffffffc
    s_add_u32 s37, s60, 5
    s_waitcnt vmcnt(0)
    buffer_load_dwordx4 v[176:179], v242, s[4:7], s28 offen offset:0
    buffer_load_dwordx4 v[180:183], v242, s[4:7], s28 offen offset:256
    buffer_load_dwordx4 v[184:187], v242, s[4:7], s28 offen offset:512
    buffer_load_dwordx4 v[188:191], v242, s[4:7], s28 offen offset:768
    buffer_load_dwordx4 v[192:195], v242, s[4:7], s28 offen offset:1024
    buffer_load_dwordx4 v[196:199], v242, s[4:7], s28 offen offset:1280
    s_waitcnt lgkmcnt(0)
    s_barrier
    ds_read_b128 v[128:131], v5 offset:0
    ds_read_b64_tr_b16 v[132:133], v6 offset:0
    ds_read_b64_tr_b16 v[134:135], v6 offset:256
    ds_read_b64_tr_b16 v[136:137], v6 offset:32
    ds_read_b64_tr_b16 v[138:139], v6 offset:288
    ds_read_b128 v[140:143], v5 offset:64
    ds_read_b64_tr_b16 v[144:145], v6 offset:2048
    ds_read_b64_tr_b16 v[146:147], v6 offset:2304
    ds_read_b64_tr_b16 v[148:149], v6 offset:2080
    ds_read_b64_tr_b16 v[150:151], v6 offset:2336
    ds_read_b128 v[152:155], v5 offset:128
    ds_read_b64_tr_b16 v[156:157], v6 offset:4096
    ds_read_b64_tr_b16 v[158:159], v6 offset:4352
    ds_read_b64_tr_b16 v[160:161], v6 offset:4128
    ds_read_b64_tr_b16 v[162:163], v6 offset:4384
    s_waitcnt lgkmcnt(10)
    v_mfma_f32_16x16x32_bf16 v[32:35], v[128:131], v[132:135], 0
    v_mfma_f32_16x16x32_bf16 v[36:39], v[128:131], v[136:139], 0
    s_waitcnt lgkmcnt(5)
    v_mfma_f32_16x16x32_bf16 v[32:35], v[140:143], v[144:147], v[32:35]
    v_mfma_f32_16x16x32_bf16 v[36:39], v[140:143], v[148:151], v[36:39]
    s_waitcnt lgkmcnt(0)
    v_mfma_f32_16x16x32_bf16 v[32:35], v[152:155], v[156:159], v[32:35]
    v_mfma_f32_16x16x32_bf16 v[36:39], v[152:155], v[160:163], v[36:39]
    s_nop 0
    s_mov_b64 exec, 0xffff
    s_nop 6
    ds_write_b64 v17, v[32:33]
    ds_write_b64 v17, v[36:37] offset:128
    s_mov_b64 exec, -1
    s_waitcnt lgkmcnt(0)
    s_barrier
    s_cmp_eq_u32 s20, 0
    s_cbranch_scc0 mt_skip_13
    ds_read_b32 v12, v29 offset:0
    ds_read_b32 v13, v29 offset:256
    ds_read_b32 v14, v29 offset:512
    ds_read_b32 v15, v29 offset:768
    v_mov_b32 v21, s37
    s_waitcnt lgkmcnt(0)
    v_add_f32 v12, v12, v13
    v_add_f32 v14, v14, v15
    v_add_f32 v12, v12, v14
    v_add_f32 v20, s29, v12
    buffer_store_dwordx2 v[20:21], v18, s[16:19], s25 offen sc1
    s_waitcnt vmcnt(1)
    s_branch mt_done_14
mt_skip_13:
    s_waitcnt vmcnt(0)
mt_done_14:
    s_branch mh_ln
mh_notu:
    s_mul_i32 s30, s32, 3
    s_add_u32 s30, s30, s39
    s_add_u32 s30, s30, 36
    s_mov_b32 s31, 0
    buffer_load_dwordx4 v[176:179], v242, s[4:7], s28 offen offset:0
    buffer_load_dwordx4 v[180:183], v242, s[4:7], s28 offen offset:256
    buffer_load_dwordx4 v[184:187], v242, s[4:7], s28 offen offset:512
    buffer_load_dwordx4 v[188:191], v242, s[4:7], s28 offen offset:768
    buffer_load_dwordx4 v[192:195], v242, s[4:7], s28 offen offset:1024
    buffer_load_dwordx4 v[196:199], v242, s[4:7], s28 offen offset:1280
    s_cmp_eq_u32 s39, 15
    s_cbranch_scc1 mh_none
    s_waitcnt vmcnt(0)
    v_readfirstlane_b32 s60, v251
    s_nop 3
    s_and_b32 s60, s60, 0xfffffffc
    s_add_u32 s37, s60, 5
    v_lshrrev_b32 v26, 2, v255
    v_mul_u32_u24 v26, 9216, v26
    v_and_b32 v27, 3, v255
    v_lshlrev_b32 v27, 4, v27
    v_add_u32 v26, v26, v27
    s_mul_i32 s22, s20, 192
    s_add_u32 s22, s22, s31
    s_mul_i32 s22, s22, 9216
    s_lshl_b32 s60, s30, 6
    s_add_u32 s22, s22, s60
    s_mul_i32 s23, s20, 12288
    v_and_b32 v247, 127, v0
    v_mul_u32_u24 v247, 12, v247
    v_lshrrev_b32 v4, 7, v0
    v_mul_u32_u24 v4, 1536, v4
    v_add_u32 v247, v247, v4
    buffer_load_dwordx3 v[244:246], v247, s[44:47], 0 offen
    s_mov_b32 m0, s23
    s_add_u32 s23, s23, 1024
    buffer_load_dwordx4 v26, s[40:43], s22 offen nt lds
    s_add_u32 s22, s22, 147456
    s_mov_b32 m0, s23
    s_add_u32 s23, s23, 1024
    buffer_load_dwordx4 v26, s[40:43], s22 offen nt lds
    s_add_u32 s22, s22, 147456
    s_mov_b32 m0, s23
    s_add_u32 s23, s23, 1024
    buffer_load_dwordx4 v26, s[40:43], s22 offen nt lds
    s_add_u32 s22, s22, 147456
    s_mov_b32 m0, s23
    s_add_u32 s23, s23, 1024
    buffer_load_dwordx4 v26, s[40:43], s22 offen nt lds
    s_add_u32 s22, s22, 147456
    s_mov_b32 m0, s23
    s_add_u32 s23, s23, 1024
    buffer_load_dwordx4 v26, s[40:43], s22 offen nt lds
    s_add_u32 s22, s22, 147456
    s_mov_b32 m0, s23
    s_add_u32 s23, s23, 1024
    buffer_load_dwordx4 v26, s[40:43], s22 offen nt lds
    s_add_u32 s22, s22, 147456
    s_mov_b32 m0, s23
    s_add_u32 s23, s23, 1024
    buffer_load_dwordx4 v26, s[40:43], s22 offen nt lds
    s_add_u32 s22, s22, 147456
    s_mov_b32 m0, s23
    s_add_u32 s23, s23, 1024
    buffer_load_dwordx4 v26, s[40:43], s22 offen nt lds
    s_add_u32 s22, s22, 147456
    s_mov_b32 m0, s23
    s_add_u32 s23, s23, 1024
    buffer_load_dwordx4 v26, s[40:43], s22 offen nt lds
    s_add_u32 s22, s22, 147456
    s_mov_b32 m0, s23
    s_add_u32 s23, s23, 1024
    buffer_load_dwordx4 v26, s[40:43], s22 offen nt lds
    s_add_u32 s22, s22, 147456
    s_mov_b32 m0, s23
    s_add_u32 s23, s23, 1024
    buffer_load_dwordx4 v26, s[40:43], s22 offen nt lds
    s_add_u32 s22, s22, 147456
    s_mov_b32 m0, s23
    s_add_u32 s23, s23, 1024
    buffer_load_dwordx4 v26, s[40:43], s22 offen nt lds
    s_add_u32 s22, s22, 147456
    s_branch mh_ln
mh_none:
    s_waitcnt vmcnt(6)
    v_readfirstlane_b32 s60, v251
    s_nop 3
    s_and_b32 s60, s60, 0xfffffffc
    s_add_u32 s37, s60, 5
    s_waitcnt vmcnt(0)
mh_ln:
    s_mov_b32 s24, 0x3f803f80
    s_mov_b32 s25, 0xffff0000
    v_mov_b32 v20, 0
    v_mov_b32 v21, 0
    v_mov_b32 v22, 0
    v_mov_b32 v23, 0
    v_dot2c_f32_bf16 v20, s24, v176
    v_dot2c_f32_bf16 v21, v176, v176
    v_dot2c_f32_bf16 v22, s24, v177
    v_dot2c_f32_bf16 v23, v177, v177
    v_dot2c_f32_bf16 v20, s24, v178
    v_dot2c_f32_bf16 v21, v178, v178
    v_dot2c_f32_bf16 v22, s24, v179
    v_dot2c_f32_bf16 v23, v179, v179
    v_dot2c_f32_bf16 v20, s24, v180
    v_dot2c_f32_bf16 v21, v180, v180
    v_dot2c_f32_bf16 v22, s24, v181
    v_dot2c_f32_bf16 v23, v181, v181
    v_dot2c_f32_bf16 v20, s24, v182
    v_dot2c_f32_bf16 v21, v182, v182
    v_dot2c_f32_bf16 v22, s24, v183
    v_dot2c_f32_bf16 v23, v183, v183
    v_dot2c_f32_bf16 v20, s24, v184
    v_dot2c_f32_bf16 v21, v184, v184
    v_dot2c_f32_bf16 v22, s24, v185
    v_dot2c_f32_bf16 v23, v185, v185
    v_dot2c_f32_bf16 v20, s24, v186
    v_dot2c_f32_bf16 v21, v186, v186
    v_dot2c_f32_bf16 v22, s24, v187
    v_dot2c_f32_bf16 v23, v187, v187
    v_dot2c_f32_bf16 v20, s24, v188
    v_dot2c_f32_bf16 v21, v188, v188
    v_dot2c_f32_bf16 v22, s24, v189
    v_dot2c_f32_bf16 v23, v189, v189
    v_dot2c_f32_bf16 v20, s24, v190
    v_dot2c_f32_bf16 v21, v190, v190
    v_dot2c_f32_bf16 v22, s24, v191
    v_dot2c_f32_bf16 v23, v191, v191
    v_dot2c_f32_bf16 v20, s24, v192
    v_dot2c_f32_bf16 v21, v192, v192
    v_dot2c_f32_bf16 v22, s24, v193
    v_dot2c_f32_bf16 v23, v193, v193
    v_dot2c_f32_bf16 v20, s24, v194
    v_dot2c_f32_bf16 v21, v194, v194
    v_dot2c_f32_bf16 v22, s24, v195
    v_dot2c_f32_bf16 v23, v195, v195
    v_dot2c_f32_bf16 v20, s24, v196
    v_dot2c_f32_bf16 v21, v196, v196
    v_dot2c_f32_bf16 v22, s24, v197
    v_dot2c_f32_bf16 v23, v197, v197
    v_dot2c_f32_bf16 v20, s24, v198
    v_dot2c_f32_bf16 v21, v198, v198
    v_dot2c_f32_bf16 v22, s24, v199
    v_dot2c_f32_bf16 v23, v199, v199
    s_nop 2
    v_pk_add_f32 v[20:21], v[20:21], v[22:23]
    v_mov_b32 v22, v20
    v_mov_b32 v23, v21
    s_nop 1
    v_permlane16_swap_b32 v20, v22
    v_permlane16_swap_b32 v21, v23
    s_nop 1
    v_pk_add_f32 v[20:21], v[20:21], v[22:23]
    v_mov_b32 v22, v20
    v_mov_b32 v23, v21
    s_nop 1
    v_permlane32_swap_b32 v20, v22
    v_permlane32_swap_b32 v21, v23
    s_nop 1
    v_pk_add_f32 v[20:21], v[20:21], v[22:23]
    v_lshlrev_b32 v11, 3, v240
    s_lshl_b32 s23, s20, 7
    s_add_u32 s23, s23, 53760
    v_add_u32 v12, s23, v11
    v_add_u32 v11, 53760, v11
    ds_write_b64 v12, v[20:21]
    v_permlane16_swap_b32 v176, v178
    v_permlane16_swap_b32 v177, v179
    v_permlane16_swap_b32 v180, v182
    v_permlane16_swap_b32 v181, v183
    v_permlane16_swap_b32 v184, v186
    v_permlane16_swap_b32 v185, v187
    v_permlane16_swap_b32 v188, v190
    v_permlane16_swap_b32 v189, v191
    v_permlane16_swap_b32 v192, v194
    v_permlane16_swap_b32 v193, v195
    v_permlane16_swap_b32 v196, v198
    v_permlane16_swap_b32 v197, v199
    s_waitcnt lgkmcnt(0)
    s_barrier
    ds_read_b64 v[112:113], v11 offset:0
    ds_read_b64 v[114:115], v11 offset:128
    ds_read_b64 v[116:117], v11 offset:256
    ds_read_b64 v[118:119], v11 offset:384
    v_lshlrev_b32 v64, 16, v176
    v_and_b32 v65, s25, v176
    v_lshlrev_b32 v66, 16, v177
    v_and_b32 v67, s25, v177
    v_lshlrev_b32 v68, 16, v178
    v_and_b32 v69, s25, v178
    v_lshlrev_b32 v70, 16, v179
    v_and_b32 v71, s25, v179
    v_lshlrev_b32 v72, 16, v180
    v_and_b32 v73, s25, v180
    v_lshlrev_b32 v74, 16, v181
    v_and_b32 v75, s25, v181
    v_lshlrev_b32 v76, 16, v182
    v_and_b32 v77, s25, v182
    v_lshlrev_b32 v78, 16, v183
    v_and_b32 v79, s25, v183
    v_lshlrev_b32 v80, 16, v184
    v_and_b32 v81, s25, v184
    v_lshlrev_b32 v82, 16, v185
    v_and_b32 v83, s25, v185
    v_lshlrev_b32 v84, 16, v186
    v_and_b32 v85, s25, v186
    v_lshlrev_b32 v86, 16, v187
    v_and_b32 v87, s25, v187
    v_lshlrev_b32 v88, 16, v188
    v_and_b32 v89, s25, v188
    v_lshlrev_b32 v90, 16, v189
    v_and_b32 v91, s25, v189
    v_lshlrev_b32 v92, 16, v190
    v_and_b32 v93, s25, v190
    v_lshlrev_b32 v94, 16, v191
    v_and_b32 v95, s25, v191
    v_lshlrev_b32 v96, 16, v192
    v_and_b32 v97, s25, v192
    v_lshlrev_b32 v98, 16, v193
    v_and_b32 v99, s25, v193
    v_lshlrev_b32 v100, 16, v194
    v_and_b32 v101, s25, v194
    v_lshlrev_b32 v102, 16, v195
    v_and_b32 v103, s25, v195
    v_lshlrev_b32 v104, 16, v196
    v_and_b32 v105, s25, v196
    v_lshlrev_b32 v106, 16, v197
    v_and_b32 v107, s25, v197
    v_lshlrev_b32 v108, 16, v198
    v_and_b32 v109, s25, v198
    v_lshlrev_b32 v110, 16, v199
    v_and_b32 v111, s25, v199
    s_waitcnt lgkmcnt(0)
    v_pk_add_f32 v[112:113], v[112:113], v[114:115]
    v_pk_add_f32 v[116:117], v[116:117], v[118:119]
    v_pk_add_f32 v[112:113], v[112:113], v[116:117]
    v_mul_f32 v9, 0x3aaaaaab, v112
    v_mul_f32 v10, 0x3aaaaaab, v113
    v_fma_f32 v10, -v9, v9, v10
    v_max_f32 v10, 0, v10
    v_add_f32 v10, 0x3727c5ac, v10
    v_rsq_f32 v10, v10
    s_nop 0
    v_mul_f32 v11, v9, v10
    v_sub_f32 v11, 0, v11
    s_lshr_b32 s21, s38, 6
    s_mul_i32 s21, s21, 2304*8
    s_add_u32 s21, s21, 131072
    v_lshlrev_b32 v13, 4, v0
    s_add_u32 s61, s21, 0
    buffer_load_dwordx4 v[16:19], v13, s[16:19], s61 offen sc1
    s_add_u32 s61, s21, 4096
    buffer_load_dwordx4 v[20:23], v13, s[16:19], s61 offen sc1
    s_add_u32 s61, s21, 8192
    buffer_load_dwordx4 v[24:27], v13, s[16:19], s61 offen sc1
    s_add_u32 s61, s21, 36864
    buffer_load_dwordx4 v[28:31], v13, s[16:19], s61 offen sc1
    s_add_u32 s61, s21, 40960
    buffer_load_dwordx4 v[32:35], v13, s[16:19], s61 offen sc1
    s_add_u32 s61, s21, 45056
    buffer_load_dwordx4 v[36:39], v13, s[16:19], s61 offen sc1
    v_pk_fma_f32 v[64:65], v[64:65], v[10:11], v[10:11] op_sel:[0,0,1] op_sel_hi:[1,0,1]
    v_pk_fma_f32 v[66:67], v[66:67], v[10:11], v[10:11] op_sel:[0,0,1] op_sel_hi:[1,0,1]
    v_pk_fma_f32 v[68:69], v[68:69], v[10:11], v[10:11] op_sel:[0,0,1] op_sel_hi:[1,0,1]
    v_pk_fma_f32 v[70:71], v[70:71], v[10:11], v[10:11] op_sel:[0,0,1] op_sel_hi:[1,0,1]
    v_pk_fma_f32 v[72:73], v[72:73], v[10:11], v[10:11] op_sel:[0,0,1] op_sel_hi:[1,0,1]
    v_pk_fma_f32 v[74:75], v[74:75], v[10:11], v[10:11] op_sel:[0,0,1] op_sel_hi:[1,0,1]
    v_pk_fma_f32 v[76:77], v[76:77], v[10:11], v[10:11] op_sel:[0,0,1] op_sel_hi:[1,0,1]
    v_pk_fma_f32 v[78:79], v[78:79], v[10:11], v[10:11] op_sel:[0,0,1] op_sel_hi:[1,0,1]
    v_pk_fma_f32 v[80:81], v[80:81], v[10:11], v[10:11] op_sel:[0,0,1] op_sel_hi:[1,0,1]
    v_pk_fma_f32 v[82:83], v[82:83], v[10:11], v[10:11] op_sel:[0,0,1] op_sel_hi:[1,0,1]
    v_pk_fma_f32 v[84:85], v[84:85], v[10:11], v[10:11] op_sel:[0,0,1] op_sel_hi:[1,0,1]
    v_pk_fma_f32 v[86:87], v[86:87], v[10:11], v[10:11] op_sel:[0,0,1] op_sel_hi:[1,0,1]
    v_pk_fma_f32 v[88:89], v[88:89], v[10:11], v[10:11] op_sel:[0,0,1] op_sel_hi:[1,0,1]
    v_pk_fma_f32 v[90:91], v[90:91], v[10:11], v[10:11] op_sel:[0,0,1] op_sel_hi:[1,0,1]
    v_pk_fma_f32 v[92:93], v[92:93], v[10:11], v[10:11] op_sel:[0,0,1] op_sel_hi:[1,0,1]
    v_pk_fma_f32 v[94:95], v[94:95], v[10:11], v[10:11] op_sel:[0,0,1] op_sel_hi:[1,0,1]
    v_pk_fma_f32 v[96:97], v[96:97], v[10:11], v[10:11] op_sel:[0,0,1] op_sel_hi:[1,0,1]
    v_pk_fma_f32 v[98:99], v[98:99], v[10:11], v[10:11] op_sel:[0,0,1] op_sel_hi:[1,0,1]
    v_pk_fma_f32 v[100:101], v[100:101], v[10:11], v[10:11] op_sel:[0,0,1] op_sel_hi:[1,0,1]
    v_pk_fma_f32 v[102:103], v[102:103], v[10:11], v[10:11] op_sel:[0,0,1] op_sel_hi:[1,0,1]
    v_pk_fma_f32 v[104:105], v[104:105], v[10:11], v[10:11] op_sel:[0,0,1] op_sel_hi:[1,0,1]
    v_pk_fma_f32 v[106:107], v[106:107], v[10:11], v[10:11] op_sel:[0,0,1] op_sel_hi:[1,0,1]
    v_pk_fma_f32 v[108:109], v[108:109], v[10:11], v[10:11] op_sel:[0,0,1] op_sel_hi:[1,0,1]
    v_pk_fma_f32 v[110:111], v[110:111], v[10:11], v[10:11] op_sel:[0,0,1] op_sel_hi:[1,0,1]
    v_lshrrev_b32 v5, 1, v241
    v_lshlrev_b32 v5, 6, v5
    v_and_b32 v6, 1, v241
    v_lshlrev_b32 v7, 4, v6
    v_add_u32 v8, v5, v7
    v_add_u32 v8, 54272, v8
    s_lshr_b32 s22, s38, 1
    s_mul_i32 s22, s22, 48*1024
    s_and_b32 s23, s38, 1
    s_lshl_b32 s23, s23, 8
    s_add_u32 s22, s22, s23
    s_add_u32 s22, s22, 1048576
    v_lshrrev_b32 v5, 1, v241
    v_lshlrev_b32 v5, 10, v5
    v_lshlrev_b32 v7, 9, v6
    v_lshlrev_b32 v9, 4, v240
    v_add3_u32 v5, v5, v7, v9
    v_lshlrev_b32 v14, 3, v0
    v_add_u32 v14, 54272, v14
    s_mov_b32 s60, 0
    s_branch mod_chk_17
mod_top_15:
    s_add_u32 s61, s21, 0
    buffer_load_dwordx4 v[16:19], v13, s[16:19], s61 offen sc1
    s_add_u32 s61, s21, 4096
    buffer_load_dwordx4 v[20:23], v13, s[16:19], s61 offen sc1
    s_add_u32 s61, s21, 8192
    buffer_load_dwordx4 v[24:27], v13, s[16:19], s61 offen sc1
    s_add_u32 s61, s21, 36864
    buffer_load_dwordx4 v[28:31], v13, s[16:19], s61 offen sc1
    s_add_u32 s61, s21, 40960
    buffer_load_dwordx4 v[32:35], v13, s[16:19], s61 offen sc1
    s_add_u32 s61, s21, 45056
    buffer_load_dwordx4 v[36:39], v13, s[16:19], s61 offen sc1
    s_add_u32 s60, s60, 1
    s_cmp_gt_u32 s60, 20000
    s_cbranch_scc1 mod_done_16
mod_chk_17:
    s_waitcnt vmcnt(0)
    v_cmp_ne_u32 vcc, s37, v17
    v_cmp_ne_u32 s[62:63], s37, v19
    s_or_b64 vcc, vcc, s[62:63]
    v_cmp_ne_u32 s[62:63], s37, v21
    s_or_b64 vcc, vcc, s[62:63]
    v_cmp_ne_u32 s[62:63], s37, v23
    s_or_b64 vcc, vcc, s[62:63]
    v_cmp_ne_u32 s[62:63], s37, v25
    s_or_b64 vcc, vcc, s[62:63]
    v_cmp_ne_u32 s[62:63], s37, v27
    s_or_b64 vcc, vcc, s[62:63]
    v_cmp_ne_u32 s[62:63], s37, v29
    s_or_b64 vcc, vcc, s[62:63]
    v_cmp_ne_u32 s[62:63], s37, v31
    s_or_b64 vcc, vcc, s[62:63]
    v_cmp_ne_u32 s[62:63], s37, v33
    s_or_b64 vcc, vcc, s[62:63]
    v_cmp_ne_u32 s[62:63], s37, v35
    s_or_b64 vcc, vcc, s[62:63]
    v_cmp_ne_u32 s[62:63], s37, v37
    s_or_b64 vcc, vcc, s[62:63]
    v_cmp_ne_u32 s[62:63], s37, v39
    s_or_b64 vcc, vcc, s[62:63]
    s_cmp_eq_u64 vcc, 0
    s_cbranch_scc0 mod_top_15
mod_done_16:
    v_add_f32 v16, v16, v28
    v_add_f32 v17, v18, v30
    ds_write_b64 v14, v[16:17] offset:0
    v_add_f32 v20, v20, v32
    v_add_f32 v21, v22, v34
    ds_write_b64 v14, v[20:21] offset:2048
    v_add_f32 v24, v24, v36
    v_add_f32 v25, v26, v38
    ds_write_b64 v14, v[24:25] offset:4096
    s_waitcnt lgkmcnt(0)
    s_barrier
    ds_read_b128 v[16:19], v8 offset:0
    ds_read_b128 v[20:23], v8 offset:32
    ds_read_b128 v[24:27], v8 offset:3072
    ds_read_b128 v[28:31], v8 offset:3104
    ds_read_b128 v[32:35], v8 offset:512
    ds_read_b128 v[36:39], v8 offset:544
    ds_read_b128 v[40:43], v8 offset:3584
    ds_read_b128 v[44:47], v8 offset:3616
    ds_read_b128 v[48:51], v8 offset:1024
    ds_read_b128 v[52:55], v8 offset:1056
    ds_read_b128 v[56:59], v8 offset:4096
    ds_read_b128 v[60:63], v8 offset:4128
    s_waitcnt lgkmcnt(8)
    v_pk_fma_f32 v[64:65], v[64:65], v[24:25], v[16:17]
    v_pk_fma_f32 v[66:67], v[66:67], v[26:27], v[18:19]
    v_pk_fma_f32 v[68:69], v[68:69], v[28:29], v[20:21]
    v_pk_fma_f32 v[70:71], v[70:71], v[30:31], v[22:23]
    v_cvt_pk_bf16_f32 v176, v64, v65
    v_cvt_pk_bf16_f32 v177, v66, v67
    v_cvt_pk_bf16_f32 v178, v68, v69
    v_cvt_pk_bf16_f32 v179, v70, v71
    buffer_store_dwordx4 v[176:179], v5, s[16:19], s22 offen sc1
    s_add_u32 s22, s22, 8192
    ds_read_b128 v[16:19], v8 offset:1536
    ds_read_b128 v[20:23], v8 offset:1568
    ds_read_b128 v[24:27], v8 offset:4608
    ds_read_b128 v[28:31], v8 offset:4640
    s_waitcnt lgkmcnt(8)
    v_pk_fma_f32 v[72:73], v[72:73], v[40:41], v[32:33]
    v_pk_fma_f32 v[74:75], v[74:75], v[42:43], v[34:35]
    v_pk_fma_f32 v[76:77], v[76:77], v[44:45], v[36:37]
    v_pk_fma_f32 v[78:79], v[78:79], v[46:47], v[38:39]
    v_cvt_pk_bf16_f32 v180, v72, v73
    v_cvt_pk_bf16_f32 v181, v74, v75
    v_cvt_pk_bf16_f32 v182, v76, v77
    v_cvt_pk_bf16_f32 v183, v78, v79
    buffer_store_dwordx4 v[180:183], v5, s[16:19], s22 offen sc1
    s_add_u32 s22, s22, 8192
    ds_read_b128 v[32:35], v8 offset:2048
    ds_read_b128 v[36:39], v8 offset:2080
    ds_read_b128 v[40:43], v8 offset:5120
    ds_read_b128 v[44:47], v8 offset:5152
    s_waitcnt lgkmcnt(8)
    v_pk_fma_f32 v[80:81], v[80:81], v[56:57], v[48:49]
    v_pk_fma_f32 v[82:83], v[82:83], v[58:59], v[50:51]
    v_pk_fma_f32 v[84:85], v[84:85], v[60:61], v[52:53]
    v_pk_fma_f32 v[86:87], v[86:87], v[62:63], v[54:55]
    v_cvt_pk_bf16_f32 v184, v80, v81
    v_cvt_pk_bf16_f32 v185, v82, v83
    v_cvt_pk_bf16_f32 v186, v84, v85
    v_cvt_pk_bf16_f32 v187, v86, v87
    buffer_store_dwordx4 v[184:187], v5, s[16:19], s22 offen sc1
    s_add_u32 s22, s22, 8192
    ds_read_b128 v[48:51], v8 offset:2560
    ds_read_b128 v[52:55], v8 offset:2592
    ds_read_b128 v[56:59], v8 offset:5632
    ds_read_b128 v[60:63], v8 offset:5664
    s_waitcnt lgkmcnt(8)
    v_pk_fma_f32 v[88:89], v[88:89], v[24:25], v[16:17]
    v_pk_fma_f32 v[90:91], v[90:91], v[26:27], v[18:19]
    v_pk_fma_f32 v[92:93], v[92:93], v[28:29], v[20:21]
    v_pk_fma_f32 v[94:95], v[94:95], v[30:31], v[22:23]
    v_cvt_pk_bf16_f32 v188, v88, v89
    v_cvt_pk_bf16_f32 v189, v90, v91
    v_cvt_pk_bf16_f32 v190, v92, v93
    v_cvt_pk_bf16_f32 v191, v94, v95
    buffer_store_dwordx4 v[188:191], v5, s[16:19], s22 offen sc1
    s_add_u32 s22, s22, 8192
    s_waitcnt lgkmcnt(4)
    v_pk_fma_f32 v[96:97], v[96:97], v[40:41], v[32:33]
    v_pk_fma_f32 v[98:99], v[98:99], v[42:43], v[34:35]
    v_pk_fma_f32 v[100:101], v[100:101], v[44:45], v[36:37]
    v_pk_fma_f32 v[102:103], v[102:103], v[46:47], v[38:39]
    v_cvt_pk_bf16_f32 v192, v96, v97
    v_cvt_pk_bf16_f32 v193, v98, v99
    v_cvt_pk_bf16_f32 v194, v100, v101
    v_cvt_pk_bf16_f32 v195, v102, v103
    buffer_store_dwordx4 v[192:195], v5, s[16:19], s22 offen sc1
    s_add_u32 s22, s22, 8192
    s_waitcnt lgkmcnt(0)
    v_pk_fma_f32 v[104:105], v[104:105], v[56:57], v[48:49]
    v_pk_fma_f32 v[106:107], v[106:107], v[58:59], v[50:51]
    v_pk_fma_f32 v[108:109], v[108:109], v[60:61], v[52:53]
    v_pk_fma_f32 v[110:111], v[110:111], v[62:63], v[54:55]
    v_cvt_pk_bf16_f32 v196, v104, v105
    v_cvt_pk_bf16_f32 v197, v106, v107
    v_cvt_pk_bf16_f32 v198, v108, v109
    v_cvt_pk_bf16_f32 v199, v110, v111
    buffer_store_dwordx4 v[196:199], v5, s[16:19], s22 offen sc1
    s_add_u32 s22, s22, 8192
    s_waitcnt vmcnt(0)
    s_lshr_b32 s60, s38, 3
    s_mul_i32 s60, s60, 1024
    s_and_b32 s61, s38, 7
    s_lshl_b32 s61, s61, 2
    s_add_u32 s60, s60, s61
    s_add_u32 s64, s60, 18874368
    s_barrier
    s_cmp_eq_u32 s20, 1
    s_cbranch_scc0 pub_skip_18
    v_mov_b32 v1, s37
    v_lshlrev_b32 v2, 7, v255
    s_mov_b64 s[62:63], exec
    s_mov_b64 exec, 255
    buffer_store_dword v1, v2, s[16:19], s64 offen sc1
    s_mov_b64 exec, s[62:63]
pub_skip_18:
    s_sub_u32 s60, s39, 12
    s_cmp_lt_u32 s60, 3
    s_cbranch_scc0 mh_nog
    v_lshlrev_b32 v12, 16, v244
    v_and_b32 v13, 0xffff0000, v244
    v_lshlrev_b32 v14, 16, v245
    v_and_b32 v15, 0xffff0000, v245
    v_lshlrev_b32 v16, 16, v246
    v_and_b32 v17, 0xffff0000, v246
    s_mov_b32 s24, 0xbfb8aa3b
    v_mul_f32 v20, s24, v12
    v_mul_f32 v21, s24, v13
    v_mul_f32 v22, s24, v14
    v_mul_f32 v23, s24, v15
    v_mul_f32 v24, s24, v16
    v_mul_f32 v25, s24, v17
    v_exp_f32 v20, v20
    v_exp_f32 v21, v21
    v_exp_f32 v22, v22
    v_exp_f32 v23, v23
    v_exp_f32 v24, v24
    v_exp_f32 v25, v25
    s_nop 0
    v_add_f32 v20, 1.0, v20
    v_add_f32 v21, 1.0, v21
    v_add_f32 v22, 1.0, v22
    v_add_f32 v23, 1.0, v23
    v_add_f32 v24, 1.0, v24
    v_add_f32 v25, 1.0, v25
    v_rcp_f32 v20, v20
    v_rcp_f32 v21, v21
    v_rcp_f32 v22, v22
    v_rcp_f32 v23, v23
    v_rcp_f32 v24, v24
    v_rcp_f32 v25, v25
    s_nop 0
    v_mul_f32 v20, v20, v12
    v_mul_f32 v21, v21, v13
    v_mul_f32 v22, v22, v14
    v_mul_f32 v23, v23, v15
    v_mul_f32 v24, v24, v16
    v_mul_f32 v25, v25, v17
    v_cvt_pk_bf16_f32 v28, v20, v21
    v_cvt_pk_bf16_f32 v29, v22, v23
    v_cvt_pk_bf16_f32 v30, v24, v25
    v_add_u32 v3, 49152, v247
    ds_write_b32 v3, v28 offset:0
    ds_write_b32 v3, v29 offset:4
    ds_write_b32 v3, v30 offset:8
    v_lshrrev_b32 v4, 4, v255
    v_and_b32 v5, 1, v255
    v_mul_u32_u24 v5, 1536, v5
    v_lshlrev_b32 v6, 4, v4
    v_add_u32 v5, v5, v6
    s_mul_i32 s24, s20, 192
    s_add_u32 s24, s24, s31
    s_lshl_b32 s24, s24, 1
    s_add_u32 s24, s24, 49152
    v_add_u32 v5, s24, v5
    v_and_b32 v6, 15, v255
    v_lshrrev_b32 v6, 2, v6
    v_lshlrev_b32 v7, 3, v4
    v_add_u32 v6, v6, v7
    v_lshlrev_b32 v6, 6, v6
    v_and_b32 v7, 3, v255
    v_lshlrev_b32 v7, 3, v7
    v_add_u32 v6, v6, v7
    s_mul_i32 s24, s20, 12288
    v_add_u32 v6, s24, v6
    v_and_b32 v17, 15, v255
    v_lshlrev_b32 v17, 3, v17
    s_lshl_b32 s24, s20, 8
    s_add_u32 s24, s24, 52224
    v_add_u32 v17, s24, v17
    v_and_b32 v18, 31, v255
    v_lshrrev_b32 v19, 5, v255
    v_lshrrev_b32 v29, 4, v18
    v_lshlrev_b32 v29, 7, v29
    v_and_b32 v30, 15, v18
    v_lshlrev_b32 v30, 3, v30
    v_lshlrev_b32 v31, 2, v19
    v_add3_u32 v29, v29, v30, v31
    v_add_u32 v29, 52224, v29
    v_mul_u32_u24 v19, 2304*8, v19
    v_lshlrev_b32 v18, 3, v18
    v_add_u32 v18, v19, v18
    s_lshl_b32 s25, s30, 8
    s_add_u32 s25, s25, 131072
    s_cmp_eq_u32 s31, 0
    s_cselect_b32 s60, 0, 36864
    s_add_u32 s25, s25, s60
    s_sub_u32 s29, s30, 24
    s_add_u32 s29, s29, s31
    s_cmp_lt_u32 s29, 24
    s_cselect_b32 s29, 1.0, 0
    s_waitcnt lgkmcnt(0)
    s_barrier
    ds_read_b128 v[128:131], v5 offset:0
    ds_read_b64_tr_b16 v[132:133], v6 offset:0
    ds_read_b64_tr_b16 v[134:135], v6 offset:256
    ds_read_b64_tr_b16 v[136:137], v6 offset:32
    ds_read_b64_tr_b16 v[138:139], v6 offset:288
    ds_read_b128 v[140:143], v5 offset:64
    ds_read_b64_tr_b16 v[144:145], v6 offset:2048
    ds_read_b64_tr_b16 v[146:147], v6 offset:2304
    ds_read_b64_tr_b16 v[148:149], v6 offset:2080
    ds_read_b64_tr_b16 v[150:151], v6 offset:2336
    ds_read_b128 v[152:155], v5 offset:128
    ds_read_b64_tr_b16 v[156:157], v6 offset:4096
    ds_read_b64_tr_b16 v[158:159], v6 offset:4352
    ds_read_b64_tr_b16 v[160:161], v6 offset:4128
    ds_read_b64_tr_b16 v[162:163], v6 offset:4384
    s_waitcnt lgkmcnt(10)
    v_mfma_f32_16x16x32_bf16 v[32:35], v[128:131], v[132:135], 0
    v_mfma_f32_16x16x32_bf16 v[36:39], v[128:131], v[136:139], 0
    s_waitcnt lgkmcnt(5)
    v_mfma_f32_16x16x32_bf16 v[32:35], v[140:143], v[144:147], v[32:35]
    v_mfma_f32_16x16x32_bf16 v[36:39], v[140:143], v[148:151], v[36:39]
    s_waitcnt lgkmcnt(0)
    v_mfma_f32_16x16x32_bf16 v[32:35], v[152:155], v[156:159], v[32:35]
    v_mfma_f32_16x16x32_bf16 v[36:39], v[152:155], v[160:163], v[36:39]
    ds_read_b128 v[128:131], v5 offset:192
    ds_read_b64_tr_b16 v[132:133], v6 offset:6144
    ds_read_b64_tr_b16 v[134:135], v6 offset:6400
    ds_read_b64_tr_b16 v[136:137], v6 offset:6176
    ds_read_b64_tr_b16 v[138:139], v6 offset:6432
    ds_read_b128 v[140:143], v5 offset:256
    ds_read_b64_tr_b16 v[144:145], v6 offset:8192
    ds_read_b64_tr_b16 v[146:147], v6 offset:8448
    ds_read_b64_tr_b16 v[148:149], v6 offset:8224
    ds_read_b64_tr_b16 v[150:151], v6 offset:8480
    ds_read_b128 v[152:155], v5 offset:320
    ds_read_b64_tr_b16 v[156:157], v6 offset:10240
    ds_read_b64_tr_b16 v[158:159], v6 offset:10496
    ds_read_b64_tr_b16 v[160:161], v6 offset:10272
    ds_read_b64_tr_b16 v[162:163], v6 offset:10528
    s_waitcnt lgkmcnt(10)
    v_mfma_f32_16x16x32_bf16 v[32:35], v[128:131], v[132:135], v[32:35]
    v_mfma_f32_16x16x32_bf16 v[36:39], v[128:131], v[136:139], v[36:39]
    s_waitcnt lgkmcnt(5)
    v_mfma_f32_16x16x32_bf16 v[32:35], v[140:143], v[144:147], v[32:35]
    v_mfma_f32_16x16x32_bf16 v[36:39], v[140:143], v[148:151], v[36:39]
    s_waitcnt lgkmcnt(0)
    v_mfma_f32_16x16x32_bf16 v[32:35], v[152:155], v[156:159], v[32:35]
    v_mfma_f32_16x16x32_bf16 v[36:39], v[152:155], v[160:163], v[36:39]
    s_nop 0
    s_mov_b64 exec, 0xffff
    s_nop 6
    ds_write_b64 v17, v[32:33]
    ds_write_b64 v17, v[36:37] offset:128
    s_mov_b64 exec, -1
    s_waitcnt lgkmcnt(0)
    s_barrier
    s_cmp_eq_u32 s20, 0
    s_cbranch_scc0 mt_skip_19
    ds_read_b32 v12, v29 offset:0
    ds_read_b32 v13, v29 offset:256
    ds_read_b32 v14, v29 offset:512
    ds_read_b32 v15, v29 offset:768
    v_mov_b32 v21, s37
    s_waitcnt lgkmcnt(0)
    v_add_f32 v12, v12, v13
    v_add_f32 v14, v14, v15
    v_add_f32 v12, v12, v14
    v_add_f32 v20, s29, v12
    buffer_store_dwordx2 v[20:21], v18, s[16:19], s25 offen sc1
mt_skip_19:
    s_barrier
mh_nog:
L_phaseB:
    s_lshl_b32 s26, s34, 10
    s_lshl_b32 s60, s56, 6
    s_add_u32 s26, s26, s60
    s_lshl_b32 s60, s58, 5
    s_add_u32 s26, s26, s60
    s_mul_i32 s26, s26, 1536
    s_mul_i32 s60, s57, 192
    s_add_u32 s26, s26, s60
    s_mul_i32 s60, s59, 96
    s_add_u32 s26, s26, s60
    v_and_b32 v236, 15, v255
    v_mul_u32_u24 v236, 1536, v236
    v_lshrrev_b32 v237, 4, v255
    v_lshlrev_b32 v238, 3, v237
    v_add_u32 v236, v236, v238
    v_add_u32 v239, 24576, v236
    buffer_load_dwordx2 v[200:201], v236, s[4:7], s26 offen offset:0
    buffer_load_dwordx2 v[202:203], v236, s[4:7], s26 offen offset:32
    buffer_load_dwordx2 v[204:205], v236, s[4:7], s26 offen offset:64
    buffer_load_dwordx2 v[206:207], v239, s[4:7], s26 offen offset:0
    buffer_load_dwordx2 v[208:209], v239, s[4:7], s26 offen offset:32
    buffer_load_dwordx2 v[210:211], v239, s[4:7], s26 offen offset:64
xa_skip_20:
    s_lshl_b32 s60, s34, 3
    s_add_u32 s60, s60, s35
    s_mul_i32 s60, s60, 1024
    s_add_u32 s64, s60, 18874368
    s_mul_i32 s60, s3, 1024
    s_add_u32 s65, s60, 18890752
    s_and_b32 s61, s3, 7
    s_lshl_b32 s61, s61, 7
    s_add_u32 s64, s64, s61
    s_and_b32 s61, s35, 7
    s_lshl_b32 s61, s61, 7
    s_add_u32 s65, s65, s61
    v_and_b32 v3, 7, v255
    v_lshlrev_b32 v3, 2, v3
    v_add_u32 v1, s64, v3
    v_add_u32 v2, s65, v3
    s_lshl_b32 s21, s34, 5
    s_lshl_b32 s60, s35, 2
    s_add_u32 s21, s21, s60
    s_add_u32 s21, s21, s20
    s_mul_i32 s21, s21, 48*1024
    s_add_u32 s21, s21, 1048576
    s_mul_i32 s22, s3, 3*48*1024
    s_lshl_b32 s60, s20, 10
    s_add_u32 s22, s22, s60
    s_add_u32 s22, s22, 4194304
    s_mul_i32 s23, s20, 3072
    v_add_u32 v10, 0, v254
    v_add_u32 v11, 48128, v254
    v_add_u32 v12, 96256, v254
    v_mov_b32 v4, v254
    v_add_u32 v5, 0x10000, v254
    v_add_u32 v6, 0x20000, v254
    s_cmp_lt_u32 s3, 8
    s_cbranch_scc0 pb_urole
    s_cmp_eq_u32 s20, 0
    s_cbranch_scc0 sp2_done_21
    s_mov_b32 s60, 0
sp2_top_22:
    s_load_dwordx8 s[84:91], s[16:17], s65 glc
    s_load_dwordx8 s[72:79], s[16:17], s64 glc
    s_add_u32 s60, s60, 1
    s_cmp_gt_u32 s60, 20000
    s_cbranch_scc1 sp2_done_21
    s_waitcnt lgkmcnt(0)
    s_and_b64 s[92:93], s[84:85], s[86:87]
    s_or_b64 s[94:95], s[84:85], s[86:87]
    s_and_b64 s[92:93], s[92:93], s[88:89]
    s_or_b64 s[94:95], s[94:95], s[88:89]
    s_and_b64 s[92:93], s[92:93], s[90:91]
    s_or_b64 s[94:95], s[94:95], s[90:91]
    s_and_b32 s92, s92, s93
    s_or_b32 s94, s94, s95
    s_cmp_eq_u32 s92, s37
    s_cbranch_scc0 sp2_top_22
    s_cmp_eq_u32 s94, s37
    s_cbranch_scc0 sp2_top_22
    s_and_b64 s[92:93], s[72:73], s[74:75]
    s_or_b64 s[94:95], s[72:73], s[74:75]
    s_and_b64 s[92:93], s[92:93], s[76:77]
    s_or_b64 s[94:95], s[94:95], s[76:77]
    s_and_b64 s[92:93], s[92:93], s[78:79]
    s_or_b64 s[94:95], s[94:95], s[78:79]
    s_and_b32 s92, s92, s93
    s_or_b32 s94, s94, s95
    s_cmp_eq_u32 s92, s37
    s_cbranch_scc0 sp2_top_22
    s_cmp_eq_u32 s94, s37
    s_cbranch_scc0 sp2_top_22
sp2_done_21:
    s_waitcnt lgkmcnt(0)
    s_barrier
    s_mov_b32 m0, s23
    s_add_u32 s23, s23, 12288
    buffer_load_dwordx4 v10, s[16:19], s22 offen offset:0 sc1 lds
    buffer_load_dwordx4 v11, s[16:19], s22 offen offset:1024 sc1 lds
    buffer_load_dwordx4 v12, s[16:19], s22 offen offset:2048 sc1 lds
    s_add_u32 s22, s22, 4096
    buffer_load_dwordx4 a[0:3], v254, s[16:19], s21 offen offset:0 sc1
    buffer_load_dwordx4 a[4:7], v254, s[16:19], s21 offen offset:1024 sc1
    buffer_load_dwordx4 a[8:11], v254, s[16:19], s21 offen offset:2048 sc1
    buffer_load_dwordx4 a[12:15], v254, s[16:19], s21 offen offset:3072 sc1
    s_add_u32 s21, s21, 4096
    s_mov_b32 m0, s23
    s_add_u32 s23, s23, 12288
    buffer_load_dwordx4 v10, s[16:19], s22 offen offset:0 sc1 lds
    buffer_load_dwordx4 v11, s[16:19], s22 offen offset:1024 sc1 lds
    buffer_load_dwordx4 v12, s[16:19], s22 offen offset:2048 sc1 lds
    s_add_u32 s22, s22, 4096
    buffer_load_dwordx4 a[16:19], v254, s[16:19], s21 offen offset:0 sc1
    buffer_load_dwordx4 a[20:23], v254, s[16:19], s21 offen offset:1024 sc1
    buffer_load_dwordx4 a[24:27], v254, s[16:19], s21 offen offset:2048 sc1
    buffer_load_dwordx4 a[28:31], v254, s[16:19], s21 offen offset:3072 sc1
    s_add_u32 s21, s21, 4096
    s_mov_b32 m0, s23
    s_add_u32 s23, s23, 12288
    buffer_load_dwordx4 v10, s[16:19], s22 offen offset:0 sc1 lds
    buffer_load_dwordx4 v11, s[16:19], s22 offen offset:1024 sc1 lds
    buffer_load_dwordx4 v12, s[16:19], s22 offen offset:2048 sc1 lds
    s_add_u32 s22, s22, 4096
    buffer_load_dwordx4 a[32:35], v254, s[16:19], s21 offen offset:0 sc1
    buffer_load_dwordx4 a[36:39], v254, s[16:19], s21 offen offset:1024 sc1
    buffer_load_dwordx4 a[40:43], v254, s[16:19], s21 offen offset:2048 sc1
    buffer_load_dwordx4 a[44:47], v254, s[16:19], s21 offen offset:3072 sc1
    s_add_u32 s21, s21, 4096
    s_waitcnt vmcnt(14)
    s_barrier
    ds_read_b128 v[64:67], v4 offset:0
    ds_read_b128 v[68:71], v4 offset:1024
    ds_read_b128 v[72:75], v4 offset:2048
    ds_read_b128 v[76:79], v4 offset:3072
    ds_read_b128 v[80:83], v4 offset:4096
    ds_read_b128 v[84:87], v4 offset:5120
    s_waitcnt lgkmcnt(5)
    v_mfma_f32_32x32x16_bf16 v[16:31], v[64:67], a[0:3], 0
    ds_read_b128 v[88:91], v4 offset:6144
    s_waitcnt lgkmcnt(5)
    v_mfma_f32_32x32x16_bf16 v[32:47], v[68:71], a[0:3], 0
    ds_read_b128 v[92:95], v4 offset:7168
    s_mov_b32 m0, s23
    s_add_u32 s23, s23, 12288
    buffer_load_dwordx4 v10, s[16:19], s22 offen offset:0 sc1 lds
    s_waitcnt lgkmcnt(5)
    v_mfma_f32_32x32x16_bf16 v[48:63], v[72:75], a[0:3], 0
    ds_read_b128 v[96:99], v4 offset:8192
    buffer_load_dwordx4 a[48:51], v254, s[16:19], s21 offen offset:0 sc1
    s_waitcnt lgkmcnt(5)
    v_mfma_f32_32x32x16_bf16 v[16:31], v[76:79], a[4:7], v[16:31]
    ds_read_b128 v[64:67], v4 offset:9216
    s_waitcnt lgkmcnt(5)
    v_mfma_f32_32x32x16_bf16 v[32:47], v[80:83], a[4:7], v[32:47]
    ds_read_b128 v[68:71], v4 offset:10240
    buffer_load_dwordx4 v11, s[16:19], s22 offen offset:1024 sc1 lds
    s_waitcnt lgkmcnt(5)
    v_mfma_f32_32x32x16_bf16 v[48:63], v[84:87], a[4:7], v[48:63]
    ds_read_b128 v[72:75], v4 offset:11264
    s_waitcnt vmcnt(10)
    s_barrier
    s_waitcnt lgkmcnt(5)
    v_mfma_f32_32x32x16_bf16 v[16:31], v[88:91], a[8:11], v[16:31]
    ds_read_b128 v[76:79], v4 offset:12288
    buffer_load_dwordx4 a[52:55], v254, s[16:19], s21 offen offset:1024 sc1
    s_waitcnt lgkmcnt(5)
    v_mfma_f32_32x32x16_bf16 v[32:47], v[92:95], a[8:11], v[32:47]
    ds_read_b128 v[80:83], v4 offset:13312
    s_waitcnt lgkmcnt(5)
    v_mfma_f32_32x32x16_bf16 v[48:63], v[96:99], a[8:11], v[48:63]
    ds_read_b128 v[84:87], v4 offset:14336
    buffer_load_dwordx4 v12, s[16:19], s22 offen offset:2048 sc1 lds
    s_add_u32 s22, s22, 4096
    s_waitcnt lgkmcnt(5)
    v_mfma_f32_32x32x16_bf16 v[16:31], v[64:67], a[12:15], v[16:31]
    ds_read_b128 v[88:91], v4 offset:15360
    buffer_load_dwordx4 a[56:59], v254, s[16:19], s21 offen offset:2048 sc1
    s_waitcnt lgkmcnt(5)
    v_mfma_f32_32x32x16_bf16 v[32:47], v[68:71], a[12:15], v[32:47]
    ds_read_b128 v[92:95], v4 offset:16384
    s_waitcnt lgkmcnt(5)
    v_mfma_f32_32x32x16_bf16 v[48:63], v[72:75], a[12:15], v[48:63]
    ds_read_b128 v[96:99], v4 offset:17408
    buffer_load_dwordx4 a[60:63], v254, s[16:19], s21 offen offset:3072 sc1
    s_add_u32 s21, s21, 4096
    s_waitcnt lgkmcnt(5)
    v_mfma_f32_32x32x16_bf16 v[16:31], v[76:79], a[16:19], v[16:31]
    ds_read_b128 v[64:67], v4 offset:18432
    s_waitcnt lgkmcnt(5)
    v_mfma_f32_32x32x16_bf16 v[32:47], v[80:83], a[16:19], v[32:47]
    ds_read_b128 v[68:71], v4 offset:19456
    s_mov_b32 m0, s23
    s_add_u32 s23, s23, 12288
    buffer_load_dwordx4 v10, s[16:19], s22 offen offset:0 sc1 lds
    s_waitcnt lgkmcnt(5)
    v_mfma_f32_32x32x16_bf16 v[48:63], v[84:87], a[16:19], v[48:63]
    ds_read_b128 v[72:75], v4 offset:20480
    buffer_load_dwordx4 a[64:67], v254, s[16:19], s21 offen offset:0 sc1
    s_waitcnt lgkmcnt(5)
    v_mfma_f32_32x32x16_bf16 v[16:31], v[88:91], a[20:23], v[16:31]
    ds_read_b128 v[76:79], v4 offset:21504
    s_waitcnt lgkmcnt(5)
    v_mfma_f32_32x32x16_bf16 v[32:47], v[92:95], a[20:23], v[32:47]
    ds_read_b128 v[80:83], v4 offset:22528
    buffer_load_dwordx4 v11, s[16:19], s22 offen offset:1024 sc1 lds
    s_waitcnt lgkmcnt(5)
    v_mfma_f32_32x32x16_bf16 v[48:63], v[96:99], a[20:23], v[48:63]
    ds_read_b128 v[84:87], v4 offset:23552
    s_waitcnt vmcnt(10)
    s_barrier
    s_waitcnt lgkmcnt(5)
    v_mfma_f32_32x32x16_bf16 v[16:31], v[64:67], a[24:27], v[16:31]
    ds_read_b128 v[88:91], v4 offset:24576
    buffer_load_dwordx4 a[68:71], v254, s[16:19], s21 offen offset:1024 sc1
    s_waitcnt lgkmcnt(5)
    v_mfma_f32_32x32x16_bf16 v[32:47], v[68:71], a[24:27], v[32:47]
    ds_read_b128 v[92:95], v4 offset:25600
    s_waitcnt lgkmcnt(5)
    v_mfma_f32_32x32x16_bf16 v[48:63], v[72:75], a[24:27], v[48:63]
    ds_read_b128 v[96:99], v4 offset:26624
    buffer_load_dwordx4 v12, s[16:19], s22 offen offset:2048 sc1 lds
    s_add_u32 s22, s22, 4096
    s_waitcnt lgkmcnt(5)
    v_mfma_f32_32x32x16_bf16 v[16:31], v[76:79], a[28:31], v[16:31]
    ds_read_b128 v[64:67], v4 offset:27648
    buffer_load_dwordx4 a[72:75], v254, s[16:19], s21 offen offset:2048 sc1
    s_waitcnt lgkmcnt(5)
    v_mfma_f32_32x32x16_bf16 v[32:47], v[80:83], a[28:31], v[32:47]
    ds_read_b128 v[68:71], v4 offset:28672
    s_waitcnt lgkmcnt(5)
    v_mfma_f32_32x32x16_bf16 v[48:63], v[84:87], a[28:31], v[48:63]
    ds_read_b128 v[72:75], v4 offset:29696
    buffer_load_dwordx4 a[76:79], v254, s[16:19], s21 offen offset:3072 sc1
    s_add_u32 s21, s21, 4096
    s_waitcnt lgkmcnt(5)
    v_mfma_f32_32x32x16_bf16 v[16:31], v[88:91], a[32:35], v[16:31]
    ds_read_b128 v[76:79], v4 offset:30720
    s_waitcnt lgkmcnt(5)
    v_mfma_f32_32x32x16_bf16 v[32:47], v[92:95], a[32:35], v[32:47]
    ds_read_b128 v[80:83], v4 offset:31744
    s_mov_b32 m0, s23
    s_add_u32 s23, s23, 12288
    buffer_load_dwordx4 v10, s[16:19], s22 offen offset:0 sc1 lds
    s_waitcnt lgkmcnt(5)
    v_mfma_f32_32x32x16_bf16 v[48:63], v[96:99], a[32:35], v[48:63]
    ds_read_b128 v[84:87], v4 offset:32768
    buffer_load_dwordx4 a[80:83], v254, s[16:19], s21 offen offset:0 sc1
    s_waitcnt lgkmcnt(5)
    v_mfma_f32_32x32x16_bf16 v[16:31], v[64:67], a[36:39], v[16:31]
    ds_read_b128 v[88:91], v4 offset:33792
    s_waitcnt lgkmcnt(5)
    v_mfma_f32_32x32x16_bf16 v[32:47], v[68:71], a[36:39], v[32:47]
    ds_read_b128 v[92:95], v4 offset:34816
    buffer_load_dwordx4 v11, s[16:19], s22 offen offset:1024 sc1 lds
    s_waitcnt lgkmcnt(5)
    v_mfma_f32_32x32x16_bf16 v[48:63], v[72:75], a[36:39], v[48:63]
    ds_read_b128 v[96:99], v4 offset:35840
    s_waitcnt vmcnt(10)
    s_barrier
    s_waitcnt lgkmcnt(5)
    v_mfma_f32_32x32x16_bf16 v[16:31], v[76:79], a[40:43], v[16:31]
    ds_read_b128 v[64:67], v4 offset:36864
    buffer_load_dwordx4 a[84:87], v254, s[16:19], s21 offen offset:1024 sc1
    s_waitcnt lgkmcnt(5)
    v_mfma_f32_32x32x16_bf16 v[32:47], v[80:83], a[40:43], v[32:47]
    ds_read_b128 v[68:71], v4 offset:37888
    s_waitcnt lgkmcnt(5)
    v_mfma_f32_32x32x16_bf16 v[48:63], v[84:87], a[40:43], v[48:63]
    ds_read_b128 v[72:75], v4 offset:38912
    buffer_load_dwordx4 v12, s[16:19], s22 offen offset:2048 sc1 lds
    s_add_u32 s22, s22, 4096
    s_waitcnt lgkmcnt(5)
    v_mfma_f32_32x32x16_bf16 v[16:31], v[88:91], a[44:47], v[16:31]
    ds_read_b128 v[76:79], v4 offset:39936
    buffer_load_dwordx4 a[88:91], v254, s[16:19], s21 offen offset:2048 sc1
    s_waitcnt lgkmcnt(5)
    v_mfma_f32_32x32x16_bf16 v[32:47], v[92:95], a[44:47], v[32:47]
    ds_read_b128 v[80:83], v4 offset:40960
    s_waitcnt lgkmcnt(5)
    v_mfma_f32_32x32x16_bf16 v[48:63], v[96:99], a[44:47], v[48:63]
    ds_read_b128 v[84:87], v4 offset:41984
    buffer_load_dwordx4 a[92:95], v254, s[16:19], s21 offen offset:3072 sc1
    s_add_u32 s21, s21, 4096
    s_waitcnt lgkmcnt(5)
    v_mfma_f32_32x32x16_bf16 v[16:31], v[64:67], a[48:51], v[16:31]
    ds_read_b128 v[88:91], v4 offset:43008
    s_waitcnt lgkmcnt(5)
    v_mfma_f32_32x32x16_bf16 v[32:47], v[68:71], a[48:51], v[32:47]
    ds_read_b128 v[92:95], v4 offset:44032
    s_mov_b32 m0, s23
    s_add_u32 s23, s23, 12288
    buffer_load_dwordx4 v10, s[16:19], s22 offen offset:0 sc1 lds
    s_waitcnt lgkmcnt(5)
    v_mfma_f32_32x32x16_bf16 v[48:63], v[72:75], a[48:51], v[48:63]
    ds_read_b128 v[96:99], v4 offset:45056
    buffer_load_dwordx4 a[96:99], v254, s[16:19], s21 offen offset:0 sc1
    s_waitcnt lgkmcnt(5)
    v_mfma_f32_32x32x16_bf16 v[16:31], v[76:79], a[52:55], v[16:31]
    ds_read_b128 v[64:67], v4 offset:46080
    s_waitcnt lgkmcnt(5)
    v_mfma_f32_32x32x16_bf16 v[32:47], v[80:83], a[52:55], v[32:47]
    ds_read_b128 v[68:71], v4 offset:47104
    buffer_load_dwordx4 v11, s[16:19], s22 offen offset:1024 sc1 lds
    s_waitcnt lgkmcnt(5)
    v_mfma_f32_32x32x16_bf16 v[48:63], v[84:87], a[52:55], v[48:63]
    ds_read_b128 v[72:75], v4 offset:48128
    s_waitcnt vmcnt(10)
    s_barrier
    s_waitcnt lgkmcnt(5)
    v_mfma_f32_32x32x16_bf16 v[16:31], v[88:91], a[56:59], v[16:31]
    ds_read_b128 v[76:79], v4 offset:49152
    buffer_load_dwordx4 a[100:103], v254, s[16:19], s21 offen offset:1024 sc1
    s_waitcnt lgkmcnt(5)
    v_mfma_f32_32x32x16_bf16 v[32:47], v[92:95], a[56:59], v[32:47]
    ds_read_b128 v[80:83], v4 offset:50176
    s_waitcnt lgkmcnt(5)
    v_mfma_f32_32x32x16_bf16 v[48:63], v[96:99], a[56:59], v[48:63]
    ds_read_b128 v[84:87], v4 offset:51200
    buffer_load_dwordx4 v12, s[16:19], s22 offen offset:2048 sc1 lds
    s_add_u32 s22, s22, 4096
    s_waitcnt lgkmcnt(5)
    v_mfma_f32_32x32x16_bf16 v[16:31], v[64:67], a[60:63], v[16:31]
    ds_read_b128 v[88:91], v4 offset:52224
    buffer_load_dwordx4 a[104:107], v254, s[16:19], s21 offen offset:2048 sc1
    s_waitcnt lgkmcnt(5)
    v_mfma_f32_32x32x16_bf16 v[32:47], v[68:71], a[60:63], v[32:47]
    ds_read_b128 v[92:95], v4 offset:53248
    s_waitcnt lgkmcnt(5)
    v_mfma_f32_32x32x16_bf16 v[48:63], v[72:75], a[60:63], v[48:63]
    ds_read_b128 v[96:99], v4 offset:54272
    buffer_load_dwordx4 a[108:111], v254, s[16:19], s21 offen offset:3072 sc1
    s_add_u32 s21, s21, 4096
    s_waitcnt lgkmcnt(5)
    v_mfma_f32_32x32x16_bf16 v[16:31], v[76:79], a[64:67], v[16:31]
    ds_read_b128 v[64:67], v4 offset:55296
    s_waitcnt lgkmcnt(5)
    v_mfma_f32_32x32x16_bf16 v[32:47], v[80:83], a[64:67], v[32:47]
    ds_read_b128 v[68:71], v4 offset:56320
    s_mov_b32 m0, s23
    s_add_u32 s23, s23, 12288
    buffer_load_dwordx4 v10, s[16:19], s22 offen offset:0 sc1 lds
    s_waitcnt lgkmcnt(5)
    v_mfma_f32_32x32x16_bf16 v[48:63], v[84:87], a[64:67], v[48:63]
    ds_read_b128 v[72:75], v4 offset:57344
    buffer_load_dwordx4 a[112:115], v254, s[16:19], s21 offen offset:0 sc1
    s_waitcnt lgkmcnt(5)
    v_mfma_f32_32x32x16_bf16 v[16:31], v[88:91], a[68:71], v[16:31]
    ds_read_b128 v[76:79], v4 offset:58368
    s_waitcnt lgkmcnt(5)
    v_mfma_f32_32x32x16_bf16 v[32:47], v[92:95], a[68:71], v[32:47]
    ds_read_b128 v[80:83], v4 offset:59392
    buffer_load_dwordx4 v11, s[16:19], s22 offen offset:1024 sc1 lds
    s_waitcnt lgkmcnt(5)
    v_mfma_f32_32x32x16_bf16 v[48:63], v[96:99], a[68:71], v[48:63]
    ds_read_b128 v[84:87], v4 offset:60416
    s_waitcnt vmcnt(10)
    s_barrier
    s_waitcnt lgkmcnt(5)
    v_mfma_f32_32x32x16_bf16 v[16:31], v[64:67], a[72:75], v[16:31]
    ds_read_b128 v[88:91], v4 offset:61440
    buffer_load_dwordx4 a[116:119], v254, s[16:19], s21 offen offset:1024 sc1
    s_waitcnt lgkmcnt(5)
    v_mfma_f32_32x32x16_bf16 v[32:47], v[68:71], a[72:75], v[32:47]
    ds_read_b128 v[92:95], v4 offset:62464
    s_waitcnt lgkmcnt(5)
    v_mfma_f32_32x32x16_bf16 v[48:63], v[72:75], a[72:75], v[48:63]
    ds_read_b128 v[96:99], v4 offset:63488
    buffer_load_dwordx4 v12, s[16:19], s22 offen offset:2048 sc1 lds
    s_add_u32 s22, s22, 4096
    s_waitcnt lgkmcnt(5)
    v_mfma_f32_32x32x16_bf16 v[16:31], v[76:79], a[76:79], v[16:31]
    ds_read_b128 v[64:67], v4 offset:64512
    buffer_load_dwordx4 a[120:123], v254, s[16:19], s21 offen offset:2048 sc1
    s_waitcnt lgkmcnt(5)
    v_mfma_f32_32x32x16_bf16 v[32:47], v[80:83], a[76:79], v[32:47]
    ds_read_b128 v[68:71], v5 offset:0
    s_waitcnt lgkmcnt(5)
    v_mfma_f32_32x32x16_bf16 v[48:63], v[84:87], a[76:79], v[48:63]
    ds_read_b128 v[72:75], v5 offset:1024
    buffer_load_dwordx4 a[124:127], v254, s[16:19], s21 offen offset:3072 sc1
    s_add_u32 s21, s21, 4096
    s_waitcnt lgkmcnt(5)
    v_mfma_f32_32x32x16_bf16 v[16:31], v[88:91], a[80:83], v[16:31]
    ds_read_b128 v[76:79], v5 offset:2048
    s_waitcnt lgkmcnt(5)
    v_mfma_f32_32x32x16_bf16 v[32:47], v[92:95], a[80:83], v[32:47]
    ds_read_b128 v[80:83], v5 offset:3072
    s_mov_b32 m0, s23
    s_add_u32 s23, s23, 12288
    buffer_load_dwordx4 v10, s[16:19], s22 offen offset:0 sc1 lds
    s_waitcnt lgkmcnt(5)
    v_mfma_f32_32x32x16_bf16 v[48:63], v[96:99], a[80:83], v[48:63]
    ds_read_b128 v[84:87], v5 offset:4096
    buffer_load_dwordx4 a[128:131], v254, s[16:19], s21 offen offset:0 sc1
    s_waitcnt lgkmcnt(5)
    v_mfma_f32_32x32x16_bf16 v[16:31], v[64:67], a[84:87], v[16:31]
    ds_read_b128 v[88:91], v5 offset:5120
    s_waitcnt lgkmcnt(5)
    v_mfma_f32_32x32x16_bf16 v[32:47], v[68:71], a[84:87], v[32:47]
    ds_read_b128 v[92:95], v5 offset:6144
    buffer_load_dwordx4 v11, s[16:19], s22 offen offset:1024 sc1 lds
    s_waitcnt lgkmcnt(5)
    v_mfma_f32_32x32x16_bf16 v[48:63], v[72:75], a[84:87], v[48:63]
    ds_read_b128 v[96:99], v5 offset:7168
    s_waitcnt vmcnt(10)
    s_barrier
    s_waitcnt lgkmcnt(5)
    v_mfma_f32_32x32x16_bf16 v[16:31], v[76:79], a[88:91], v[16:31]
    ds_read_b128 v[64:67], v5 offset:8192
    buffer_load_dwordx4 a[132:135], v254, s[16:19], s21 offen offset:1024 sc1
    s_waitcnt lgkmcnt(5)
    v_mfma_f32_32x32x16_bf16 v[32:47], v[80:83], a[88:91], v[32:47]
    ds_read_b128 v[68:71], v5 offset:9216
    s_waitcnt lgkmcnt(5)
    v_mfma_f32_32x32x16_bf16 v[48:63], v[84:87], a[88:91], v[48:63]
    ds_read_b128 v[72:75], v5 offset:10240
    buffer_load_dwordx4 v12, s[16:19], s22 offen offset:2048 sc1 lds
    s_add_u32 s22, s22, 4096
    s_waitcnt lgkmcnt(5)
    v_mfma_f32_32x32x16_bf16 v[16:31], v[88:91], a[92:95], v[16:31]
    ds_read_b128 v[76:79], v5 offset:11264
    buffer_load_dwordx4 a[136:139], v254, s[16:19], s21 offen offset:2048 sc1
    s_waitcnt lgkmcnt(5)
    v_mfma_f32_32x32x16_bf16 v[32:47], v[92:95], a[92:95], v[32:47]
    ds_read_b128 v[80:83], v5 offset:12288
    s_waitcnt lgkmcnt(5)
    v_mfma_f32_32x32x16_bf16 v[48:63], v[96:99], a[92:95], v[48:63]
    ds_read_b128 v[84:87], v5 offset:13312
    buffer_load_dwordx4 a[140:143], v254, s[16:19], s21 offen offset:3072 sc1
    s_add_u32 s21, s21, 4096
    s_waitcnt lgkmcnt(5)
    v_mfma_f32_32x32x16_bf16 v[16:31], v[64:67], a[96:99], v[16:31]
    ds_read_b128 v[88:91], v5 offset:14336
    s_waitcnt lgkmcnt(5)
    v_mfma_f32_32x32x16_bf16 v[32:47], v[68:71], a[96:99], v[32:47]
    ds_read_b128 v[92:95], v5 offset:15360
    s_mov_b32 m0, s23
    s_add_u32 s23, s23, 12288
    buffer_load_dwordx4 v10, s[16:19], s22 offen offset:0 sc1 lds
    s_waitcnt lgkmcnt(5)
    v_mfma_f32_32x32x16_bf16 v[48:63], v[72:75], a[96:99], v[48:63]
    ds_read_b128 v[96:99], v5 offset:16384
    buffer_load_dwordx4 a[144:147], v254, s[16:19], s21 offen offset:0 sc1
    s_waitcnt lgkmcnt(5)
    v_mfma_f32_32x32x16_bf16 v[16:31], v[76:79], a[100:103], v[16:31]
    ds_read_b128 v[64:67], v5 offset:17408
    s_waitcnt lgkmcnt(5)
    v_mfma_f32_32x32x16_bf16 v[32:47], v[80:83], a[100:103], v[32:47]
    ds_read_b128 v[68:71], v5 offset:18432
    buffer_load_dwordx4 v11, s[16:19], s22 offen offset:1024 sc1 lds
    s_waitcnt lgkmcnt(5)
    v_mfma_f32_32x32x16_bf16 v[48:63], v[84:87], a[100:103], v[48:63]
    ds_read_b128 v[72:75], v5 offset:19456
    s_waitcnt vmcnt(10)
    s_barrier
    s_waitcnt lgkmcnt(5)
    v_mfma_f32_32x32x16_bf16 v[16:31], v[88:91], a[104:107], v[16:31]
    ds_read_b128 v[76:79], v5 offset:20480
    buffer_load_dwordx4 a[148:151], v254, s[16:19], s21 offen offset:1024 sc1
    s_waitcnt lgkmcnt(5)
    v_mfma_f32_32x32x16_bf16 v[32:47], v[92:95], a[104:107], v[32:47]
    ds_read_b128 v[80:83], v5 offset:21504
    s_waitcnt lgkmcnt(5)
    v_mfma_f32_32x32x16_bf16 v[48:63], v[96:99], a[104:107], v[48:63]
    ds_read_b128 v[84:87], v5 offset:22528
    buffer_load_dwordx4 v12, s[16:19], s22 offen offset:2048 sc1 lds
    s_add_u32 s22, s22, 4096
    s_waitcnt lgkmcnt(5)
    v_mfma_f32_32x32x16_bf16 v[16:31], v[64:67], a[108:111], v[16:31]
    ds_read_b128 v[88:91], v5 offset:23552
    buffer_load_dwordx4 a[152:155], v254, s[16:19], s21 offen offset:2048 sc1
    s_waitcnt lgkmcnt(5)
    v_mfma_f32_32x32x16_bf16 v[32:47], v[68:71], a[108:111], v[32:47]
    ds_read_b128 v[92:95], v5 offset:24576
    s_waitcnt lgkmcnt(5)
    v_mfma_f32_32x32x16_bf16 v[48:63], v[72:75], a[108:111], v[48:63]
    ds_read_b128 v[96:99], v5 offset:25600
    buffer_load_dwordx4 a[156:159], v254, s[16:19], s21 offen offset:3072 sc1
    s_add_u32 s21, s21, 4096
    s_waitcnt lgkmcnt(5)
    v_mfma_f32_32x32x16_bf16 v[16:31], v[76:79], a[112:115], v[16:31]
    ds_read_b128 v[64:67], v5 offset:26624
    s_waitcnt lgkmcnt(5)
    v_mfma_f32_32x32x16_bf16 v[32:47], v[80:83], a[112:115], v[32:47]
    ds_read_b128 v[68:71], v5 offset:27648
    s_mov_b32 m0, s23
    s_add_u32 s23, s23, 12288
    buffer_load_dwordx4 v10, s[16:19], s22 offen offset:0 sc1 lds
    s_waitcnt lgkmcnt(5)
    v_mfma_f32_32x32x16_bf16 v[48:63], v[84:87], a[112:115], v[48:63]
    ds_read_b128 v[72:75], v5 offset:28672
    buffer_load_dwordx4 a[160:163], v254, s[16:19], s21 offen offset:0 sc1
    s_waitcnt lgkmcnt(5)
    v_mfma_f32_32x32x16_bf16 v[16:31], v[88:91], a[116:119], v[16:31]
    ds_read_b128 v[76:79], v5 offset:29696
    s_waitcnt lgkmcnt(5)
    v_mfma_f32_32x32x16_bf16 v[32:47], v[92:95], a[116:119], v[32:47]
    ds_read_b128 v[80:83], v5 offset:30720
    buffer_load_dwordx4 v11, s[16:19], s22 offen offset:1024 sc1 lds
    s_waitcnt lgkmcnt(5)
    v_mfma_f32_32x32x16_bf16 v[48:63], v[96:99], a[116:119], v[48:63]
    ds_read_b128 v[84:87], v5 offset:31744
    s_waitcnt vmcnt(10)
    s_barrier
    s_waitcnt lgkmcnt(5)
    v_mfma_f32_32x32x16_bf16 v[16:31], v[64:67], a[120:123], v[16:31]
    ds_read_b128 v[88:91], v5 offset:32768
    buffer_load_dwordx4 a[164:167], v254, s[16:19], s21 offen offset:1024 sc1
    s_waitcnt lgkmcnt(5)
    v_mfma_f32_32x32x16_bf16 v[32:47], v[68:71], a[120:123], v[32:47]
    ds_read_b128 v[92:95], v5 offset:33792
    s_waitcnt lgkmcnt(5)
    v_mfma_f32_32x32x16_bf16 v[48:63], v[72:75], a[120:123], v[48:63]
    ds_read_b128 v[96:99], v5 offset:34816
    buffer_load_dwordx4 v12, s[16:19], s22 offen offset:2048 sc1 lds
    s_add_u32 s22, s22, 4096
    s_waitcnt lgkmcnt(5)
    v_mfma_f32_32x32x16_bf16 v[16:31], v[76:79], a[124:127], v[16:31]
    ds_read_b128 v[64:67], v5 offset:35840
    buffer_load_dwordx4 a[168:171], v254, s[16:19], s21 offen offset:2048 sc1
    s_waitcnt lgkmcnt(5)
    v_mfma_f32_32x32x16_bf16 v[32:47], v[80:83], a[124:127], v[32:47]
    ds_read_b128 v[68:71], v5 offset:36864
    s_waitcnt lgkmcnt(5)
    v_mfma_f32_32x32x16_bf16 v[48:63], v[84:87], a[124:127], v[48:63]
    ds_read_b128 v[72:75], v5 offset:37888
    buffer_load_dwordx4 a[172:175], v254, s[16:19], s21 offen offset:3072 sc1
    s_add_u32 s21, s21, 4096
    s_waitcnt lgkmcnt(5)
    v_mfma_f32_32x32x16_bf16 v[16:31], v[88:91], a[128:131], v[16:31]
    ds_read_b128 v[76:79], v5 offset:38912
    s_waitcnt lgkmcnt(5)
    v_mfma_f32_32x32x16_bf16 v[32:47], v[92:95], a[128:131], v[32:47]
    ds_read_b128 v[80:83], v5 offset:39936
    s_mov_b32 m0, s23
    s_add_u32 s23, s23, 12288
    buffer_load_dwordx4 v10, s[16:19], s22 offen offset:0 sc1 lds
    s_waitcnt lgkmcnt(5)
    v_mfma_f32_32x32x16_bf16 v[48:63], v[96:99], a[128:131], v[48:63]
    ds_read_b128 v[84:87], v5 offset:40960
    buffer_load_dwordx4 a[176:179], v254, s[16:19], s21 offen offset:0 sc1
    s_waitcnt lgkmcnt(5)
    v_mfma_f32_32x32x16_bf16 v[16:31], v[64:67], a[132:135], v[16:31]
    ds_read_b128 v[88:91], v5 offset:41984
    s_waitcnt lgkmcnt(5)
    v_mfma_f32_32x32x16_bf16 v[32:47], v[68:71], a[132:135], v[32:47]
    ds_read_b128 v[92:95], v5 offset:43008
    buffer_load_dwordx4 v11, s[16:19], s22 offen offset:1024 sc1 lds
    s_waitcnt lgkmcnt(5)
    v_mfma_f32_32x32x16_bf16 v[48:63], v[72:75], a[132:135], v[48:63]
    ds_read_b128 v[96:99], v5 offset:44032
    s_waitcnt vmcnt(10)
    s_barrier
    s_waitcnt lgkmcnt(5)
    v_mfma_f32_32x32x16_bf16 v[16:31], v[76:79], a[136:139], v[16:31]
    ds_read_b128 v[64:67], v5 offset:45056
    buffer_load_dwordx4 a[180:183], v254, s[16:19], s21 offen offset:1024 sc1
    s_waitcnt lgkmcnt(5)
    v_mfma_f32_32x32x16_bf16 v[32:47], v[80:83], a[136:139], v[32:47]
    ds_read_b128 v[68:71], v5 offset:46080
    s_waitcnt lgkmcnt(5)
    v_mfma_f32_32x32x16_bf16 v[48:63], v[84:87], a[136:139], v[48:63]
    ds_read_b128 v[72:75], v5 offset:47104
    buffer_load_dwordx4 v12, s[16:19], s22 offen offset:2048 sc1 lds
    s_add_u32 s22, s22, 4096
    s_waitcnt lgkmcnt(5)
    v_mfma_f32_32x32x16_bf16 v[16:31], v[88:91], a[140:143], v[16:31]
    ds_read_b128 v[76:79], v5 offset:48128
    buffer_load_dwordx4 a[184:187], v254, s[16:19], s21 offen offset:2048 sc1
    s_waitcnt lgkmcnt(5)
    v_mfma_f32_32x32x16_bf16 v[32:47], v[92:95], a[140:143], v[32:47]
    ds_read_b128 v[80:83], v5 offset:49152
    s_waitcnt lgkmcnt(5)
    v_mfma_f32_32x32x16_bf16 v[48:63], v[96:99], a[140:143], v[48:63]
    ds_read_b128 v[84:87], v5 offset:50176
    buffer_load_dwordx4 a[188:191], v254, s[16:19], s21 offen offset:3072 sc1
    s_add_u32 s21, s21, 4096
    s_waitcnt lgkmcnt(5)
    v_mfma_f32_32x32x16_bf16 v[16:31], v[64:67], a[144:147], v[16:31]
    ds_read_b128 v[88:91], v5 offset:51200
    s_waitcnt lgkmcnt(5)
    v_mfma_f32_32x32x16_bf16 v[32:47], v[68:71], a[144:147], v[32:47]
    ds_read_b128 v[92:95], v5 offset:52224
    s_waitcnt lgkmcnt(5)
    v_mfma_f32_32x32x16_bf16 v[48:63], v[72:75], a[144:147], v[48:63]
    ds_read_b128 v[96:99], v5 offset:53248
    s_waitcnt lgkmcnt(5)
    v_mfma_f32_32x32x16_bf16 v[16:31], v[76:79], a[148:151], v[16:31]
    ds_read_b128 v[64:67], v5 offset:54272
    s_waitcnt lgkmcnt(5)
    v_mfma_f32_32x32x16_bf16 v[32:47], v[80:83], a[148:151], v[32:47]
    ds_read_b128 v[68:71], v5 offset:55296
    s_waitcnt lgkmcnt(5)
    v_mfma_f32_32x32x16_bf16 v[48:63], v[84:87], a[148:151], v[48:63]
    ds_read_b128 v[72:75], v5 offset:56320
    s_waitcnt vmcnt(7)
    s_barrier
    s_waitcnt lgkmcnt(5)
    v_mfma_f32_32x32x16_bf16 v[16:31], v[88:91], a[152:155], v[16:31]
    ds_read_b128 v[76:79], v5 offset:57344
    s_waitcnt lgkmcnt(5)
    v_mfma_f32_32x32x16_bf16 v[32:47], v[92:95], a[152:155], v[32:47]
    ds_read_b128 v[80:83], v5 offset:58368
    s_waitcnt lgkmcnt(5)
    v_mfma_f32_32x32x16_bf16 v[48:63], v[96:99], a[152:155], v[48:63]
    ds_read_b128 v[84:87], v5 offset:59392
    s_waitcnt lgkmcnt(5)
    v_mfma_f32_32x32x16_bf16 v[16:31], v[64:67], a[156:159], v[16:31]
    ds_read_b128 v[88:91], v5 offset:60416
    s_waitcnt lgkmcnt(5)
    v_mfma_f32_32x32x16_bf16 v[32:47], v[68:71], a[156:159], v[32:47]
    ds_read_b128 v[92:95], v5 offset:61440
    s_waitcnt lgkmcnt(5)
    v_mfma_f32_32x32x16_bf16 v[48:63], v[72:75], a[156:159], v[48:63]
    ds_read_b128 v[96:99], v5 offset:62464
    s_waitcnt lgkmcnt(5)
    v_mfma_f32_32x32x16_bf16 v[16:31], v[76:79], a[160:163], v[16:31]
    ds_read_b128 v[64:67], v5 offset:63488
    s_lshl_b32 s28, s34, 5
    s_lshl_b32 s60, s35, 2
    s_add_u32 s28, s28, s60
    s_add_u32 s28, s28, s20
    s_mul_i32 s28, s28, 48*1024
    s_mul_i32 s60, s3, 6*1024
    s_add_u32 s28, s28, s60
    s_add_u32 s28, s28, 7340032
    s_mov_b32 s24, 0x3d553b95
    s_mov_b32 s25, s24
    s_lshl_b32 s60, s34, 3
    s_add_u32 s60, s60, s35
    s_mul_i32 s60, s60, 1024
    s_lshl_b32 s61, s3, 2
    s_add_u32 s60, s60, s61
    s_add_u32 s64, s60, 18907136
    s_waitcnt lgkmcnt(5)
    v_mfma_f32_32x32x16_bf16 v[32:47], v[80:83], a[160:163], v[32:47]
    ds_read_b128 v[68:71], v5 offset:64512
    s_waitcnt lgkmcnt(5)
    v_mfma_f32_32x32x16_bf16 v[48:63], v[84:87], a[160:163], v[48:63]
    ds_read_b128 v[72:75], v6 offset:0
    s_waitcnt lgkmcnt(5)
    v_mfma_f32_32x32x16_bf16 v[16:31], v[88:91], a[164:167], v[16:31]
    ds_read_b128 v[76:79], v6 offset:1024
    s_waitcnt lgkmcnt(5)
    v_mfma_f32_32x32x16_bf16 v[32:47], v[92:95], a[164:167], v[32:47]
    ds_read_b128 v[80:83], v6 offset:2048
    s_waitcnt lgkmcnt(5)
    v_mfma_f32_32x32x16_bf16 v[48:63], v[96:99], a[164:167], v[48:63]
    ds_read_b128 v[84:87], v6 offset:3072
    s_waitcnt vmcnt(0)
    s_barrier
    s_waitcnt lgkmcnt(5)
    v_mfma_f32_32x32x16_bf16 v[16:31], v[64:67], a[168:171], v[16:31]
    ds_read_b128 v[88:91], v6 offset:4096
    s_waitcnt lgkmcnt(5)
    v_mfma_f32_32x32x16_bf16 v[32:47], v[68:71], a[168:171], v[32:47]
    ds_read_b128 v[92:95], v6 offset:7168
    s_waitcnt lgkmcnt(5)
    v_mfma_f32_32x32x16_bf16 v[48:63], v[72:75], a[168:171], v[48:63]
    ds_read_b128 v[96:99], v6 offset:10240
    s_waitcnt lgkmcnt(5)
    v_mfma_f32_32x32x16_bf16 v[16:31], v[76:79], a[172:175], v[16:31]
    ds_read_b128 v[64:67], v6 offset:13312
    s_waitcnt lgkmcnt(5)
    v_mfma_f32_32x32x16_bf16 v[32:47], v[80:83], a[172:175], v[32:47]
    ds_read_b128 v[68:71], v6 offset:5120
    s_waitcnt lgkmcnt(5)
    v_mfma_f32_32x32x16_bf16 v[48:63], v[84:87], a[172:175], v[48:63]
    ds_read_b128 v[72:75], v6 offset:8192
    s_waitcnt lgkmcnt(5)
    v_mfma_f32_32x32x16_bf16 v[16:31], v[88:91], a[176:179], v[16:31]
    ds_read_b128 v[76:79], v6 offset:11264
    s_waitcnt lgkmcnt(5)
    v_mfma_f32_32x32x16_bf16 v[16:31], v[92:95], a[180:183], v[16:31]
    ds_read_b128 v[80:83], v6 offset:14336
    s_waitcnt lgkmcnt(5)
    v_mfma_f32_32x32x16_bf16 v[16:31], v[96:99], a[184:187], v[16:31]
    ds_read_b128 v[84:87], v6 offset:6144
    s_waitcnt lgkmcnt(5)
    v_mfma_f32_32x32x16_bf16 v[16:31], v[64:67], a[188:191], v[16:31]
    ds_read_b128 v[88:91], v6 offset:9216
    s_waitcnt lgkmcnt(5)
    v_mfma_f32_32x32x16_bf16 v[32:47], v[68:71], a[176:179], v[32:47]
    ds_read_b128 v[92:95], v6 offset:12288
    s_waitcnt lgkmcnt(5)
    v_mfma_f32_32x32x16_bf16 v[32:47], v[72:75], a[180:183], v[32:47]
    ds_read_b128 v[96:99], v6 offset:15360
    s_nop 1
    v_pk_mul_f32 v[16:17], v[16:17], s[24:25]
    v_pk_mul_f32 v[18:19], v[18:19], s[24:25]
    v_pk_mul_f32 v[20:21], v[20:21], s[24:25]
    v_pk_mul_f32 v[22:23], v[22:23], s[24:25]
    v_cvt_pk_bf16_f32 v100, v16, v17
    s_waitcnt lgkmcnt(5)
    v_mfma_f32_32x32x16_bf16 v[32:47], v[76:79], a[184:187], v[32:47]
    v_cvt_pk_bf16_f32 v101, v18, v19
    v_cvt_pk_bf16_f32 v102, v20, v21
    v_cvt_pk_bf16_f32 v103, v22, v23
    buffer_store_dwordx4 v[100:103], v254, s[16:19], s28 offen offset:0 sc1
    v_pk_mul_f32 v[24:25], v[24:25], s[24:25]
    s_waitcnt lgkmcnt(4)
    v_mfma_f32_32x32x16_bf16 v[32:47], v[80:83], a[188:191], v[32:47]
    v_pk_mul_f32 v[26:27], v[26:27], s[24:25]
    v_pk_mul_f32 v[28:29], v[28:29], s[24:25]
    v_pk_mul_f32 v[30:31], v[30:31], s[24:25]
    v_cvt_pk_bf16_f32 v104, v24, v25
    v_cvt_pk_bf16_f32 v105, v26, v27
    s_waitcnt lgkmcnt(3)
    v_mfma_f32_32x32x16_bf16 v[48:63], v[84:87], a[176:179], v[48:63]
    v_cvt_pk_bf16_f32 v106, v28, v29
    v_cvt_pk_bf16_f32 v107, v30, v31
    buffer_store_dwordx4 v[104:107], v254, s[16:19], s28 offen offset:1024 sc1
    s_add_u32 s28, s28, 2048
    s_waitcnt lgkmcnt(2)
    v_mfma_f32_32x32x16_bf16 v[48:63], v[88:91], a[180:183], v[48:63]
    s_nop 1
    v_pk_mul_f32 v[32:33], v[32:33], s[24:25]
    v_pk_mul_f32 v[34:35], v[34:35], s[24:25]
    v_pk_mul_f32 v[36:37], v[36:37], s[24:25]
    v_pk_mul_f32 v[38:39], v[38:39], s[24:25]
    v_cvt_pk_bf16_f32 v108, v32, v33
    s_waitcnt lgkmcnt(1)
    v_mfma_f32_32x32x16_bf16 v[48:63], v[92:95], a[184:187], v[48:63]
    v_cvt_pk_bf16_f32 v109, v34, v35
    v_cvt_pk_bf16_f32 v110, v36, v37
    v_cvt_pk_bf16_f32 v111, v38, v39
    buffer_store_dwordx4 v[108:111], v254, s[16:19], s28 offen offset:0 sc1
    v_pk_mul_f32 v[40:41], v[40:41], s[24:25]
    s_waitcnt lgkmcnt(0)
    v_mfma_f32_32x32x16_bf16 v[48:63], v[96:99], a[188:191], v[48:63]
    v_pk_mul_f32 v[42:43], v[42:43], s[24:25]
    v_pk_mul_f32 v[44:45], v[44:45], s[24:25]
    v_pk_mul_f32 v[46:47], v[46:47], s[24:25]
    v_cvt_pk_bf16_f32 v112, v40, v41
    v_cvt_pk_bf16_f32 v113, v42, v43
    v_cvt_pk_bf16_f32 v114, v44, v45
    v_cvt_pk_bf16_f32 v115, v46, v47
    buffer_store_dwordx4 v[112:115], v254, s[16:19], s28 offen offset:1024 sc1
    s_add_u32 s28, s28, 2048
    s_nop 3
    v_pk_mul_f32 v[48:49], v[48:49], s[24:25]
    v_pk_mul_f32 v[50:51], v[50:51], s[24:25]
    v_pk_mul_f32 v[52:53], v[52:53], s[24:25]
    v_pk_mul_f32 v[54:55], v[54:55], s[24:25]
    v_cvt_pk_bf16_f32 v116, v48, v49
    v_cvt_pk_bf16_f32 v117, v50, v51
    v_cvt_pk_bf16_f32 v118, v52, v53
    v_cvt_pk_bf16_f32 v119, v54, v55
    buffer_store_dwordx4 v[116:119], v254, s[16:19], s28 offen offset:0 sc1
    v_pk_mul_f32 v[56:57], v[56:57], s[24:25]
    v_pk_mul_f32 v[58:59], v[58:59], s[24:25]
    v_pk_mul_f32 v[60:61], v[60:61], s[24:25]
    v_pk_mul_f32 v[62:63], v[62:63], s[24:25]
    v_cvt_pk_bf16_f32 v120, v56, v57
    v_cvt_pk_bf16_f32 v121, v58, v59
    v_cvt_pk_bf16_f32 v122, v60, v61
    v_cvt_pk_bf16_f32 v123, v62, v63
    buffer_store_dwordx4 v[120:123], v254, s[16:19], s28 offen offset:1024 sc1
    s_add_u32 s28, s28, 2048
    s_branch pb_pub
pb_urole:
    s_cmp_eq_u32 s20, 0
    s_cbranch_scc0 sp2_done_23
    s_mov_b32 s60, 0
sp2_top_24:
    s_load_dwordx8 s[84:91], s[16:17], s64 glc
    s_load_dwordx8 s[72:79], s[16:17], s65 glc
    s_add_u32 s60, s60, 1
    s_cmp_gt_u32 s60, 20000
    s_cbranch_scc1 sp2_done_23
    s_waitcnt lgkmcnt(0)
    s_and_b64 s[92:93], s[84:85], s[86:87]
    s_or_b64 s[94:95], s[84:85], s[86:87]
    s_and_b64 s[92:93], s[92:93], s[88:89]
    s_or_b64 s[94:95], s[94:95], s[88:89]
    s_and_b64 s[92:93], s[92:93], s[90:91]
    s_or_b64 s[94:95], s[94:95], s[90:91]
    s_and_b32 s92, s92, s93
    s_or_b32 s94, s94, s95
    s_cmp_eq_u32 s92, s37
    s_cbranch_scc0 sp2_top_24
    s_cmp_eq_u32 s94, s37
    s_cbranch_scc0 sp2_top_24
sp2_done_23:
    s_waitcnt lgkmcnt(0)
    s_barrier
    buffer_load_dwordx4 a[0:3], v254, s[16:19], s21 offen offset:0 sc1
    buffer_load_dwordx4 a[4:7], v254, s[16:19], s21 offen offset:1024 sc1
    buffer_load_dwordx4 a[8:11], v254, s[16:19], s21 offen offset:2048 sc1
    buffer_load_dwordx4 a[12:15], v254, s[16:19], s21 offen offset:3072 sc1
    s_add_u32 s21, s21, 4096
    buffer_load_dwordx4 a[16:19], v254, s[16:19], s21 offen offset:0 sc1
    buffer_load_dwordx4 a[20:23], v254, s[16:19], s21 offen offset:1024 sc1
    buffer_load_dwordx4 a[24:27], v254, s[16:19], s21 offen offset:2048 sc1
    buffer_load_dwordx4 a[28:31], v254, s[16:19], s21 offen offset:3072 sc1
    s_add_u32 s21, s21, 4096
    buffer_load_dwordx4 a[32:35], v254, s[16:19], s21 offen offset:0 sc1
    buffer_load_dwordx4 a[36:39], v254, s[16:19], s21 offen offset:1024 sc1
    buffer_load_dwordx4 a[40:43], v254, s[16:19], s21 offen offset:2048 sc1
    buffer_load_dwordx4 a[44:47], v254, s[16:19], s21 offen offset:3072 sc1
    s_add_u32 s21, s21, 4096
    buffer_load_dwordx4 a[48:51], v254, s[16:19], s21 offen offset:0 sc1
    buffer_load_dwordx4 a[52:55], v254, s[16:19], s21 offen offset:1024 sc1
    buffer_load_dwordx4 a[56:59], v254, s[16:19], s21 offen offset:2048 sc1
    buffer_load_dwordx4 a[60:63], v254, s[16:19], s21 offen offset:3072 sc1
    s_add_u32 s21, s21, 4096
    s_cmp_eq_u32 s20, 0
    s_cbranch_scc0 sp2b_done_25
    s_mov_b32 s60, 0
    s_branch sp2b_chk_27
sp2b_top_26:
    s_load_dwordx8 s[72:79], s[16:17], s65 glc
    s_add_u32 s60, s60, 1
    s_cmp_gt_u32 s60, 20000
    s_cbranch_scc1 sp2b_done_25
sp2b_chk_27:
    s_waitcnt lgkmcnt(0)
    s_and_b64 s[92:93], s[72:73], s[74:75]
    s_or_b64 s[94:95], s[72:73], s[74:75]
    s_and_b64 s[92:93], s[92:93], s[76:77]
    s_or_b64 s[94:95], s[94:95], s[76:77]
    s_and_b64 s[92:93], s[92:93], s[78:79]
    s_or_b64 s[94:95], s[94:95], s[78:79]
    s_and_b32 s92, s92, s93
    s_or_b32 s94, s94, s95
    s_cmp_eq_u32 s92, s37
    s_cbranch_scc0 sp2b_top_26
    s_cmp_eq_u32 s94, s37
    s_cbranch_scc0 sp2b_top_26
sp2b_done_25:
    s_waitcnt lgkmcnt(0)
    s_barrier
    s_mov_b32 m0, s23
    s_add_u32 s23, s23, 12288
    buffer_load_dwordx4 v10, s[16:19], s22 offen offset:0 sc1 lds
    buffer_load_dwordx4 v11, s[16:19], s22 offen offset:1024 sc1 lds
    buffer_load_dwordx4 v12, s[16:19], s22 offen offset:2048 sc1 lds
    s_add_u32 s22, s22, 4096
    s_mov_b32 m0, s23
    s_add_u32 s23, s23, 12288
    buffer_load_dwordx4 v10, s[16:19], s22 offen offset:0 sc1 lds
    buffer_load_dwordx4 v11, s[16:19], s22 offen offset:1024 sc1 lds
    buffer_load_dwordx4 v12, s[16:19], s22 offen offset:2048 sc1 lds
    s_add_u32 s22, s22, 4096
    s_waitcnt vmcnt(3)
    s_barrier
    ds_read_b128 v[64:67], v4 offset:0
    ds_read_b128 v[68:71], v4 offset:1024
    ds_read_b128 v[72:75], v4 offset:2048
    ds_read_b128 v[76:79], v4 offset:3072
    ds_read_b128 v[80:83], v4 offset:4096
    ds_read_b128 v[84:87], v4 offset:5120
    s_waitcnt lgkmcnt(5)
    v_mfma_f32_32x32x16_bf16 v[16:31], a[0:3], v[64:67], 0
    ds_read_b128 v[88:91], v4 offset:6144
    s_waitcnt lgkmcnt(5)
    v_mfma_f32_32x32x16_bf16 v[32:47], a[0:3], v[68:71], 0
    ds_read_b128 v[92:95], v4 offset:7168
    s_mov_b32 m0, s23
    s_add_u32 s23, s23, 12288
    buffer_load_dwordx4 v10, s[16:19], s22 offen offset:0 sc1 lds
    s_waitcnt lgkmcnt(5)
    v_mfma_f32_32x32x16_bf16 v[48:63], a[0:3], v[72:75], 0
    ds_read_b128 v[96:99], v4 offset:8192
    buffer_load_dwordx4 v11, s[16:19], s22 offen offset:1024 sc1 lds
    s_waitcnt lgkmcnt(5)
    v_mfma_f32_32x32x16_bf16 v[16:31], a[4:7], v[76:79], v[16:31]
    ds_read_b128 v[64:67], v4 offset:9216
    s_waitcnt lgkmcnt(5)
    v_mfma_f32_32x32x16_bf16 v[32:47], a[4:7], v[80:83], v[32:47]
    ds_read_b128 v[68:71], v4 offset:10240
    buffer_load_dwordx4 v12, s[16:19], s22 offen offset:2048 sc1 lds
    s_add_u32 s22, s22, 4096
    s_waitcnt lgkmcnt(5)
    v_mfma_f32_32x32x16_bf16 v[48:63], a[4:7], v[84:87], v[48:63]
    ds_read_b128 v[72:75], v4 offset:11264
    s_waitcnt vmcnt(3)
    s_barrier
    s_waitcnt lgkmcnt(5)
    v_mfma_f32_32x32x16_bf16 v[16:31], a[8:11], v[88:91], v[16:31]
    ds_read_b128 v[76:79], v4 offset:12288
    s_mov_b32 m0, s23
    s_add_u32 s23, s23, 12288
    buffer_load_dwordx4 v10, s[16:19], s22 offen offset:0 sc1 lds
    s_waitcnt lgkmcnt(5)
    v_mfma_f32_32x32x16_bf16 v[32:47], a[8:11], v[92:95], v[32:47]
    ds_read_b128 v[80:83], v4 offset:13312
    s_waitcnt lgkmcnt(5)
    v_mfma_f32_32x32x16_bf16 v[48:63], a[8:11], v[96:99], v[48:63]
    ds_read_b128 v[84:87], v4 offset:14336
    buffer_load_dwordx4 v11, s[16:19], s22 offen offset:1024 sc1 lds
    s_waitcnt lgkmcnt(5)
    v_mfma_f32_32x32x16_bf16 v[16:31], a[12:15], v[64:67], v[16:31]
    ds_read_b128 v[88:91], v4 offset:15360
    buffer_load_dwordx4 v12, s[16:19], s22 offen offset:2048 sc1 lds
    s_add_u32 s22, s22, 4096
    s_waitcnt lgkmcnt(5)
    v_mfma_f32_32x32x16_bf16 v[32:47], a[12:15], v[68:71], v[32:47]
    ds_read_b128 v[92:95], v4 offset:16384
    s_waitcnt lgkmcnt(5)
    v_mfma_f32_32x32x16_bf16 v[48:63], a[12:15], v[72:75], v[48:63]
    ds_read_b128 v[96:99], v4 offset:17408
    s_mov_b32 m0, s23
    s_add_u32 s23, s23, 12288
    buffer_load_dwordx4 v10, s[16:19], s22 offen offset:0 sc1 lds
    s_waitcnt lgkmcnt(5)
    v_mfma_f32_32x32x16_bf16 v[16:31], a[16:19], v[76:79], v[16:31]
    ds_read_b128 v[64:67], v4 offset:18432
    s_waitcnt lgkmcnt(5)
    v_mfma_f32_32x32x16_bf16 v[32:47], a[16:19], v[80:83], v[32:47]
    ds_read_b128 v[68:71], v4 offset:19456
    buffer_load_dwordx4 a[64:67], v254, s[16:19], s21 offen offset:0 sc1
    s_waitcnt lgkmcnt(5)
    v_mfma_f32_32x32x16_bf16 v[48:63], a[16:19], v[84:87], v[48:63]
    ds_read_b128 v[72:75], v4 offset:20480
    buffer_load_dwordx4 v11, s[16:19], s22 offen offset:1024 sc1 lds
    s_waitcnt lgkmcnt(5)
    v_mfma_f32_32x32x16_bf16 v[16:31], a[20:23], v[88:91], v[16:31]
    ds_read_b128 v[76:79], v4 offset:21504
    s_waitcnt lgkmcnt(5)
    v_mfma_f32_32x32x16_bf16 v[32:47], a[20:23], v[92:95], v[32:47]
    ds_read_b128 v[80:83], v4 offset:22528
    buffer_load_dwordx4 a[68:71], v254, s[16:19], s21 offen offset:1024 sc1
    s_waitcnt lgkmcnt(5)
    v_mfma_f32_32x32x16_bf16 v[48:63], a[20:23], v[96:99], v[48:63]
    ds_read_b128 v[84:87], v4 offset:23552
    s_waitcnt vmcnt(7)
    s_barrier
    s_waitcnt lgkmcnt(5)
    v_mfma_f32_32x32x16_bf16 v[16:31], a[24:27], v[64:67], v[16:31]
    ds_read_b128 v[88:91], v4 offset:24576
    buffer_load_dwordx4 v12, s[16:19], s22 offen offset:2048 sc1 lds
    s_add_u32 s22, s22, 4096
    s_waitcnt lgkmcnt(5)
    v_mfma_f32_32x32x16_bf16 v[32:47], a[24:27], v[68:71], v[32:47]
    ds_read_b128 v[92:95], v4 offset:25600
    s_waitcnt lgkmcnt(5)
    v_mfma_f32_32x32x16_bf16 v[48:63], a[24:27], v[72:75], v[48:63]
    ds_read_b128 v[96:99], v4 offset:26624
    buffer_load_dwordx4 a[72:75], v254, s[16:19], s21 offen offset:2048 sc1
    s_waitcnt lgkmcnt(5)
    v_mfma_f32_32x32x16_bf16 v[16:31], a[28:31], v[76:79], v[16:31]
    ds_read_b128 v[64:67], v4 offset:27648
    buffer_load_dwordx4 a[76:79], v254, s[16:19], s21 offen offset:3072 sc1
    s_add_u32 s21, s21, 4096
    s_waitcnt lgkmcnt(5)
    v_mfma_f32_32x32x16_bf16 v[32:47], a[28:31], v[80:83], v[32:47]
    ds_read_b128 v[68:71], v4 offset:28672
    s_waitcnt lgkmcnt(5)
    v_mfma_f32_32x32x16_bf16 v[48:63], a[28:31], v[84:87], v[48:63]
    ds_read_b128 v[72:75], v4 offset:29696
    s_mov_b32 m0, s23
    s_add_u32 s23, s23, 12288
    buffer_load_dwordx4 v10, s[16:19], s22 offen offset:0 sc1 lds
    s_waitcnt lgkmcnt(5)
    v_mfma_f32_32x32x16_bf16 v[16:31], a[32:35], v[88:91], v[16:31]
    ds_read_b128 v[76:79], v4 offset:30720
    s_waitcnt lgkmcnt(5)
    v_mfma_f32_32x32x16_bf16 v[32:47], a[32:35], v[92:95], v[32:47]
    ds_read_b128 v[80:83], v4 offset:31744
    buffer_load_dwordx4 a[80:83], v254, s[16:19], s21 offen offset:0 sc1
    s_waitcnt lgkmcnt(5)
    v_mfma_f32_32x32x16_bf16 v[48:63], a[32:35], v[96:99], v[48:63]
    ds_read_b128 v[84:87], v4 offset:32768
    buffer_load_dwordx4 v11, s[16:19], s22 offen offset:1024 sc1 lds
    s_waitcnt lgkmcnt(5)
    v_mfma_f32_32x32x16_bf16 v[16:31], a[36:39], v[64:67], v[16:31]
    ds_read_b128 v[88:91], v4 offset:33792
    s_waitcnt lgkmcnt(5)
    v_mfma_f32_32x32x16_bf16 v[32:47], a[36:39], v[68:71], v[32:47]
    ds_read_b128 v[92:95], v4 offset:34816
    buffer_load_dwordx4 a[84:87], v254, s[16:19], s21 offen offset:1024 sc1
    s_waitcnt lgkmcnt(5)
    v_mfma_f32_32x32x16_bf16 v[48:63], a[36:39], v[72:75], v[48:63]
    ds_read_b128 v[96:99], v4 offset:35840
    s_waitcnt vmcnt(11)
    s_barrier
    s_waitcnt lgkmcnt(5)
    v_mfma_f32_32x32x16_bf16 v[16:31], a[40:43], v[76:79], v[16:31]
    ds_read_b128 v[64:67], v4 offset:36864
    buffer_load_dwordx4 v12, s[16:19], s22 offen offset:2048 sc1 lds
    s_add_u32 s22, s22, 4096
    s_waitcnt lgkmcnt(5)
    v_mfma_f32_32x32x16_bf16 v[32:47], a[40:43], v[80:83], v[32:47]
    ds_read_b128 v[68:71], v4 offset:37888
    s_waitcnt lgkmcnt(5)
    v_mfma_f32_32x32x16_bf16 v[48:63], a[40:43], v[84:87], v[48:63]
    ds_read_b128 v[72:75], v4 offset:38912
    buffer_load_dwordx4 a[88:91], v254, s[16:19], s21 offen offset:2048 sc1
    s_waitcnt lgkmcnt(5)
    v_mfma_f32_32x32x16_bf16 v[16:31], a[44:47], v[88:91], v[16:31]
    ds_read_b128 v[76:79], v4 offset:39936
    buffer_load_dwordx4 a[92:95], v254, s[16:19], s21 offen offset:3072 sc1
    s_add_u32 s21, s21, 4096
    s_waitcnt lgkmcnt(5)
    v_mfma_f32_32x32x16_bf16 v[32:47], a[44:47], v[92:95], v[32:47]
    ds_read_b128 v[80:83], v4 offset:40960
    s_waitcnt lgkmcnt(5)
    v_mfma_f32_32x32x16_bf16 v[48:63], a[44:47], v[96:99], v[48:63]
    ds_read_b128 v[84:87], v4 offset:41984
    s_mov_b32 m0, s23
    s_add_u32 s23, s23, 12288
    buffer_load_dwordx4 v10, s[16:19], s22 offen offset:0 sc1 lds
    s_waitcnt lgkmcnt(5)
    v_mfma_f32_32x32x16_bf16 v[16:31], a[48:51], v[64:67], v[16:31]
    ds_read_b128 v[88:91], v4 offset:43008
    s_waitcnt lgkmcnt(5)
    v_mfma_f32_32x32x16_bf16 v[32:47], a[48:51], v[68:71], v[32:47]
    ds_read_b128 v[92:95], v4 offset:44032
    buffer_load_dwordx4 a[96:99], v254, s[16:19], s21 offen offset:0 sc1
    s_waitcnt lgkmcnt(5)
    v_mfma_f32_32x32x16_bf16 v[48:63], a[48:51], v[72:75], v[48:63]
    ds_read_b128 v[96:99], v4 offset:45056
    buffer_load_dwordx4 v11, s[16:19], s22 offen offset:1024 sc1 lds
    s_waitcnt lgkmcnt(5)
    v_mfma_f32_32x32x16_bf16 v[16:31], a[52:55], v[76:79], v[16:31]
    ds_read_b128 v[64:67], v4 offset:46080
    s_waitcnt lgkmcnt(5)
    v_mfma_f32_32x32x16_bf16 v[32:47], a[52:55], v[80:83], v[32:47]
    ds_read_b128 v[68:71], v4 offset:47104
    buffer_load_dwordx4 a[100:103], v254, s[16:19], s21 offen offset:1024 sc1
    s_waitcnt lgkmcnt(5)
    v_mfma_f32_32x32x16_bf16 v[48:63], a[52:55], v[84:87], v[48:63]
    ds_read_b128 v[72:75], v4 offset:48128
    s_waitcnt vmcnt(11)
    s_barrier
    s_waitcnt lgkmcnt(5)
    v_mfma_f32_32x32x16_bf16 v[16:31], a[56:59], v[88:91], v[16:31]
    ds_read_b128 v[76:79], v4 offset:49152
    buffer_load_dwordx4 v12, s[16:19], s22 offen offset:2048 sc1 lds
    s_add_u32 s22, s22, 4096
    s_waitcnt lgkmcnt(5)
    v_mfma_f32_32x32x16_bf16 v[32:47], a[56:59], v[92:95], v[32:47]
    ds_read_b128 v[80:83], v4 offset:50176
    s_waitcnt lgkmcnt(5)
    v_mfma_f32_32x32x16_bf16 v[48:63], a[56:59], v[96:99], v[48:63]
    ds_read_b128 v[84:87], v4 offset:51200
    buffer_load_dwordx4 a[104:107], v254, s[16:19], s21 offen offset:2048 sc1
    s_waitcnt lgkmcnt(5)
    v_mfma_f32_32x32x16_bf16 v[16:31], a[60:63], v[64:67], v[16:31]
    ds_read_b128 v[88:91], v4 offset:52224
    buffer_load_dwordx4 a[108:111], v254, s[16:19], s21 offen offset:3072 sc1
    s_add_u32 s21, s21, 4096
    s_waitcnt lgkmcnt(5)
    v_mfma_f32_32x32x16_bf16 v[32:47], a[60:63], v[68:71], v[32:47]
    ds_read_b128 v[92:95], v4 offset:53248
    s_waitcnt lgkmcnt(5)
    v_mfma_f32_32x32x16_bf16 v[48:63], a[60:63], v[72:75], v[48:63]
    ds_read_b128 v[96:99], v4 offset:54272
    s_mov_b32 m0, s23
    s_add_u32 s23, s23, 12288
    buffer_load_dwordx4 v10, s[16:19], s22 offen offset:0 sc1 lds
    s_waitcnt lgkmcnt(5)
    v_mfma_f32_32x32x16_bf16 v[16:31], a[64:67], v[76:79], v[16:31]
    ds_read_b128 v[64:67], v4 offset:55296
    s_waitcnt lgkmcnt(5)
    v_mfma_f32_32x32x16_bf16 v[32:47], a[64:67], v[80:83], v[32:47]
    ds_read_b128 v[68:71], v4 offset:56320
    buffer_load_dwordx4 a[112:115], v254, s[16:19], s21 offen offset:0 sc1
    s_waitcnt lgkmcnt(5)
    v_mfma_f32_32x32x16_bf16 v[48:63], a[64:67], v[84:87], v[48:63]
    ds_read_b128 v[72:75], v4 offset:57344
    buffer_load_dwordx4 v11, s[16:19], s22 offen offset:1024 sc1 lds
    s_waitcnt lgkmcnt(5)
    v_mfma_f32_32x32x16_bf16 v[16:31], a[68:71], v[88:91], v[16:31]
    ds_read_b128 v[76:79], v4 offset:58368
    s_waitcnt lgkmcnt(5)
    v_mfma_f32_32x32x16_bf16 v[32:47], a[68:71], v[92:95], v[32:47]
    ds_read_b128 v[80:83], v4 offset:59392
    buffer_load_dwordx4 a[116:119], v254, s[16:19], s21 offen offset:1024 sc1
    s_waitcnt lgkmcnt(5)
    v_mfma_f32_32x32x16_bf16 v[48:63], a[68:71], v[96:99], v[48:63]
    ds_read_b128 v[84:87], v4 offset:60416
    s_waitcnt vmcnt(11)
    s_barrier
    s_waitcnt lgkmcnt(5)
    v_mfma_f32_32x32x16_bf16 v[16:31], a[72:75], v[64:67], v[16:31]
    ds_read_b128 v[88:91], v4 offset:61440
    buffer_load_dwordx4 v12, s[16:19], s22 offen offset:2048 sc1 lds
    s_add_u32 s22, s22, 4096
    s_waitcnt lgkmcnt(5)
    v_mfma_f32_32x32x16_bf16 v[32:47], a[72:75], v[68:71], v[32:47]
    ds_read_b128 v[92:95], v4 offset:62464
    s_waitcnt lgkmcnt(5)
    v_mfma_f32_32x32x16_bf16 v[48:63], a[72:75], v[72:75], v[48:63]
    ds_read_b128 v[96:99], v4 offset:63488
    buffer_load_dwordx4 a[120:123], v254, s[16:19], s21 offen offset:2048 sc1
    s_waitcnt lgkmcnt(5)
    v_mfma_f32_32x32x16_bf16 v[16:31], a[76:79], v[76:79], v[16:31]
    ds_read_b128 v[64:67], v4 offset:64512
    buffer_load_dwordx4 a[124:127], v254, s[16:19], s21 offen offset:3072 sc1
    s_add_u32 s21, s21, 4096
    s_waitcnt lgkmcnt(5)
    v_mfma_f32_32x32x16_bf16 v[32:47], a[76:79], v[80:83], v[32:47]
    ds_read_b128 v[68:71], v5 offset:0
    s_waitcnt lgkmcnt(5)
    v_mfma_f32_32x32x16_bf16 v[48:63], a[76:79], v[84:87], v[48:63]
    ds_read_b128 v[72:75], v5 offset:1024
    s_mov_b32 m0, s23
    s_add_u32 s23, s23, 12288
    buffer_load_dwordx4 v10, s[16:19], s22 offen offset:0 sc1 lds
    s_waitcnt lgkmcnt(5)
    v_mfma_f32_32x32x16_bf16 v[16:31], a[80:83], v[88:91], v[16:31]
    ds_read_b128 v[76:79], v5 offset:2048
    s_waitcnt lgkmcnt(5)
    v_mfma_f32_32x32x16_bf16 v[32:47], a[80:83], v[92:95], v[32:47]
    ds_read_b128 v[80:83], v5 offset:3072
    buffer_load_dwordx4 a[128:131], v254, s[16:19], s21 offen offset:0 sc1
    s_waitcnt lgkmcnt(5)
    v_mfma_f32_32x32x16_bf16 v[48:63], a[80:83], v[96:99], v[48:63]
    ds_read_b128 v[84:87], v5 offset:4096
    buffer_load_dwordx4 v11, s[16:19], s22 offen offset:1024 sc1 lds
    s_waitcnt lgkmcnt(5)
    v_mfma_f32_32x32x16_bf16 v[16:31], a[84:87], v[64:67], v[16:31]
    ds_read_b128 v[88:91], v5 offset:5120
    s_waitcnt lgkmcnt(5)
    v_mfma_f32_32x32x16_bf16 v[32:47], a[84:87], v[68:71], v[32:47]
    ds_read_b128 v[92:95], v5 offset:6144
    buffer_load_dwordx4 a[132:135], v254, s[16:19], s21 offen offset:1024 sc1
    s_waitcnt lgkmcnt(5)
    v_mfma_f32_32x32x16_bf16 v[48:63], a[84:87], v[72:75], v[48:63]
    ds_read_b128 v[96:99], v5 offset:7168
    s_waitcnt vmcnt(11)
    s_barrier
    s_waitcnt lgkmcnt(5)
    v_mfma_f32_32x32x16_bf16 v[16:31], a[88:91], v[76:79], v[16:31]
    ds_read_b128 v[64:67], v5 offset:8192
    buffer_load_dwordx4 v12, s[16:19], s22 offen offset:2048 sc1 lds
    s_add_u32 s22, s22, 4096
    s_waitcnt lgkmcnt(5)
    v_mfma_f32_32x32x16_bf16 v[32:47], a[88:91], v[80:83], v[32:47]
    ds_read_b128 v[68:71], v5 offset:9216
    s_waitcnt lgkmcnt(5)
    v_mfma_f32_32x32x16_bf16 v[48:63], a[88:91], v[84:87], v[48:63]
    ds_read_b128 v[72:75], v5 offset:10240
    buffer_load_dwordx4 a[136:139], v254, s[16:19], s21 offen offset:2048 sc1
    s_waitcnt lgkmcnt(5)
    v_mfma_f32_32x32x16_bf16 v[16:31], a[92:95], v[88:91], v[16:31]
    ds_read_b128 v[76:79], v5 offset:11264
    buffer_load_dwordx4 a[140:143], v254, s[16:19], s21 offen offset:3072 sc1
    s_add_u32 s21, s21, 4096
    s_waitcnt lgkmcnt(5)
    v_mfma_f32_32x32x16_bf16 v[32:47], a[92:95], v[92:95], v[32:47]
    ds_read_b128 v[80:83], v5 offset:12288
    s_waitcnt lgkmcnt(5)
    v_mfma_f32_32x32x16_bf16 v[48:63], a[92:95], v[96:99], v[48:63]
    ds_read_b128 v[84:87], v5 offset:13312
    s_mov_b32 m0, s23
    s_add_u32 s23, s23, 12288
    buffer_load_dwordx4 v10, s[16:19], s22 offen offset:0 sc1 lds
    s_waitcnt lgkmcnt(5)
    v_mfma_f32_32x32x16_bf16 v[16:31], a[96:99], v[64:67], v[16:31]
    ds_read_b128 v[88:91], v5 offset:14336
    s_waitcnt lgkmcnt(5)
    v_mfma_f32_32x32x16_bf16 v[32:47], a[96:99], v[68:71], v[32:47]
    ds_read_b128 v[92:95], v5 offset:15360
    buffer_load_dwordx4 a[144:147], v254, s[16:19], s21 offen offset:0 sc1
    s_waitcnt lgkmcnt(5)
    v_mfma_f32_32x32x16_bf16 v[48:63], a[96:99], v[72:75], v[48:63]
    ds_read_b128 v[96:99], v5 offset:16384
    buffer_load_dwordx4 v11, s[16:19], s22 offen offset:1024 sc1 lds
    s_waitcnt lgkmcnt(5)
    v_mfma_f32_32x32x16_bf16 v[16:31], a[100:103], v[76:79], v[16:31]
    ds_read_b128 v[64:67], v5 offset:17408
    s_waitcnt lgkmcnt(5)
    v_mfma_f32_32x32x16_bf16 v[32:47], a[100:103], v[80:83], v[32:47]
    ds_read_b128 v[68:71], v5 offset:18432
    buffer_load_dwordx4 a[148:151], v254, s[16:19], s21 offen offset:1024 sc1
    s_waitcnt lgkmcnt(5)
    v_mfma_f32_32x32x16_bf16 v[48:63], a[100:103], v[84:87], v[48:63]
    ds_read_b128 v[72:75], v5 offset:19456
    s_waitcnt vmcnt(11)
    s_barrier
    s_waitcnt lgkmcnt(5)
    v_mfma_f32_32x32x16_bf16 v[16:31], a[104:107], v[88:91], v[16:31]
    ds_read_b128 v[76:79], v5 offset:20480
    buffer_load_dwordx4 v12, s[16:19], s22 offen offset:2048 sc1 lds
    s_add_u32 s22, s22, 4096
    s_waitcnt lgkmcnt(5)
    v_mfma_f32_32x32x16_bf16 v[32:47], a[104:107], v[92:95], v[32:47]
    ds_read_b128 v[80:83], v5 offset:21504
    s_waitcnt lgkmcnt(5)
    v_mfma_f32_32x32x16_bf16 v[48:63], a[104:107], v[96:99], v[48:63]
    ds_read_b128 v[84:87], v5 offset:22528
    buffer_load_dwordx4 a[152:155], v254, s[16:19], s21 offen offset:2048 sc1
    s_waitcnt lgkmcnt(5)
    v_mfma_f32_32x32x16_bf16 v[16:31], a[108:111], v[64:67], v[16:31]
    ds_read_b128 v[88:91], v5 offset:23552
    buffer_load_dwordx4 a[156:159], v254, s[16:19], s21 offen offset:3072 sc1
    s_add_u32 s21, s21, 4096
    s_waitcnt lgkmcnt(5)
    v_mfma_f32_32x32x16_bf16 v[32:47], a[108:111], v[68:71], v[32:47]
    ds_read_b128 v[92:95], v5 offset:24576
    s_waitcnt lgkmcnt(5)
    v_mfma_f32_32x32x16_bf16 v[48:63], a[108:111], v[72:75], v[48:63]
    ds_read_b128 v[96:99], v5 offset:25600
    s_mov_b32 m0, s23
    s_add_u32 s23, s23, 12288
    buffer_load_dwordx4 v10, s[16:19], s22 offen offset:0 sc1 lds
    s_waitcnt lgkmcnt(5)
    v_mfma_f32_32x32x16_bf16 v[16:31], a[112:115], v[76:79], v[16:31]
    ds_read_b128 v[64:67], v5 offset:26624
    s_waitcnt lgkmcnt(5)
    v_mfma_f32_32x32x16_bf16 v[32:47], a[112:115], v[80:83], v[32:47]
    ds_read_b128 v[68:71], v5 offset:27648
    buffer_load_dwordx4 a[160:163], v254, s[16:19], s21 offen offset:0 sc1
    s_waitcnt lgkmcnt(5)
    v_mfma_f32_32x32x16_bf16 v[48:63], a[112:115], v[84:87], v[48:63]
    ds_read_b128 v[72:75], v5 offset:28672
    buffer_load_dwordx4 v11, s[16:19], s22 offen offset:1024 sc1 lds
    s_waitcnt lgkmcnt(5)
    v_mfma_f32_32x32x16_bf16 v[16:31], a[116:119], v[88:91], v[16:31]
    ds_read_b128 v[76:79], v5 offset:29696
    s_waitcnt lgkmcnt(5)
    v_mfma_f32_32x32x16_bf16 v[32:47], a[116:119], v[92:95], v[32:47]
    ds_read_b128 v[80:83], v5 offset:30720
    buffer_load_dwordx4 a[164:167], v254, s[16:19], s21 offen offset:1024 sc1
    s_waitcnt lgkmcnt(5)
    v_mfma_f32_32x32x16_bf16 v[48:63], a[116:119], v[96:99], v[48:63]
    ds_read_b128 v[84:87], v5 offset:31744
    s_waitcnt vmcnt(11)
    s_barrier
    s_waitcnt lgkmcnt(5)
    v_mfma_f32_32x32x16_bf16 v[16:31], a[120:123], v[64:67], v[16:31]
    ds_read_b128 v[88:91], v5 offset:32768
    buffer_load_dwordx4 v12, s[16:19], s22 offen offset:2048 sc1 lds
    s_add_u32 s22, s22, 4096
    s_waitcnt lgkmcnt(5)
    v_mfma_f32_32x32x16_bf16 v[32:47], a[120:123], v[68:71], v[32:47]
    ds_read_b128 v[92:95], v5 offset:33792
    s_waitcnt lgkmcnt(5)
    v_mfma_f32_32x32x16_bf16 v[48:63], a[120:123], v[72:75], v[48:63]
    ds_read_b128 v[96:99], v5 offset:34816
    buffer_load_dwordx4 a[168:171], v254, s[16:19], s21 offen offset:2048 sc1
    s_waitcnt lgkmcnt(5)
    v_mfma_f32_32x32x16_bf16 v[16:31], a[124:127], v[76:79], v[16:31]
    ds_read_b128 v[64:67], v5 offset:35840
    buffer_load_dwordx4 a[172:175], v254, s[16:19], s21 offen offset:3072 sc1
    s_add_u32 s21, s21, 4096
    s_waitcnt lgkmcnt(5)
    v_mfma_f32_32x32x16_bf16 v[32:47], a[124:127], v[80:83], v[32:47]
    ds_read_b128 v[68:71], v5 offset:36864
    s_waitcnt lgkmcnt(5)
    v_mfma_f32_32x32x16_bf16 v[48:63], a[124:127], v[84:87], v[48:63]
    ds_read_b128 v[72:75], v5 offset:37888
    s_mov_b32 m0, s23
    s_add_u32 s23, s23, 12288
    buffer_load_dwordx4 v10, s[16:19], s22 offen offset:0 sc1 lds
    s_waitcnt lgkmcnt(5)
    v_mfma_f32_32x32x16_bf16 v[16:31], a[128:131], v[88:91], v[16:31]
    ds_read_b128 v[76:79], v5 offset:38912
    s_waitcnt lgkmcnt(5)
    v_mfma_f32_32x32x16_bf16 v[32:47], a[128:131], v[92:95], v[32:47]
    ds_read_b128 v[80:83], v5 offset:39936
    buffer_load_dwordx4 a[176:179], v254, s[16:19], s21 offen offset:0 sc1
    s_waitcnt lgkmcnt(5)
    v_mfma_f32_32x32x16_bf16 v[48:63], a[128:131], v[96:99], v[48:63]
    ds_read_b128 v[84:87], v5 offset:40960
    buffer_load_dwordx4 v11, s[16:19], s22 offen offset:1024 sc1 lds
    s_waitcnt lgkmcnt(5)
    v_mfma_f32_32x32x16_bf16 v[16:31], a[132:135], v[64:67], v[16:31]
    ds_read_b128 v[88:91], v5 offset:41984
    s_waitcnt lgkmcnt(5)
    v_mfma_f32_32x32x16_bf16 v[32:47], a[132:135], v[68:71], v[32:47]
    ds_read_b128 v[92:95], v5 offset:43008
    buffer_load_dwordx4 a[180:183], v254, s[16:19], s21 offen offset:1024 sc1
    s_waitcnt lgkmcnt(5)
    v_mfma_f32_32x32x16_bf16 v[48:63], a[132:135], v[72:75], v[48:63]
    ds_read_b128 v[96:99], v5 offset:44032
    s_waitcnt vmcnt(11)
    s_barrier
    s_waitcnt lgkmcnt(5)
    v_mfma_f32_32x32x16_bf16 v[16:31], a[136:139], v[76:79], v[16:31]
    ds_read_b128 v[64:67], v5 offset:45056
    buffer_load_dwordx4 v12, s[16:19], s22 offen offset:2048 sc1 lds
    s_add_u32 s22, s22, 4096
    s_waitcnt lgkmcnt(5)
    v_mfma_f32_32x32x16_bf16 v[32:47], a[136:139], v[80:83], v[32:47]
    ds_read_b128 v[68:71], v5 offset:46080
    s_waitcnt lgkmcnt(5)
    v_mfma_f32_32x32x16_bf16 v[48:63], a[136:139], v[84:87], v[48:63]
    ds_read_b128 v[72:75], v5 offset:47104
    buffer_load_dwordx4 a[184:187], v254, s[16:19], s21 offen offset:2048 sc1
    s_waitcnt lgkmcnt(5)
    v_mfma_f32_32x32x16_bf16 v[16:31], a[140:143], v[88:91], v[16:31]
    ds_read_b128 v[76:79], v5 offset:48128
    buffer_load_dwordx4 a[188:191], v254, s[16:19], s21 offen offset:3072 sc1
    s_add_u32 s21, s21, 4096
    s_waitcnt lgkmcnt(5)
    v_mfma_f32_32x32x16_bf16 v[32:47], a[140:143], v[92:95], v[32:47]
    ds_read_b128 v[80:83], v5 offset:49152
    s_waitcnt lgkmcnt(5)
    v_mfma_f32_32x32x16_bf16 v[48:63], a[140:143], v[96:99], v[48:63]
    ds_read_b128 v[84:87], v5 offset:50176
    s_waitcnt lgkmcnt(5)
    v_mfma_f32_32x32x16_bf16 v[16:31], a[144:147], v[64:67], v[16:31]
    ds_read_b128 v[88:91], v5 offset:51200
    s_waitcnt lgkmcnt(5)
    v_mfma_f32_32x32x16_bf16 v[32:47], a[144:147], v[68:71], v[32:47]
    ds_read_b128 v[92:95], v5 offset:52224
    s_waitcnt lgkmcnt(5)
    v_mfma_f32_32x32x16_bf16 v[48:63], a[144:147], v[72:75], v[48:63]
    ds_read_b128 v[96:99], v5 offset:53248
    s_waitcnt lgkmcnt(5)
    v_mfma_f32_32x32x16_bf16 v[16:31], a[148:151], v[76:79], v[16:31]
    ds_read_b128 v[64:67], v5 offset:54272
    s_waitcnt lgkmcnt(5)
    v_mfma_f32_32x32x16_bf16 v[32:47], a[148:151], v[80:83], v[32:47]
    ds_read_b128 v[68:71], v5 offset:55296
    s_waitcnt lgkmcnt(5)
    v_mfma_f32_32x32x16_bf16 v[48:63], a[148:151], v[84:87], v[48:63]
    ds_read_b128 v[72:75], v5 offset:56320
    s_waitcnt vmcnt(7)
    s_barrier
    s_waitcnt lgkmcnt(5)
    v_mfma_f32_32x32x16_bf16 v[16:31], a[152:155], v[88:91], v[16:31]
    ds_read_b128 v[76:79], v5 offset:57344
    s_waitcnt lgkmcnt(5)
    v_mfma_f32_32x32x16_bf16 v[32:47], a[152:155], v[92:95], v[32:47]
    ds_read_b128 v[80:83], v5 offset:58368
    s_waitcnt lgkmcnt(5)
    v_mfma_f32_32x32x16_bf16 v[48:63], a[152:155], v[96:99], v[48:63]
    ds_read_b128 v[84:87], v5 offset:59392
    s_waitcnt lgkmcnt(5)
    v_mfma_f32_32x32x16_bf16 v[16:31], a[156:159], v[64:67], v[16:31]
    ds_read_b128 v[88:91], v5 offset:60416
    s_waitcnt lgkmcnt(5)
    v_mfma_f32_32x32x16_bf16 v[32:47], a[156:159], v[68:71], v[32:47]
    ds_read_b128 v[92:95], v5 offset:61440
    s_waitcnt lgkmcnt(5)
    v_mfma_f32_32x32x16_bf16 v[48:63], a[156:159], v[72:75], v[48:63]
    ds_read_b128 v[96:99], v5 offset:62464
    s_waitcnt lgkmcnt(5)
    v_mfma_f32_32x32x16_bf16 v[16:31], a[160:163], v[76:79], v[16:31]
    ds_read_b128 v[64:67], v5 offset:63488
    s_mul_i32 s28, s34, 48*32*1024
    s_sub_u32 s60, s3, 8
    s_mul_i32 s60, s60, 6*32*1024
    s_add_u32 s28, s28, s60
    s_lshl_b32 s60, s35, 2
    s_add_u32 s60, s60, s20
    s_lshl_b32 s60, s60, 10
    s_add_u32 s28, s28, s60
    s_add_u32 s28, s28, 10485760
    s_lshl_b32 s60, s34, 3
    s_add_u32 s60, s60, s3
    s_sub_u32 s60, s60, 8
    s_mul_i32 s60, s60, 1024
    s_lshl_b32 s61, s35, 2
    s_add_u32 s60, s60, s61
    s_add_u32 s64, s60, 18923520
    v_and_b32 v8, 15, v255
    v_lshlrev_b32 v8, 4, v8
    v_lshrrev_b32 v9, 4, v255
    v_and_b32 v9, 1, v9
    v_lshlrev_b32 v9, 15, v9
    v_lshrrev_b32 v10, 5, v255
    v_lshlrev_b32 v10, 9, v10
    v_add3_u32 v7, v8, v9, v10
    s_waitcnt lgkmcnt(5)
    v_mfma_f32_32x32x16_bf16 v[32:47], a[160:163], v[80:83], v[32:47]
    ds_read_b128 v[68:71], v5 offset:64512
    s_waitcnt lgkmcnt(5)
    v_mfma_f32_32x32x16_bf16 v[48:63], a[160:163], v[84:87], v[48:63]
    ds_read_b128 v[72:75], v6 offset:0
    s_waitcnt lgkmcnt(5)
    v_mfma_f32_32x32x16_bf16 v[16:31], a[164:167], v[88:91], v[16:31]
    ds_read_b128 v[76:79], v6 offset:1024
    s_waitcnt lgkmcnt(5)
    v_mfma_f32_32x32x16_bf16 v[32:47], a[164:167], v[92:95], v[32:47]
    ds_read_b128 v[80:83], v6 offset:2048
    s_waitcnt lgkmcnt(5)
    v_mfma_f32_32x32x16_bf16 v[48:63], a[164:167], v[96:99], v[48:63]
    ds_read_b128 v[84:87], v6 offset:3072
    s_waitcnt vmcnt(0)
    s_barrier
    s_waitcnt lgkmcnt(5)
    v_mfma_f32_32x32x16_bf16 v[16:31], a[168:171], v[64:67], v[16:31]
    ds_read_b128 v[88:91], v6 offset:4096
    s_waitcnt lgkmcnt(5)
    v_mfma_f32_32x32x16_bf16 v[32:47], a[168:171], v[68:71], v[32:47]
    ds_read_b128 v[92:95], v6 offset:7168
    s_waitcnt lgkmcnt(5)
    v_mfma_f32_32x32x16_bf16 v[48:63], a[168:171], v[72:75], v[48:63]
    ds_read_b128 v[96:99], v6 offset:10240
    s_waitcnt lgkmcnt(5)
    v_mfma_f32_32x32x16_bf16 v[16:31], a[172:175], v[76:79], v[16:31]
    ds_read_b128 v[64:67], v6 offset:13312
    s_waitcnt lgkmcnt(5)
    v_mfma_f32_32x32x16_bf16 v[32:47], a[172:175], v[80:83], v[32:47]
    ds_read_b128 v[68:71], v6 offset:5120
    s_waitcnt lgkmcnt(5)
    v_mfma_f32_32x32x16_bf16 v[48:63], a[172:175], v[84:87], v[48:63]
    ds_read_b128 v[72:75], v6 offset:8192
    s_waitcnt lgkmcnt(5)
    v_mfma_f32_32x32x16_bf16 v[16:31], a[176:179], v[88:91], v[16:31]
    ds_read_b128 v[76:79], v6 offset:11264
    s_waitcnt lgkmcnt(5)
    v_mfma_f32_32x32x16_bf16 v[16:31], a[180:183], v[92:95], v[16:31]
    ds_read_b128 v[80:83], v6 offset:14336
    s_waitcnt lgkmcnt(5)
    v_mfma_f32_32x32x16_bf16 v[16:31], a[184:187], v[96:99], v[16:31]
    ds_read_b128 v[84:87], v6 offset:6144
    s_waitcnt lgkmcnt(5)
    v_mfma_f32_32x32x16_bf16 v[16:31], a[188:191], v[64:67], v[16:31]
    ds_read_b128 v[88:91], v6 offset:9216
    s_waitcnt lgkmcnt(5)
    v_mfma_f32_32x32x16_bf16 v[32:47], a[176:179], v[68:71], v[32:47]
    ds_read_b128 v[92:95], v6 offset:12288
    s_waitcnt lgkmcnt(5)
    v_mfma_f32_32x32x16_bf16 v[32:47], a[180:183], v[72:75], v[32:47]
    ds_read_b128 v[96:99], v6 offset:15360
    s_nop 1
    v_cvt_pk_bf16_f32 v100, v16, v17
    v_cvt_pk_bf16_f32 v101, v18, v19
    v_cvt_pk_bf16_f32 v102, v20, v21
    v_cvt_pk_bf16_f32 v103, v22, v23
    buffer_store_dwordx4 v[100:103], v7, s[16:19], s28 offen offset:0 sc1
    s_waitcnt lgkmcnt(5)
    v_mfma_f32_32x32x16_bf16 v[32:47], a[184:187], v[76:79], v[32:47]
    v_cvt_pk_bf16_f32 v104, v24, v25
    v_cvt_pk_bf16_f32 v105, v26, v27
    v_cvt_pk_bf16_f32 v106, v28, v29
    v_cvt_pk_bf16_f32 v107, v30, v31
    buffer_store_dwordx4 v[104:107], v7, s[16:19], s28 offen offset:256 sc1
    s_waitcnt lgkmcnt(4)
    v_mfma_f32_32x32x16_bf16 v[32:47], a[188:191], v[80:83], v[32:47]
    s_add_u32 s28, s28, 65536
    s_waitcnt lgkmcnt(3)
    v_mfma_f32_32x32x16_bf16 v[48:63], a[176:179], v[84:87], v[48:63]
    s_waitcnt lgkmcnt(2)
    v_mfma_f32_32x32x16_bf16 v[48:63], a[180:183], v[88:91], v[48:63]
    s_nop 1
    v_cvt_pk_bf16_f32 v108, v32, v33
    v_cvt_pk_bf16_f32 v109, v34, v35
    v_cvt_pk_bf16_f32 v110, v36, v37
    v_cvt_pk_bf16_f32 v111, v38, v39
    buffer_store_dwordx4 v[108:111], v7, s[16:19], s28 offen offset:0 sc1
    s_waitcnt lgkmcnt(1)
    v_mfma_f32_32x32x16_bf16 v[48:63], a[184:187], v[92:95], v[48:63]
    v_cvt_pk_bf16_f32 v112, v40, v41
    v_cvt_pk_bf16_f32 v113, v42, v43
    v_cvt_pk_bf16_f32 v114, v44, v45
    v_cvt_pk_bf16_f32 v115, v46, v47
    buffer_store_dwordx4 v[112:115], v7, s[16:19], s28 offen offset:256 sc1
    s_waitcnt lgkmcnt(0)
    v_mfma_f32_32x32x16_bf16 v[48:63], a[188:191], v[96:99], v[48:63]
    s_add_u32 s28, s28, 65536
    s_nop 7
    s_nop 3
    v_cvt_pk_bf16_f32 v116, v48, v49
    v_cvt_pk_bf16_f32 v117, v50, v51
    v_cvt_pk_bf16_f32 v118, v52, v53
    v_cvt_pk_bf16_f32 v119, v54, v55
    buffer_store_dwordx4 v[116:119], v7, s[16:19], s28 offen offset:0 sc1
    v_cvt_pk_bf16_f32 v120, v56, v57
    v_cvt_pk_bf16_f32 v121, v58, v59
    v_cvt_pk_bf16_f32 v122, v60, v61
    v_cvt_pk_bf16_f32 v123, v62, v63
    buffer_store_dwordx4 v[120:123], v7, s[16:19], s28 offen offset:256 sc1
    s_add_u32 s28, s28, 65536
pb_pub:
    s_mov_b32 s97, s64
    s_mul_i32 s27, s34, 2304
    s_mul_i32 s60, s57, 96
    s_add_u32 s27, s27, s60
    s_mul_i32 s60, s59, 48
    s_add_u32 s27, s27, s60
    s_add_u32 s27, s27, 1536
    s_lshl_b32 s27, s27, 3
    s_add_u32 s27, s27, 131072
    v_lshlrev_b32 v238, 5, v237
    s_lshl_b32 s60, s34, 3
    s_lshr_b32 s61, s36, 1
    s_add_u32 s60, s60, s61
    s_mul_i32 s60, s60, 1024
    s_add_u32 s64, s60, 18907136
    s_lshl_b32 s60, s34, 3
    s_add_u32 s60, s60, s57
    s_mul_i32 s60, s60, 1024
    s_add_u32 s65, s60, 18923520
    s_and_b32 s61, s35, 7
    s_lshl_b32 s61, s61, 7
    s_add_u32 s64, s64, s61
    s_and_b32 s61, s56, 7
    s_lshl_b32 s61, s61, 7
    s_add_u32 s65, s65, s61
    v_and_b32 v3, 7, v255
    v_lshlrev_b32 v3, 2, v3
    v_add_u32 v1, s64, v3
    v_add_u32 v243, s65, v3
    s_lshl_b32 s22, s34, 5
    s_lshl_b32 s60, s36, 1
    s_add_u32 s22, s22, s60
    s_mul_i32 s22, s22, 48*1024
    s_lshl_b32 s60, s20, 11
    s_add_u32 s22, s22, s60
    s_add_u32 s22, s22, 7340032
    v_mov_b32 v10, v254
    v_add_u32 v11, 48128, v254
    v_subrev_u32 v12, 1024, v254
    v_add_u32 v13, 47104, v254
    s_lshl_b32 s23, s20, 12
    v_mov_b32 v4, v254
    v_add_u32 v5, 0x10000, v254
    s_mul_i32 s21, s34, 48
    s_mul_i32 s60, s57, 6
    s_add_u32 s21, s21, s60
    s_mul_i32 s60, s59, 3
    s_add_u32 s21, s21, s60
    s_lshl_b32 s21, s21, 15
    s_lshl_b32 s60, s58, 14
    s_add_u32 s21, s21, s60
    s_add_u32 s21, s21, 10485760
    v_add_u32 v240, 0, v254
    v_add_u32 v241, 32768, v254
    v_add_u32 v242, 65536, v254
    s_mov_b32 s31, 0
    s_mov_b32 s30, 0
    s_mov_b32 s96, s65
    s_lshl_b32 s22, s34, 5
    s_lshl_b32 s60, s36, 1
    s_add_u32 s22, s22, s60
    s_mul_i32 s22, s22, 48*1024
    s_lshl_b32 s23, s20, 10
    s_add_u32 s22, s22, s23
    s_add_u32 s22, s22, 7340032
    s_waitcnt vmcnt(0)
    s_barrier
    s_cmp_eq_u32 s20, 1
    s_cbranch_scc0 pub_skip_28
    v_mov_b32 v1, s37
    v_lshlrev_b32 v2, 7, v255
    s_mov_b64 s[62:63], exec
    s_mov_b64 exec, 255
    buffer_store_dword v1, v2, s[16:19], s97 offen sc1
    s_mov_b64 exec, s[62:63]
pub_skip_28:
    s_cmp_eq_u32 s20, 0
    s_cbranch_scc0 fp_skip_29
    s_load_dwordx8 s[84:91], s[16:17], s64 glc
fp_skip_29:
    s_cmp_eq_u32 s20, 0
    s_cbranch_scc0 sp_done_30
    s_mov_b32 s60, 0
    s_branch sp_chk_32
sp_top_31:
    s_load_dwordx8 s[84:91], s[16:17], s64 glc
    s_add_u32 s60, s60, 1
    s_cmp_gt_u32 s60, 20000
    s_cbranch_scc1 sp_done_30
sp_chk_32:
    s_waitcnt lgkmcnt(0)
    s_and_b64 s[92:93], s[84:85], s[86:87]
    s_and_b64 s[94:95], s[88:89], s[90:91]
    s_and_b64 s[92:93], s[92:93], s[94:95]
    s_or_b64 s[84:85], s[84:85], s[86:87]
    s_or_b64 s[88:89], s[88:89], s[90:91]
    s_or_b64 s[84:85], s[84:85], s[88:89]
    s_and_b32 s92, s92, s93
    s_or_b32 s84, s84, s85
    s_cmp_eq_u32 s92, s37
    s_cbranch_scc0 sp_top_31
    s_cmp_eq_u32 s84, s37
    s_cbranch_scc0 sp_top_31
sp_done_30:
    s_barrier
    s_mov_b32 m0, s23
    s_add_u32 s23, s23, 4096
    buffer_load_dwordx4 v254, s[16:19], s22 offen sc1 lds
    s_add_u32 s22, s22, 4096
    s_mov_b32 m0, s23
    s_add_u32 s23, s23, 4096
    buffer_load_dwordx4 v254, s[16:19], s22 offen sc1 lds
    s_add_u32 s22, s22, 4096
    s_mov_b32 m0, s23
    s_add_u32 s23, s23, 4096
    buffer_load_dwordx4 v254, s[16:19], s22 offen sc1 lds
    s_add_u32 s22, s22, 4096
    s_mov_b32 m0, s23
    s_add_u32 s23, s23, 4096
    buffer_load_dwordx4 v254, s[16:19], s22 offen sc1 lds
    s_add_u32 s22, s22, 4096
    s_mov_b32 m0, s23
    s_add_u32 s23, s23, 4096
    buffer_load_dwordx4 v254, s[16:19], s22 offen sc1 lds
    s_add_u32 s22, s22, 4096
    s_mov_b32 m0, s23
    s_add_u32 s23, s23, 4096
    buffer_load_dwordx4 v254, s[16:19], s22 offen sc1 lds
    s_add_u32 s22, s22, 4096
    s_mov_b32 m0, s23
    s_add_u32 s23, s23, 4096
    buffer_load_dwordx4 v254, s[16:19], s22 offen sc1 lds
    s_add_u32 s22, s22, 4096
    s_mov_b32 m0, s23
    s_add_u32 s23, s23, 4096
    buffer_load_dwordx4 v254, s[16:19], s22 offen sc1 lds
    s_add_u32 s22, s22, 4096
    s_mov_b32 m0, s23
    s_add_u32 s23, s23, 4096
    buffer_load_dwordx4 v254, s[16:19], s22 offen sc1 lds
    s_add_u32 s22, s22, 4096
    s_mov_b32 m0, s23
    s_add_u32 s23, s23, 4096
    buffer_load_dwordx4 v254, s[16:19], s22 offen sc1 lds
    s_add_u32 s22, s22, 4096
    s_mov_b32 m0, s23
    s_add_u32 s23, s23, 4096
    buffer_load_dwordx4 v254, s[16:19], s22 offen sc1 lds
    s_add_u32 s22, s22, 4096
    s_mov_b32 m0, s23
    s_add_u32 s23, s23, 4096
    buffer_load_dwordx4 v254, s[16:19], s22 offen sc1 lds
    s_add_u32 s22, s22, 4096
    buffer_load_dword v244, v243, s[16:19], 0 offen sc1
    buffer_load_dwordx4 v[212:215], v238, s[16:19], s27 offen offset:0 sc1
    buffer_load_dwordx4 v[216:219], v238, s[16:19], s27 offen offset:16 sc1
    buffer_load_dwordx4 v[220:223], v238, s[16:19], s27 offen offset:128 sc1
    buffer_load_dwordx4 v[224:227], v238, s[16:19], s27 offen offset:144 sc1
    buffer_load_dwordx4 v[228:231], v238, s[16:19], s27 offen offset:256 sc1
    buffer_load_dwordx4 v[232:235], v238, s[16:19], s27 offen offset:272 sc1
    s_lshl_b32 s25, s34, 6
    s_lshl_b32 s60, s36, 2
    s_add_u32 s25, s25, s60
    s_lshl_b32 s25, s25, 15
    s_lshl_b32 s60, s35, 2
    s_add_u32 s60, s60, s20
    s_lshl_b32 s60, s60, 10
    s_add_u32 s25, s25, s60
    s_add_u32 s25, s25, 13631488
    s_lshl_b32 s60, s34, 4
    s_add_u32 s60, s60, s36
    s_mul_i32 s60, s60, 1024
    s_lshr_b32 s61, s35, 1
    s_lshl_b32 s61, s61, 4
    s_add_u32 s60, s60, s61
    s_and_b32 s61, s35, 1
    s_lshl_b32 s61, s61, 2
    s_add_u32 s60, s60, s61
    s_add_u32 s97, s60, 18939904
    v_and_b32 v8, 15, v255
    v_lshlrev_b32 v8, 4, v8
    v_lshrrev_b32 v9, 4, v255
    v_and_b32 v9, 1, v9
    v_lshlrev_b32 v9, 15, v9
    v_lshrrev_b32 v10, 5, v255
    v_lshlrev_b32 v10, 9, v10
    v_add3_u32 v7, v8, v9, v10
    s_mov_b32 s24, 0x42200000
    s_waitcnt vmcnt(15)
    s_barrier
    ds_read_b128 v[64:67], v4 offset:0
    ds_read_b128 v[68:71], v4 offset:1024
    ds_read_b128 v[72:75], v4 offset:2048
    ds_read_b128 v[76:79], v4 offset:3072
    ds_read_b128 v[80:83], v4 offset:4096
    ds_read_b128 v[84:87], v4 offset:5120
    s_waitcnt lgkmcnt(5)
    v_mfma_f32_32x32x16_bf16 v[16:31], a[0:3], v[64:67], 0
    ds_read_b128 v[88:91], v4 offset:6144
    s_mov_b32 m0, s23
    s_add_u32 s23, s23, 4096
    buffer_load_dwordx4 v254, s[16:19], s22 offen sc1 lds
    s_add_u32 s22, s22, 4096
    s_waitcnt lgkmcnt(5)
    v_mfma_f32_32x32x16_bf16 v[16:31], a[4:7], v[68:71], v[16:31]
    ds_read_b128 v[64:67], v4 offset:7168
    s_waitcnt lgkmcnt(5)
    v_mfma_f32_32x32x16_bf16 v[16:31], a[8:11], v[72:75], v[16:31]
    ds_read_b128 v[68:71], v4 offset:8192
    s_mov_b32 m0, s23
    s_add_u32 s23, s23, 4096
    buffer_load_dwordx4 v254, s[16:19], s22 offen sc1 lds
    s_add_u32 s22, s22, 4096
    s_waitcnt lgkmcnt(5)
    v_mfma_f32_32x32x16_bf16 v[16:31], a[12:15], v[76:79], v[16:31]
    ds_read_b128 v[72:75], v4 offset:9216
    s_waitcnt lgkmcnt(5)
    v_mfma_f32_32x32x16_bf16 v[16:31], a[16:19], v[80:83], v[16:31]
    ds_read_b128 v[76:79], v4 offset:10240
    s_mov_b32 m0, s23
    s_add_u32 s23, s23, 4096
    buffer_load_dwordx4 v254, s[16:19], s22 offen sc1 lds
    s_add_u32 s22, s22, 4096
    s_waitcnt lgkmcnt(5)
    v_mfma_f32_32x32x16_bf16 v[16:31], a[20:23], v[84:87], v[16:31]
    ds_read_b128 v[80:83], v4 offset:11264
    s_waitcnt lgkmcnt(5)
    v_mfma_f32_32x32x16_bf16 v[16:31], a[24:27], v[88:91], v[16:31]
    ds_read_b128 v[84:87], v4 offset:12288
    s_mov_b32 m0, s23
    s_add_u32 s23, s23, 4096
    buffer_load_dwordx4 v254, s[16:19], s22 offen sc1 lds
    s_add_u32 s22, s22, 4096
    s_waitcnt lgkmcnt(5)
    v_mfma_f32_32x32x16_bf16 v[16:31], a[28:31], v[64:67], v[16:31]
    ds_read_b128 v[88:91], v4 offset:13312
    s_waitcnt lgkmcnt(5)
    v_mfma_f32_32x32x16_bf16 v[16:31], a[32:35], v[68:71], v[16:31]
    ds_read_b128 v[64:67], v4 offset:14336
    s_mov_b32 m0, s23
    s_add_u32 s23, s23, 4096
    buffer_load_dwordx4 v254, s[16:19], s22 offen sc1 lds
    s_add_u32 s22, s22, 4096
    s_waitcnt lgkmcnt(5)
    v_mfma_f32_32x32x16_bf16 v[16:31], a[36:39], v[72:75], v[16:31]
    ds_read_b128 v[68:71], v4 offset:15360
    s_waitcnt vmcnt(16)
    s_barrier
    s_waitcnt lgkmcnt(5)
    v_mfma_f32_32x32x16_bf16 v[16:31], a[40:43], v[76:79], v[16:31]
    ds_read_b128 v[72:75], v4 offset:16384
    s_mov_b32 m0, s23
    s_add_u32 s23, s23, 4096
    buffer_load_dwordx4 v254, s[16:19], s22 offen sc1 lds
    s_add_u32 s22, s22, 4096
    s_waitcnt lgkmcnt(5)
    v_mfma_f32_32x32x16_bf16 v[16:31], a[44:47], v[80:83], v[16:31]
    ds_read_b128 v[76:79], v4 offset:17408
    s_waitcnt lgkmcnt(5)
    v_mfma_f32_32x32x16_bf16 v[16:31], a[48:51], v[84:87], v[16:31]
    ds_read_b128 v[80:83], v4 offset:18432
    s_mov_b32 m0, s23
    s_add_u32 s23, s23, 4096
    buffer_load_dwordx4 v254, s[16:19], s22 offen sc1 lds
    s_add_u32 s22, s22, 4096
    s_waitcnt lgkmcnt(5)
    v_mfma_f32_32x32x16_bf16 v[16:31], a[52:55], v[88:91], v[16:31]
    ds_read_b128 v[84:87], v4 offset:19456
    s_waitcnt lgkmcnt(5)
    v_mfma_f32_32x32x16_bf16 v[16:31], a[56:59], v[64:67], v[16:31]
    ds_read_b128 v[88:91], v4 offset:20480
    s_mov_b32 m0, s23
    s_add_u32 s23, s23, 4096
    buffer_load_dwordx4 v254, s[16:19], s22 offen sc1 lds
    s_add_u32 s22, s22, 4096
    s_waitcnt lgkmcnt(5)
    v_mfma_f32_32x32x16_bf16 v[16:31], a[60:63], v[68:71], v[16:31]
    ds_read_b128 v[64:67], v4 offset:21504
    s_waitcnt lgkmcnt(5)
    v_mfma_f32_32x32x16_bf16 v[16:31], a[64:67], v[72:75], v[16:31]
    ds_read_b128 v[68:71], v4 offset:22528
    s_mov_b32 m0, s23
    s_add_u32 s23, s23, 4096
    buffer_load_dwordx4 v254, s[16:19], s22 offen sc1 lds
    s_add_u32 s22, s22, 4096
    s_waitcnt lgkmcnt(5)
    v_mfma_f32_32x32x16_bf16 v[16:31], a[68:71], v[76:79], v[16:31]
    ds_read_b128 v[72:75], v4 offset:23552
    s_waitcnt lgkmcnt(5)
    v_mfma_f32_32x32x16_bf16 v[16:31], a[72:75], v[80:83], v[16:31]
    ds_read_b128 v[76:79], v4 offset:24576
    s_mov_b32 m0, s23
    s_add_u32 s23, s23, 4096
    buffer_load_dwordx4 v254, s[16:19], s22 offen sc1 lds
    s_add_u32 s22, s22, 4096
    s_waitcnt lgkmcnt(5)
    v_mfma_f32_32x32x16_bf16 v[16:31], a[76:79], v[84:87], v[16:31]
    ds_read_b128 v[80:83], v4 offset:25600
    s_waitcnt lgkmcnt(5)
    v_mfma_f32_32x32x16_bf16 v[16:31], a[80:83], v[88:91], v[16:31]
    ds_read_b128 v[84:87], v4 offset:26624
    s_mov_b32 m0, s23
    s_add_u32 s23, s23, 4096
    buffer_load_dwordx4 v254, s[16:19], s22 offen sc1 lds
    s_add_u32 s22, s22, 4096
    s_waitcnt lgkmcnt(5)
    v_mfma_f32_32x32x16_bf16 v[16:31], a[84:87], v[64:67], v[16:31]
    ds_read_b128 v[88:91], v4 offset:27648
    s_waitcnt lgkmcnt(5)
    v_mfma_f32_32x32x16_bf16 v[16:31], a[88:91], v[68:71], v[16:31]
    ds_read_b128 v[64:67], v4 offset:28672
    s_mov_b32 m0, s23
    s_add_u32 s23, s23, 4096
    buffer_load_dwordx4 v254, s[16:19], s22 offen sc1 lds
    s_add_u32 s22, s22, 4096
    s_waitcnt lgkmcnt(5)
    v_mfma_f32_32x32x16_bf16 v[16:31], a[92:95], v[72:75], v[16:31]
    ds_read_b128 v[68:71], v4 offset:29696
    s_waitcnt lgkmcnt(5)
    v_mfma_f32_32x32x16_bf16 v[16:31], a[96:99], v[76:79], v[16:31]
    ds_read_b128 v[72:75], v4 offset:30720
    s_waitcnt vmcnt(18)
    v_cmp_ne_u32 vcc, s37, v244
    s_cmp_eq_u64 vcc, 0
    s_cbranch_scc1 chk_ok_35
    s_mov_b32 s60, 0
chk_top_36:
    buffer_load_dword v244, v243, s[16:19], 0 offen sc1
    s_add_u32 s60, s60, 1
    s_cmp_gt_u32 s60, 20000
    s_cbranch_scc1 chk_ok_35
    s_waitcnt vmcnt(0)
    v_cmp_ne_u32 vcc, s37, v244
    s_cmp_eq_u64 vcc, 0
    s_cbranch_scc0 chk_top_36
chk_ok_35:
    s_add_u32 s60, s30, 0
    s_and_b32 s60, s60, 15
    s_lshl_b32 s60, s60, 10
    s_add_u32 s28, s21, s60
    buffer_load_dwordx4 a[192:195], v240, s[16:19], s28 offen sc1
    s_waitcnt lgkmcnt(5)
    v_mfma_f32_32x32x16_bf16 v[16:31], a[100:103], v[80:83], v[16:31]
    ds_read_b128 v[76:79], v4 offset:31744
    s_barrier
    s_waitcnt lgkmcnt(5)
    v_mfma_f32_32x32x16_bf16 v[16:31], a[104:107], v[84:87], v[16:31]
    ds_read_b128 v[80:83], v4 offset:32768
    buffer_load_dwordx4 a[196:199], v241, s[16:19], s28 offen sc1
    s_waitcnt lgkmcnt(5)
    v_mfma_f32_32x32x16_bf16 v[16:31], a[108:111], v[88:91], v[16:31]
    ds_read_b128 v[84:87], v4 offset:33792
    s_waitcnt lgkmcnt(5)
    v_mfma_f32_32x32x16_bf16 v[16:31], a[112:115], v[64:67], v[16:31]
    ds_read_b128 v[88:91], v4 offset:34816
    buffer_load_dwordx4 a[200:203], v242, s[16:19], s28 offen sc1
    s_waitcnt lgkmcnt(5)
    v_mfma_f32_32x32x16_bf16 v[16:31], a[116:119], v[68:71], v[16:31]
    ds_read_b128 v[64:67], v4 offset:35840
    s_waitcnt lgkmcnt(5)
    v_mfma_f32_32x32x16_bf16 v[16:31], a[120:123], v[72:75], v[16:31]
    ds_read_b128 v[68:71], v4 offset:36864
    s_add_u32 s60, s30, 1
    s_and_b32 s60, s60, 15
    s_lshl_b32 s60, s60, 10
    s_add_u32 s28, s21, s60
    buffer_load_dwordx4 a[204:207], v240, s[16:19], s28 offen sc1
    s_waitcnt lgkmcnt(5)
    v_mfma_f32_32x32x16_bf16 v[16:31], a[124:127], v[76:79], v[16:31]
    ds_read_b128 v[72:75], v4 offset:37888
    s_waitcnt lgkmcnt(5)
    v_mfma_f32_32x32x16_bf16 v[16:31], a[128:131], v[80:83], v[16:31]
    ds_read_b128 v[76:79], v4 offset:38912
    s_waitcnt lgkmcnt(5)
    v_mfma_f32_32x32x16_bf16 v[16:31], a[132:135], v[84:87], v[16:31]
    ds_read_b128 v[80:83], v4 offset:39936
    s_waitcnt lgkmcnt(5)
    v_mfma_f32_32x32x16_bf16 v[16:31], a[136:139], v[88:91], v[16:31]
    ds_read_b128 v[84:87], v4 offset:40960
    buffer_load_dwordx4 a[208:211], v241, s[16:19], s28 offen sc1
    s_waitcnt lgkmcnt(5)
    v_mfma_f32_32x32x16_bf16 v[16:31], a[140:143], v[64:67], v[16:31]
    ds_read_b128 v[88:91], v4 offset:41984
    s_waitcnt lgkmcnt(5)
    v_mfma_f32_32x32x16_bf16 v[16:31], a[144:147], v[68:71], v[16:31]
    ds_read_b128 v[64:67], v4 offset:43008
    buffer_load_dwordx4 a[212:215], v242, s[16:19], s28 offen sc1
    s_waitcnt lgkmcnt(5)
    v_mfma_f32_32x32x16_bf16 v[16:31], a[148:151], v[72:75], v[16:31]
    ds_read_b128 v[68:71], v4 offset:44032
    s_waitcnt lgkmcnt(5)
    v_mfma_f32_32x32x16_bf16 v[16:31], a[152:155], v[76:79], v[16:31]
    ds_read_b128 v[72:75], v4 offset:45056
    s_add_u32 s60, s30, 2
    s_and_b32 s60, s60, 15
    s_lshl_b32 s60, s60, 10
    s_add_u32 s28, s21, s60
    buffer_load_dwordx4 a[216:219], v240, s[16:19], s28 offen sc1
    s_waitcnt lgkmcnt(5)
    v_mfma_f32_32x32x16_bf16 v[16:31], a[156:159], v[80:83], v[16:31]
    ds_read_b128 v[76:79], v4 offset:46080
    s_waitcnt lgkmcnt(5)
    v_mfma_f32_32x32x16_bf16 v[16:31], a[160:163], v[84:87], v[16:31]
    ds_read_b128 v[80:83], v4 offset:47104
    s_waitcnt lgkmcnt(5)
    v_mfma_f32_32x32x16_bf16 v[16:31], a[164:167], v[88:91], v[16:31]
    ds_read_b128 v[84:87], v4 offset:48128
    s_waitcnt vmcnt(15)
    s_barrier
    s_waitcnt lgkmcnt(5)
    v_mfma_f32_32x32x16_bf16 v[16:31], a[168:171], v[64:67], v[16:31]
    ds_read_b128 v[88:91], v4 offset:49152
    buffer_load_dwordx4 a[220:223], v241, s[16:19], s28 offen sc1
    s_waitcnt lgkmcnt(5)
    v_mfma_f32_32x32x16_bf16 v[16:31], a[172:175], v[68:71], v[16:31]
    ds_read_b128 v[64:67], v4 offset:50176
    s_waitcnt lgkmcnt(5)
    v_mfma_f32_32x32x16_bf16 v[16:31], a[176:179], v[72:75], v[16:31]
    ds_read_b128 v[68:71], v4 offset:51200
    buffer_load_dwordx4 a[224:227], v242, s[16:19], s28 offen sc1
    s_waitcnt lgkmcnt(5)
    v_mfma_f32_32x32x16_bf16 v[16:31], a[180:183], v[76:79], v[16:31]
    ds_read_b128 v[72:75], v4 offset:52224
    s_waitcnt lgkmcnt(5)
    v_mfma_f32_32x32x16_bf16 v[16:31], a[184:187], v[80:83], v[16:31]
    ds_read_b128 v[76:79], v4 offset:53248
    s_add_u32 s60, s30, 3
    s_and_b32 s60, s60, 15
    s_lshl_b32 s60, s60, 10
    s_add_u32 s28, s21, s60
    buffer_load_dwordx4 a[228:231], v240, s[16:19], s28 offen sc1
    s_waitcnt lgkmcnt(5)
    v_mfma_f32_32x32x16_bf16 v[16:31], a[188:191], v[84:87], v[16:31]
    ds_read_b128 v[80:83], v4 offset:54272
    s_waitcnt lgkmcnt(5)
    v_mfma_f32_32x32x16_bf16 v[32:47], a[0:3], v[88:91], 0
    ds_read_b128 v[84:87], v4 offset:55296
    buffer_load_dwordx4 a[232:235], v241, s[16:19], s28 offen sc1
    s_waitcnt lgkmcnt(5)
    v_mfma_f32_32x32x16_bf16 v[32:47], a[4:7], v[64:67], v[32:47]
    ds_read_b128 v[88:91], v4 offset:56320
    s_nop 3
    v_max3_f32 v56, |v16|, |v17|, |v18|
    v_max3_f32 v56, v56, |v19|, |v20|
    s_waitcnt lgkmcnt(5)
    v_mfma_f32_32x32x16_bf16 v[32:47], a[8:11], v[68:71], v[32:47]
    ds_read_b128 v[64:67], v4 offset:57344
    v_max3_f32 v56, v56, |v21|, |v22|
    v_max3_f32 v56, v56, |v23|, |v24|
    s_waitcnt lgkmcnt(5)
    v_mfma_f32_32x32x16_bf16 v[32:47], a[12:15], v[72:75], v[32:47]
    ds_read_b128 v[68:71], v4 offset:58368
    v_max3_f32 v56, v56, |v25|, |v26|
    v_max3_f32 v56, v56, |v27|, |v28|
    s_waitcnt lgkmcnt(5)
    v_mfma_f32_32x32x16_bf16 v[32:47], a[16:19], v[76:79], v[32:47]
    ds_read_b128 v[72:75], v4 offset:59392
    buffer_load_dwordx4 a[236:239], v242, s[16:19], s28 offen sc1
    v_max3_f32 v56, v56, |v29|, |v30|
    v_max_f32 v56, v56, |v31|
    s_waitcnt lgkmcnt(5)
    v_mfma_f32_32x32x16_bf16 v[32:47], a[20:23], v[80:83], v[32:47]
    ds_read_b128 v[76:79], v4 offset:60416
    v_cmp_lt_f32 vcc, s24, v56
    s_cmp_eq_u64 vcc, 0
    s_cbranch_scc0 slowc_34
slowc_back_33:
    s_waitcnt lgkmcnt(5)
    v_mfma_f32_32x32x16_bf16 v[32:47], a[24:27], v[84:87], v[32:47]
    ds_read_b128 v[80:83], v4 offset:61440
    s_add_u32 s60, s30, 4
    s_and_b32 s60, s60, 15
    s_lshl_b32 s60, s60, 10
    s_add_u32 s28, s21, s60
    buffer_load_dwordx4 a[240:243], v240, s[16:19], s28 offen sc1
    v_exp_f32 v16, v16
    s_waitcnt lgkmcnt(5)
    v_mfma_f32_32x32x16_bf16 v[32:47], a[28:31], v[88:91], v[32:47]
    ds_read_b128 v[84:87], v4 offset:62464
    v_exp_f32 v17, v17
    s_waitcnt lgkmcnt(5)
    v_mfma_f32_32x32x16_bf16 v[32:47], a[32:35], v[64:67], v[32:47]
    ds_read_b128 v[88:91], v4 offset:63488
    buffer_load_dwordx4 a[244:247], v241, s[16:19], s28 offen sc1
    v_exp_f32 v18, v18
    s_waitcnt lgkmcnt(5)
    v_mfma_f32_32x32x16_bf16 v[32:47], a[36:39], v[68:71], v[32:47]
    ds_read_b128 v[64:67], v4 offset:64512
    v_exp_f32 v19, v19
    s_waitcnt vmcnt(18)
    s_barrier
    s_waitcnt lgkmcnt(5)
    v_mfma_f32_32x32x16_bf16 v[32:47], a[40:43], v[72:75], v[32:47]
    ds_read_b128 v[68:71], v5 offset:0
    v_exp_f32 v20, v20
    s_waitcnt lgkmcnt(5)
    v_mfma_f32_32x32x16_bf16 v[32:47], a[44:47], v[76:79], v[32:47]
    ds_read_b128 v[72:75], v5 offset:1024
    v_exp_f32 v21, v21
    s_waitcnt lgkmcnt(5)
    v_mfma_f32_32x32x16_bf16 v[32:47], a[48:51], v[80:83], v[32:47]
    ds_read_b128 v[76:79], v5 offset:2048
    buffer_load_dwordx4 a[248:251], v242, s[16:19], s28 offen sc1
    v_exp_f32 v22, v22
    s_waitcnt lgkmcnt(5)
    v_mfma_f32_32x32x16_bf16 v[32:47], a[52:55], v[84:87], v[32:47]
    ds_read_b128 v[80:83], v5 offset:3072
    v_exp_f32 v23, v23
    s_waitcnt lgkmcnt(5)
    v_mfma_f32_32x32x16_bf16 v[32:47], a[56:59], v[88:91], v[32:47]
    ds_read_b128 v[84:87], v5 offset:4096
    s_add_u32 s60, s30, 5
    s_and_b32 s60, s60, 15
    s_lshl_b32 s60, s60, 10
    s_add_u32 s28, s21, s60
    buffer_load_dwordx4 a[252:255], v240, s[16:19], s28 offen sc1
    v_exp_f32 v24, v24
    s_waitcnt lgkmcnt(5)
    v_mfma_f32_32x32x16_bf16 v[32:47], a[60:63], v[64:67], v[32:47]
    ds_read_b128 v[88:91], v5 offset:5120
    v_exp_f32 v25, v25
    s_waitcnt lgkmcnt(5)
    v_mfma_f32_32x32x16_bf16 v[32:47], a[64:67], v[68:71], v[32:47]
    ds_read_b128 v[64:67], v5 offset:6144
    buffer_load_dwordx4 v[104:107], v241, s[16:19], s28 offen sc1
    v_exp_f32 v26, v26
    s_waitcnt lgkmcnt(5)
    v_mfma_f32_32x32x16_bf16 v[32:47], a[68:71], v[72:75], v[32:47]
    ds_read_b128 v[68:71], v5 offset:7168
    v_exp_f32 v27, v27
    s_waitcnt lgkmcnt(5)
    v_mfma_f32_32x32x16_bf16 v[32:47], a[72:75], v[76:79], v[32:47]
    ds_read_b128 v[72:75], v5 offset:8192
    buffer_load_dwordx4 v[108:111], v242, s[16:19], s28 offen sc1
    v_exp_f32 v28, v28
    s_waitcnt lgkmcnt(5)
    v_mfma_f32_32x32x16_bf16 v[32:47], a[76:79], v[80:83], v[32:47]
    ds_read_b128 v[76:79], v5 offset:9216
    v_exp_f32 v29, v29
    s_waitcnt lgkmcnt(5)
    v_mfma_f32_32x32x16_bf16 v[32:47], a[80:83], v[84:87], v[32:47]
    ds_read_b128 v[80:83], v5 offset:10240
    v_exp_f32 v30, v30
    s_waitcnt lgkmcnt(5)
    v_mfma_f32_32x32x16_bf16 v[32:47], a[84:87], v[88:91], v[32:47]
    ds_read_b128 v[84:87], v5 offset:11264
    v_exp_f32 v31, v31
    s_waitcnt lgkmcnt(5)
    v_mfma_f32_32x32x16_bf16 v[32:47], a[88:91], v[64:67], v[32:47]
    ds_read_b128 v[88:91], v5 offset:12288
    s_add_u32 s60, s30, 6
    s_and_b32 s60, s60, 15
    s_lshl_b32 s60, s60, 10
    s_add_u32 s28, s21, s60
    buffer_load_dwordx4 v[112:115], v240, s[16:19], s28 offen sc1
    v_cvt_pk_bf16_f32 v48, v16, v17
    v_cvt_pk_bf16_f32 v49, v18, v19
    s_waitcnt lgkmcnt(5)
    v_mfma_f32_32x32x16_bf16 v[32:47], a[92:95], v[68:71], v[32:47]
    ds_read_b128 v[64:67], v5 offset:13312
    v_cvt_pk_bf16_f32 v50, v20, v21
    v_cvt_pk_bf16_f32 v51, v22, v23
    s_waitcnt lgkmcnt(5)
    v_mfma_f32_32x32x16_bf16 v[32:47], a[96:99], v[72:75], v[32:47]
    ds_read_b128 v[68:71], v5 offset:14336
    buffer_load_dwordx4 v[116:119], v241, s[16:19], s28 offen sc1
    buffer_store_dwordx4 v[48:51], v7, s[16:19], s25 offen offset:0 sc1
    v_cvt_pk_bf16_f32 v52, v24, v25
    s_waitcnt lgkmcnt(5)
    v_mfma_f32_32x32x16_bf16 v[32:47], a[100:103], v[76:79], v[32:47]
    ds_read_b128 v[72:75], v5 offset:15360
    v_cvt_pk_bf16_f32 v53, v26, v27
    v_cvt_pk_bf16_f32 v54, v28, v29
    s_waitcnt vmcnt(21)
    s_barrier
    s_waitcnt lgkmcnt(5)
    v_mfma_f32_32x32x16_bf16 v[32:47], a[104:107], v[80:83], v[32:47]
    ds_read_b128 v[76:79], v5 offset:16384
    buffer_load_dwordx4 v[120:123], v242, s[16:19], s28 offen sc1
    v_cvt_pk_bf16_f32 v55, v30, v31
    buffer_store_dwordx4 v[52:55], v7, s[16:19], s25 offen offset:256 sc1
    s_waitcnt lgkmcnt(5)
    v_mfma_f32_32x32x16_bf16 v[32:47], a[108:111], v[84:87], v[32:47]
    ds_read_b128 v[80:83], v5 offset:17408
    s_waitcnt lgkmcnt(5)
    v_mfma_f32_32x32x16_bf16 v[32:47], a[112:115], v[88:91], v[32:47]
    ds_read_b128 v[84:87], v5 offset:18432
    s_waitcnt lgkmcnt(5)
    v_mfma_f32_32x32x16_bf16 v[32:47], a[116:119], v[64:67], v[32:47]
    ds_read_b128 v[88:91], v5 offset:19456
    s_waitcnt lgkmcnt(5)
    v_mfma_f32_32x32x16_bf16 v[32:47], a[120:123], v[68:71], v[32:47]
    ds_read_b128 v[64:67], v5 offset:20480
    s_add_u32 s60, s30, 7
    s_and_b32 s60, s60, 15
    s_lshl_b32 s60, s60, 10
    s_add_u32 s28, s21, s60
    buffer_load_dwordx4 v[124:127], v240, s[16:19], s28 offen sc1
    s_waitcnt lgkmcnt(5)
    v_mfma_f32_32x32x16_bf16 v[32:47], a[124:127], v[72:75], v[32:47]
    ds_read_b128 v[68:71], v5 offset:21504
    s_waitcnt lgkmcnt(5)
    v_mfma_f32_32x32x16_bf16 v[32:47], a[128:131], v[76:79], v[32:47]
    ds_read_b128 v[72:75], v5 offset:22528
    buffer_load_dwordx4 v[128:131], v241, s[16:19], s28 offen sc1
    s_waitcnt lgkmcnt(5)
    v_mfma_f32_32x32x16_bf16 v[32:47], a[132:135], v[80:83], v[32:47]
    ds_read_b128 v[76:79], v5 offset:23552
    s_waitcnt lgkmcnt(5)
    v_mfma_f32_32x32x16_bf16 v[32:47], a[136:139], v[84:87], v[32:47]
    ds_read_b128 v[80:83], v5 offset:24576
    buffer_load_dwordx4 v[132:135], v242, s[16:19], s28 offen sc1
    s_waitcnt lgkmcnt(5)
    v_mfma_f32_32x32x16_bf16 v[32:47], a[140:143], v[88:91], v[32:47]
    ds_read_b128 v[84:87], v5 offset:25600
    s_waitcnt lgkmcnt(5)
    v_mfma_f32_32x32x16_bf16 v[32:47], a[144:147], v[64:67], v[32:47]
    ds_read_b128 v[88:91], v5 offset:26624
    s_add_u32 s60, s30, 8
    s_and_b32 s60, s60, 15
    s_lshl_b32 s60, s60, 10
    s_add_u32 s28, s21, s60
    buffer_load_dwordx4 v[136:139], v240, s[16:19], s28 offen sc1
    s_waitcnt lgkmcnt(5)
    v_mfma_f32_32x32x16_bf16 v[32:47], a[148:151], v[68:71], v[32:47]
    ds_read_b128 v[64:67], v5 offset:27648
    s_waitcnt lgkmcnt(5)
    v_mfma_f32_32x32x16_bf16 v[32:47], a[152:155], v[72:75], v[32:47]
    ds_read_b128 v[68:71], v5 offset:28672
    s_waitcnt lgkmcnt(5)
    v_mfma_f32_32x32x16_bf16 v[32:47], a[156:159], v[76:79], v[32:47]
    ds_read_b128 v[72:75], v5 offset:29696
    s_waitcnt lgkmcnt(5)
    v_mfma_f32_32x32x16_bf16 v[32:47], a[160:163], v[80:83], v[32:47]
    ds_read_b128 v[76:79], v5 offset:30720
    buffer_load_dwordx4 v[140:143], v241, s[16:19], s28 offen sc1
    s_waitcnt lgkmcnt(5)
    v_mfma_f32_32x32x16_bf16 v[32:47], a[164:167], v[84:87], v[32:47]
    ds_read_b128 v[80:83], v5 offset:31744
    s_waitcnt lgkmcnt(5)
    v_mfma_f32_32x32x16_bf16 v[32:47], a[168:171], v[88:91], v[32:47]
    buffer_load_dwordx4 v[144:147], v242, s[16:19], s28 offen sc1
    s_waitcnt lgkmcnt(4)
    v_mfma_f32_32x32x16_bf16 v[32:47], a[172:175], v[64:67], v[32:47]
    s_waitcnt lgkmcnt(3)
    v_mfma_f32_32x32x16_bf16 v[32:47], a[176:179], v[68:71], v[32:47]
    s_add_u32 s60, s30, 9
    s_and_b32 s60, s60, 15
    s_lshl_b32 s60, s60, 10
    s_add_u32 s28, s21, s60
    buffer_load_dwordx4 v[148:151], v240, s[16:19], s28 offen sc1
    s_waitcnt lgkmcnt(2)
    v_mfma_f32_32x32x16_bf16 v[32:47], a[180:183], v[72:75], v[32:47]
    s_waitcnt lgkmcnt(1)
    v_mfma_f32_32x32x16_bf16 v[32:47], a[184:187], v[76:79], v[32:47]
    s_waitcnt lgkmcnt(0)
    v_mfma_f32_32x32x16_bf16 v[32:47], a[188:191], v[80:83], v[32:47]
    s_add_u32 s25, s25, 65536
    s_nop 7
    s_nop 3
    v_max3_f32 v56, |v32|, |v33|, |v34|
    v_max3_f32 v56, v56, |v35|, |v36|
    v_max3_f32 v56, v56, |v37|, |v38|
    v_max3_f32 v56, v56, |v39|, |v40|
    v_max3_f32 v56, v56, |v41|, |v42|
    v_max3_f32 v56, v56, |v43|, |v44|
    v_max3_f32 v56, v56, |v45|, |v46|
    v_max_f32 v56, v56, |v47|
    v_cmp_lt_f32 vcc, s24, v56
    s_cmp_eq_u64 vcc, 0
    s_cbranch_scc0 slowc_38
slowc_back_37:
    v_exp_f32 v32, v32
    v_exp_f32 v33, v33
    v_exp_f32 v34, v34
    v_exp_f32 v35, v35
    v_exp_f32 v36, v36
    v_exp_f32 v37, v37
    v_exp_f32 v38, v38
    v_exp_f32 v39, v39
    v_exp_f32 v40, v40
    v_exp_f32 v41, v41
    v_exp_f32 v42, v42
    v_exp_f32 v43, v43
    v_exp_f32 v44, v44
    v_exp_f32 v45, v45
    v_exp_f32 v46, v46
    v_exp_f32 v47, v47
    v_cvt_pk_bf16_f32 v56, v32, v33
    v_cvt_pk_bf16_f32 v57, v34, v35
    v_cvt_pk_bf16_f32 v58, v36, v37
    v_cvt_pk_bf16_f32 v59, v38, v39
    buffer_store_dwordx4 v[56:59], v7, s[16:19], s25 offen offset:0 sc1
    v_cvt_pk_bf16_f32 v60, v40, v41
    v_cvt_pk_bf16_f32 v61, v42, v43
    v_cvt_pk_bf16_f32 v62, v44, v45
    v_cvt_pk_bf16_f32 v63, v46, v47
    buffer_store_dwordx4 v[60:63], v7, s[16:19], s25 offen offset:256 sc1
    buffer_load_dwordx4 v[152:155], v241, s[16:19], s28 offen sc1
    buffer_load_dwordx4 v[156:159], v242, s[16:19], s28 offen sc1
    s_add_u32 s60, s30, 10
    s_and_b32 s60, s60, 15
    s_lshl_b32 s60, s60, 10
    s_add_u32 s28, s21, s60
    buffer_load_dwordx4 v[160:163], v240, s[16:19], s28 offen sc1
    buffer_load_dwordx4 v[164:167], v241, s[16:19], s28 offen sc1
    buffer_load_dwordx4 v[168:171], v242, s[16:19], s28 offen sc1
    s_add_u32 s60, s30, 11
    s_and_b32 s60, s60, 15
    s_lshl_b32 s60, s60, 10
    s_add_u32 s28, s21, s60
    buffer_load_dwordx4 v[172:175], v240, s[16:19], s28 offen sc1
    buffer_load_dwordx4 v[176:179], v241, s[16:19], s28 offen sc1
    buffer_load_dwordx4 v[180:183], v242, s[16:19], s28 offen sc1
    s_lshl_b32 s60, s34, 4
    s_add_u32 s60, s60, s56
    s_mul_i32 s60, s60, 1024
    s_add_u32 s64, s60, 18939904
    s_and_b32 s61, s57, 7
    s_lshl_b32 s61, s61, 7
    s_add_u32 s64, s64, s61
    v_and_b32 v1, 7, v255
    v_lshlrev_b32 v1, 2, v1
    v_add_u32 v1, s64, v1
    s_lshl_b32 s22, s34, 6
    s_lshl_b32 s60, s56, 2
    s_add_u32 s22, s22, s60
    s_lshl_b32 s22, s22, 15
    s_lshl_b32 s60, s58, 4
    s_add_u32 s60, s60, s59
    s_lshl_b32 s23, s60, 12
    s_lshl_b32 s60, s60, 10
    s_add_u32 s22, s22, s60
    s_add_u32 s22, s22, 13631488
    v_add_u32 v10, 0, v254
    v_add_u32 v11, 31744, v254
    v_add_u32 v12, 63488, v254
    v_add_u32 v13, 95232, v254
    s_lshl_b32 s60, s58, 16
    s_lshl_b32 s61, s58, 11
    s_add_u32 s61, s60, s61
    v_add_u32 v8, s61, v254
    s_xor_b32 s61, s58, 1
    s_lshl_b32 s61, s61, 11
    s_add_u32 s61, s60, s61
    v_add_u32 v9, s61, v254
    v_mov_b32 v4, 0x3f803f80
    v_mov_b32 v5, 0x3f803f80
    v_mov_b32 v6, 0x3f803f80
    v_mov_b32 v7, 0x3f803f80
    s_mov_b32 s60, 0
gate_top_39:
    v_cmp_ne_u32 vcc, s37, v213
    v_cmp_ne_u32 s[62:63], s37, v215
    s_or_b64 vcc, vcc, s[62:63]
    v_cmp_ne_u32 s[62:63], s37, v217
    s_or_b64 vcc, vcc, s[62:63]
    v_cmp_ne_u32 s[62:63], s37, v219
    s_or_b64 vcc, vcc, s[62:63]
    v_cmp_ne_u32 s[62:63], s37, v221
    s_or_b64 vcc, vcc, s[62:63]
    v_cmp_ne_u32 s[62:63], s37, v223
    s_or_b64 vcc, vcc, s[62:63]
    v_cmp_ne_u32 s[62:63], s37, v225
    s_or_b64 vcc, vcc, s[62:63]
    v_cmp_ne_u32 s[62:63], s37, v227
    s_or_b64 vcc, vcc, s[62:63]
    v_cmp_ne_u32 s[62:63], s37, v229
    s_or_b64 vcc, vcc, s[62:63]
    v_cmp_ne_u32 s[62:63], s37, v231
    s_or_b64 vcc, vcc, s[62:63]
    v_cmp_ne_u32 s[62:63], s37, v233
    s_or_b64 vcc, vcc, s[62:63]
    v_cmp_ne_u32 s[62:63], s37, v235
    s_or_b64 vcc, vcc, s[62:63]
    s_cmp_eq_u64 vcc, 0
    s_cbranch_scc1 gate_done_40
    s_add_u32 s60, s60, 1
    s_cmp_gt_u32 s60, 20000
    s_cbranch_scc1 gate_done_40
    buffer_load_dwordx4 v[212:215], v238, s[16:19], s27 offen offset:0 sc1
    buffer_load_dwordx4 v[216:219], v238, s[16:19], s27 offen offset:16 sc1
    buffer_load_dwordx4 v[220:223], v238, s[16:19], s27 offen offset:128 sc1
    buffer_load_dwordx4 v[224:227], v238, s[16:19], s27 offen offset:144 sc1
    buffer_load_dwordx4 v[228:231], v238, s[16:19], s27 offen offset:256 sc1
    buffer_load_dwordx4 v[232:235], v238, s[16:19], s27 offen offset:272 sc1
    s_waitcnt vmcnt(0)
    s_branch gate_top_39
gate_done_40:
    v_mov_b32 v213, v214
    v_mov_b32 v214, v216
    v_mov_b32 v215, v218
    v_mov_b32 v216, v220
    v_mov_b32 v217, v222
    v_mov_b32 v218, v224
    v_mov_b32 v219, v226
    v_mov_b32 v220, v228
    v_mov_b32 v221, v230
    v_mov_b32 v222, v232
    v_mov_b32 v223, v234
    s_mov_b32 s61, 0xffff0000
    v_lshlrev_b32 v224, 16, v200
    v_and_b32 v225, s61, v200
    v_lshlrev_b32 v226, 16, v201
    v_and_b32 v227, s61, v201
    v_lshlrev_b32 v228, 16, v202
    v_and_b32 v229, s61, v202
    v_lshlrev_b32 v230, 16, v203
    v_and_b32 v231, s61, v203
    v_lshlrev_b32 v232, 16, v204
    v_and_b32 v233, s61, v204
    v_lshlrev_b32 v234, 16, v205
    v_and_b32 v235, s61, v205
    v_lshlrev_b32 v200, 16, v206
    v_and_b32 v201, s61, v206
    v_lshlrev_b32 v202, 16, v207
    v_and_b32 v203, s61, v207
    v_lshlrev_b32 v204, 16, v208
    v_and_b32 v205, s61, v208
    v_lshlrev_b32 v206, 16, v209
    v_and_b32 v207, s61, v209
    v_lshlrev_b32 v208, 16, v210
    v_and_b32 v209, s61, v210
    v_lshlrev_b32 v210, 16, v211
    v_and_b32 v211, s61, v211
    s_waitcnt vmcnt(8)
    s_barrier
    s_cmp_eq_u32 s20, 1
    s_cbranch_scc0 pub_skip_41
    v_mov_b32 v1, s37
    v_lshlrev_b32 v2, 7, v255
    s_mov_b64 s[62:63], exec
    s_mov_b64 exec, 255
    buffer_store_dword v1, v2, s[16:19], s97 offen sc1
    s_mov_b64 exec, s[62:63]
pub_skip_41:
    s_cmp_eq_u32 s20, 0
    s_cbranch_scc0 fp_skip_42
    s_load_dwordx16 s[84:99], s[16:17], s64 glc
fp_skip_42:
    s_add_u32 s60, s30, 12
    s_and_b32 s60, s60, 15
    s_lshl_b32 s60, s60, 10
    s_add_u32 s28, s21, s60
    buffer_load_dwordx4 v[184:187], v240, s[16:19], s28 offen sc1
    buffer_load_dwordx4 v[188:191], v241, s[16:19], s28 offen sc1
    buffer_load_dwordx4 v[192:195], v242, s[16:19], s28 offen sc1
    s_add_u32 s60, s30, 13
    s_and_b32 s60, s60, 15
    s_lshl_b32 s60, s60, 10
    s_add_u32 s28, s21, s60
    buffer_load_dwordx4 v[196:199], v240, s[16:19], s28 offen sc1
    buffer_load_dwordx4 a[0:3], v241, s[16:19], s28 offen sc1
    buffer_load_dwordx4 a[4:7], v242, s[16:19], s28 offen sc1
    s_add_u32 s60, s30, 14
    s_and_b32 s60, s60, 15
    s_lshl_b32 s60, s60, 10
    s_add_u32 s28, s21, s60
    buffer_load_dwordx4 a[8:11], v240, s[16:19], s28 offen sc1
    buffer_load_dwordx4 a[12:15], v241, s[16:19], s28 offen sc1
    buffer_load_dwordx4 a[16:19], v242, s[16:19], s28 offen sc1
    s_add_u32 s60, s30, 15
    s_and_b32 s60, s60, 15
    s_lshl_b32 s60, s60, 10
    s_add_u32 s28, s21, s60
    buffer_load_dwordx4 a[20:23], v240, s[16:19], s28 offen sc1
    buffer_load_dwordx4 a[24:27], v241, s[16:19], s28 offen sc1
    buffer_load_dwordx4 a[28:31], v242, s[16:19], s28 offen sc1
    v_mov_b32 v2, 163824
    s_cmp_eq_u32 s20, 0
    s_cbranch_scc0 sp_done_43
    s_mov_b32 s60, 0
    s_branch sp_chk_45
sp_top_44:
    s_load_dwordx16 s[84:99], s[16:17], s64 glc
    s_add_u32 s60, s60, 1
    s_cmp_gt_u32 s60, 20000
    s_cbranch_scc1 sp_done_43
sp_chk_45:
    s_waitcnt lgkmcnt(0)
    s_and_b64 s[62:63], s[84:85], s[88:89]
    s_and_b64 s[24:25], s[92:93], s[96:97]
    s_and_b64 s[62:63], s[62:63], s[24:25]
    s_or_b64 s[24:25], s[84:85], s[88:89]
    s_or_b64 s[28:29], s[92:93], s[96:97]
    s_or_b64 s[24:25], s[24:25], s[28:29]
    s_and_b32 s62, s62, s63
    s_or_b32 s24, s24, s25
    s_cmp_eq_u32 s62, s37
    s_cbranch_scc0 sp_top_44
    s_cmp_eq_u32 s24, s37
    s_cbranch_scc0 sp_top_44
sp_done_43:
    s_waitcnt lgkmcnt(0)
    s_barrier
    s_mov_b32 s28, 8192
    s_add_u32 s60, s31, 0
    s_and_b32 s60, s60, 7
    s_lshl_b32 s60, s60, 11
    s_add_u32 s29, s22, s60
    s_mov_b32 m0, s23
    s_add_u32 s23, s23, s28
    buffer_load_dwordx4 v10, s[16:19], s29 offen offset:0 sc1 lds
    buffer_load_dwordx4 v11, s[16:19], s29 offen offset:1024 sc1 lds
    buffer_load_dwordx4 v12, s[16:19], s29 offen offset:2048 sc1 lds
    buffer_load_dwordx4 v13, s[16:19], s29 offen offset:3072 sc1 lds
    s_add_u32 s60, s31, 1
    s_and_b32 s60, s60, 7
    s_lshl_b32 s60, s60, 11
    s_add_u32 s29, s22, s60
    s_mov_b32 m0, s23
    s_add_u32 s23, s23, s28
    buffer_load_dwordx4 v10, s[16:19], s29 offen offset:0 sc1 lds
    buffer_load_dwordx4 v11, s[16:19], s29 offen offset:1024 sc1 lds
    buffer_load_dwordx4 v12, s[16:19], s29 offen offset:2048 sc1 lds
    buffer_load_dwordx4 v13, s[16:19], s29 offen offset:3072 sc1 lds
    s_add_u32 s60, s31, 2
    s_and_b32 s60, s60, 7
    s_lshl_b32 s60, s60, 11
    s_add_u32 s29, s22, s60
    s_mov_b32 m0, s23
    s_add_u32 s23, s23, s28
    buffer_load_dwordx4 v10, s[16:19], s29 offen offset:0 sc1 lds
    buffer_load_dwordx4 v11, s[16:19], s29 offen offset:1024 sc1 lds
    buffer_load_dwordx4 v12, s[16:19], s29 offen offset:2048 sc1 lds
    buffer_load_dwordx4 v13, s[16:19], s29 offen offset:3072 sc1 lds
    s_cmp_eq_u32 s20, 0
    s_cbranch_scc0 mark_skip_46
    s_mov_b32 s24, 0
    s_cmp_eq_u32 s86, s37
    s_cselect_b32 s24, 1, s24
    s_cmp_eq_u32 s87, s37
    s_cselect_b32 s24, 1, s24
    s_cmp_eq_u32 s90, s37
    s_cselect_b32 s24, 1, s24
    s_cmp_eq_u32 s91, s37
    s_cselect_b32 s24, 1, s24
    s_cmp_eq_u32 s94, s37
    s_cselect_b32 s24, 1, s24
    s_cmp_eq_u32 s95, s37
    s_cselect_b32 s24, 1, s24
    s_cmp_eq_u32 s98, s37
    s_cselect_b32 s24, 1, s24
    s_cmp_eq_u32 s99, s37
    s_cselect_b32 s24, 1, s24
    v_mov_b32 v1, s24
    ds_write_b32 v2, v1
    s_waitcnt lgkmcnt(0)
mark_skip_46:
    s_waitcnt vmcnt(8)
    s_barrier
    ds_read_b32 v1, v2
    ds_read_b128 v[72:75], v8 offset:0
    ds_read_b128 v[76:79], v8 offset:1024
    ds_read_b128 v[80:83], v9 offset:0
    ds_read_b128 v[84:87], v9 offset:1024
    s_waitcnt lgkmcnt(4)
    v_readfirstlane_b32 s60, v1
    s_nop 0
    s_cmp_lg_u32 s60, 0
    s_cbranch_scc1 slowd_48
slowd_back_47:
    s_cmp_eq_u32 s59, 0
    s_cbranch_scc0 pd_nh1
    s_waitcnt lgkmcnt(3)
    v_mfma_f32_16x16x32_bf16 v[16:19], a[192:195], v[72:75], 0
    ds_read_b128 v[88:91], v8 offset:4096
    v_mfma_f32_16x16x32_bf16 v[20:23], a[196:199], v[72:75], 0
    v_mfma_f32_16x16x32_bf16 v[24:27], a[200:203], v[72:75], 0
    v_mfma_f32_16x16x32_bf16 v[64:67], v[4:7], v[72:75], 0
    s_add_u32 s60, s31, 3
    s_and_b32 s60, s60, 7
    s_lshl_b32 s60, s60, 11
    s_add_u32 s29, s22, s60
    s_mov_b32 m0, s23
    s_add_u32 s23, s23, s28
    buffer_load_dwordx4 v10, s[16:19], s29 offen offset:0 sc1 lds
    s_waitcnt lgkmcnt(3)
    v_mfma_f32_16x16x32_bf16 v[28:31], a[192:195], v[76:79], 0
    ds_read_b128 v[92:95], v8 offset:5120
    v_mfma_f32_16x16x32_bf16 v[32:35], a[196:199], v[76:79], 0
    v_mfma_f32_16x16x32_bf16 v[36:39], a[200:203], v[76:79], 0
    v_mfma_f32_16x16x32_bf16 v[68:71], v[4:7], v[76:79], 0
    s_waitcnt lgkmcnt(3)
    v_mfma_f32_16x16x32_bf16 v[40:43], a[192:195], v[80:83], 0
    ds_read_b128 v[96:99], v9 offset:4096
    v_mfma_f32_16x16x32_bf16 v[44:47], a[196:199], v[80:83], 0
    v_mfma_f32_16x16x32_bf16 v[48:51], a[200:203], v[80:83], 0
    buffer_load_dwordx4 v11, s[16:19], s29 offen offset:1024 sc1 lds
    s_waitcnt lgkmcnt(3)
    v_mfma_f32_16x16x32_bf16 v[52:55], a[192:195], v[84:87], 0
    ds_read_b128 v[100:103], v9 offset:5120
    v_mfma_f32_16x16x32_bf16 v[56:59], a[196:199], v[84:87], 0
    v_mfma_f32_16x16x32_bf16 v[60:63], a[200:203], v[84:87], 0
    s_waitcnt vmcnt(6)
    s_barrier
    s_waitcnt lgkmcnt(3)
    v_mfma_f32_16x16x32_bf16 v[16:19], a[204:207], v[88:91], v[16:19]
    ds_read_b128 v[72:75], v8 offset:8192
    v_mfma_f32_16x16x32_bf16 v[20:23], a[208:211], v[88:91], v[20:23]
    v_mfma_f32_16x16x32_bf16 v[24:27], a[212:215], v[88:91], v[24:27]
    v_mfma_f32_16x16x32_bf16 v[64:67], v[4:7], v[88:91], v[64:67]
    buffer_load_dwordx4 v12, s[16:19], s29 offen offset:2048 sc1 lds
    s_waitcnt lgkmcnt(3)
    v_mfma_f32_16x16x32_bf16 v[28:31], a[204:207], v[92:95], v[28:31]
    ds_read_b128 v[76:79], v8 offset:9216
    v_mfma_f32_16x16x32_bf16 v[32:35], a[208:211], v[92:95], v[32:35]
    v_mfma_f32_16x16x32_bf16 v[36:39], a[212:215], v[92:95], v[36:39]
    v_mfma_f32_16x16x32_bf16 v[68:71], v[4:7], v[92:95], v[68:71]
    s_waitcnt lgkmcnt(3)
    v_mfma_f32_16x16x32_bf16 v[40:43], a[204:207], v[96:99], v[40:43]
    ds_read_b128 v[80:83], v9 offset:8192
    v_mfma_f32_16x16x32_bf16 v[44:47], a[208:211], v[96:99], v[44:47]
    v_mfma_f32_16x16x32_bf16 v[48:51], a[212:215], v[96:99], v[48:51]
    buffer_load_dwordx4 v13, s[16:19], s29 offen offset:3072 sc1 lds
    s_waitcnt lgkmcnt(3)
    v_mfma_f32_16x16x32_bf16 v[52:55], a[204:207], v[100:103], v[52:55]
    ds_read_b128 v[84:87], v9 offset:9216
    v_mfma_f32_16x16x32_bf16 v[56:59], a[208:211], v[100:103], v[56:59]
    v_mfma_f32_16x16x32_bf16 v[60:63], a[212:215], v[100:103], v[60:63]
    s_waitcnt lgkmcnt(3)
    v_mfma_f32_16x16x32_bf16 v[16:19], a[216:219], v[72:75], v[16:19]
    ds_read_b128 v[88:91], v8 offset:12288
    v_mfma_f32_16x16x32_bf16 v[20:23], a[220:223], v[72:75], v[20:23]
    v_mfma_f32_16x16x32_bf16 v[24:27], a[224:227], v[72:75], v[24:27]
    v_mfma_f32_16x16x32_bf16 v[64:67], v[4:7], v[72:75], v[64:67]
    s_add_u32 s60, s31, 4
    s_and_b32 s60, s60, 7
    s_lshl_b32 s60, s60, 11
    s_add_u32 s29, s22, s60
    s_mov_b32 m0, s23
    s_add_u32 s23, s23, s28
    buffer_load_dwordx4 v10, s[16:19], s29 offen offset:0 sc1 lds
    s_waitcnt lgkmcnt(3)
    v_mfma_f32_16x16x32_bf16 v[28:31], a[216:219], v[76:79], v[28:31]
    ds_read_b128 v[92:95], v8 offset:13312
    v_mfma_f32_16x16x32_bf16 v[32:35], a[220:223], v[76:79], v[32:35]
    v_mfma_f32_16x16x32_bf16 v[36:39], a[224:227], v[76:79], v[36:39]
    v_mfma_f32_16x16x32_bf16 v[68:71], v[4:7], v[76:79], v[68:71]
    s_waitcnt lgkmcnt(3)
    v_mfma_f32_16x16x32_bf16 v[40:43], a[216:219], v[80:83], v[40:43]
    ds_read_b128 v[96:99], v9 offset:12288
    v_mfma_f32_16x16x32_bf16 v[44:47], a[220:223], v[80:83], v[44:47]
    v_mfma_f32_16x16x32_bf16 v[48:51], a[224:227], v[80:83], v[48:51]
    buffer_load_dwordx4 v11, s[16:19], s29 offen offset:1024 sc1 lds
    s_waitcnt lgkmcnt(3)
    v_mfma_f32_16x16x32_bf16 v[52:55], a[216:219], v[84:87], v[52:55]
    ds_read_b128 v[100:103], v9 offset:13312
    v_mfma_f32_16x16x32_bf16 v[56:59], a[220:223], v[84:87], v[56:59]
    v_mfma_f32_16x16x32_bf16 v[60:63], a[224:227], v[84:87], v[60:63]
    s_waitcnt vmcnt(6)
    s_barrier
    s_waitcnt lgkmcnt(3)
    v_mfma_f32_16x16x32_bf16 v[16:19], a[228:231], v[88:91], v[16:19]
    ds_read_b128 v[72:75], v8 offset:16384
    v_mfma_f32_16x16x32_bf16 v[20:23], a[232:235], v[88:91], v[20:23]
    v_mfma_f32_16x16x32_bf16 v[24:27], a[236:239], v[88:91], v[24:27]
    v_mfma_f32_16x16x32_bf16 v[64:67], v[4:7], v[88:91], v[64:67]
    buffer_load_dwordx4 v12, s[16:19], s29 offen offset:2048 sc1 lds
    s_waitcnt lgkmcnt(3)
    v_mfma_f32_16x16x32_bf16 v[28:31], a[228:231], v[92:95], v[28:31]
    ds_read_b128 v[76:79], v8 offset:17408
    v_mfma_f32_16x16x32_bf16 v[32:35], a[232:235], v[92:95], v[32:35]
    v_mfma_f32_16x16x32_bf16 v[36:39], a[236:239], v[92:95], v[36:39]
    v_mfma_f32_16x16x32_bf16 v[68:71], v[4:7], v[92:95], v[68:71]
    s_waitcnt lgkmcnt(3)
    v_mfma_f32_16x16x32_bf16 v[40:43], a[228:231], v[96:99], v[40:43]
    ds_read_b128 v[80:83], v9 offset:16384
    v_mfma_f32_16x16x32_bf16 v[44:47], a[232:235], v[96:99], v[44:47]
    v_mfma_f32_16x16x32_bf16 v[48:51], a[236:239], v[96:99], v[48:51]
    buffer_load_dwordx4 v13, s[16:19], s29 offen offset:3072 sc1 lds
    s_waitcnt lgkmcnt(3)
    v_mfma_f32_16x16x32_bf16 v[52:55], a[228:231], v[100:103], v[52:55]
    ds_read_b128 v[84:87], v9 offset:17408
    v_mfma_f32_16x16x32_bf16 v[56:59], a[232:235], v[100:103], v[56:59]
    v_mfma_f32_16x16x32_bf16 v[60:63], a[236:239], v[100:103], v[60:63]
    s_waitcnt lgkmcnt(3)
    v_mfma_f32_16x16x32_bf16 v[16:19], a[240:243], v[72:75], v[16:19]
    ds_read_b128 v[88:91], v8 offset:20480
    v_mfma_f32_16x16x32_bf16 v[20:23], a[244:247], v[72:75], v[20:23]
    v_mfma_f32_16x16x32_bf16 v[24:27], a[248:251], v[72:75], v[24:27]
    v_mfma_f32_16x16x32_bf16 v[64:67], v[4:7], v[72:75], v[64:67]
    s_add_u32 s60, s31, 5
    s_and_b32 s60, s60, 7
    s_lshl_b32 s60, s60, 11
    s_add_u32 s29, s22, s60
    s_mov_b32 m0, s23
    s_add_u32 s23, s23, s28
    buffer_load_dwordx4 v10, s[16:19], s29 offen offset:0 sc1 lds
    s_waitcnt lgkmcnt(3)
    v_mfma_f32_16x16x32_bf16 v[28:31], a[240:243], v[76:79], v[28:31]
    ds_read_b128 v[92:95], v8 offset:21504
    v_mfma_f32_16x16x32_bf16 v[32:35], a[244:247], v[76:79], v[32:35]
    v_mfma_f32_16x16x32_bf16 v[36:39], a[248:251], v[76:79], v[36:39]
    v_mfma_f32_16x16x32_bf16 v[68:71], v[4:7], v[76:79], v[68:71]
    s_waitcnt lgkmcnt(3)
    v_mfma_f32_16x16x32_bf16 v[40:43], a[240:243], v[80:83], v[40:43]
    ds_read_b128 v[96:99], v9 offset:20480
    v_mfma_f32_16x16x32_bf16 v[44:47], a[244:247], v[80:83], v[44:47]
    v_mfma_f32_16x16x32_bf16 v[48:51], a[248:251], v[80:83], v[48:51]
    buffer_load_dwordx4 v11, s[16:19], s29 offen offset:1024 sc1 lds
    s_waitcnt lgkmcnt(3)
    v_mfma_f32_16x16x32_bf16 v[52:55], a[240:243], v[84:87], v[52:55]
    ds_read_b128 v[100:103], v9 offset:21504
    v_mfma_f32_16x16x32_bf16 v[56:59], a[244:247], v[84:87], v[56:59]
    v_mfma_f32_16x16x32_bf16 v[60:63], a[248:251], v[84:87], v[60:63]
    s_waitcnt vmcnt(6)
    s_barrier
    s_waitcnt lgkmcnt(3)
    v_mfma_f32_16x16x32_bf16 v[16:19], a[252:255], v[88:91], v[16:19]
    ds_read_b128 v[72:75], v8 offset:24576
    v_mfma_f32_16x16x32_bf16 v[20:23], v[104:107], v[88:91], v[20:23]
    v_mfma_f32_16x16x32_bf16 v[24:27], v[108:111], v[88:91], v[24:27]
    v_mfma_f32_16x16x32_bf16 v[64:67], v[4:7], v[88:91], v[64:67]
    buffer_load_dwordx4 v12, s[16:19], s29 offen offset:2048 sc1 lds
    s_waitcnt lgkmcnt(3)
    v_mfma_f32_16x16x32_bf16 v[28:31], a[252:255], v[92:95], v[28:31]
    ds_read_b128 v[76:79], v8 offset:25600
    v_mfma_f32_16x16x32_bf16 v[32:35], v[104:107], v[92:95], v[32:35]
    v_mfma_f32_16x16x32_bf16 v[36:39], v[108:111], v[92:95], v[36:39]
    v_mfma_f32_16x16x32_bf16 v[68:71], v[4:7], v[92:95], v[68:71]
    s_waitcnt lgkmcnt(3)
    v_mfma_f32_16x16x32_bf16 v[40:43], a[252:255], v[96:99], v[40:43]
    ds_read_b128 v[80:83], v9 offset:24576
    v_mfma_f32_16x16x32_bf16 v[44:47], v[104:107], v[96:99], v[44:47]
    v_mfma_f32_16x16x32_bf16 v[48:51], v[108:111], v[96:99], v[48:51]
    buffer_load_dwordx4 v13, s[16:19], s29 offen offset:3072 sc1 lds
    s_waitcnt lgkmcnt(3)
    v_mfma_f32_16x16x32_bf16 v[52:55], a[252:255], v[100:103], v[52:55]
    ds_read_b128 v[84:87], v9 offset:25600
    v_mfma_f32_16x16x32_bf16 v[56:59], v[104:107], v[100:103], v[56:59]
    v_mfma_f32_16x16x32_bf16 v[60:63], v[108:111], v[100:103], v[60:63]
    s_waitcnt lgkmcnt(3)
    v_mfma_f32_16x16x32_bf16 v[16:19], v[112:115], v[72:75], v[16:19]
    ds_read_b128 v[88:91], v8 offset:28672
    v_mfma_f32_16x16x32_bf16 v[20:23], v[116:119], v[72:75], v[20:23]
    v_mfma_f32_16x16x32_bf16 v[24:27], v[120:123], v[72:75], v[24:27]
    v_mfma_f32_16x16x32_bf16 v[64:67], v[4:7], v[72:75], v[64:67]
    s_add_u32 s60, s31, 6
    s_and_b32 s60, s60, 7
    s_lshl_b32 s60, s60, 11
    s_add_u32 s29, s22, s60
    s_mov_b32 m0, s23
    s_add_u32 s23, s23, s28
    buffer_load_dwordx4 v10, s[16:19], s29 offen offset:0 sc1 lds
    s_waitcnt lgkmcnt(3)
    v_mfma_f32_16x16x32_bf16 v[28:31], v[112:115], v[76:79], v[28:31]
    ds_read_b128 v[92:95], v8 offset:29696
    v_mfma_f32_16x16x32_bf16 v[32:35], v[116:119], v[76:79], v[32:35]
    v_mfma_f32_16x16x32_bf16 v[36:39], v[120:123], v[76:79], v[36:39]
    v_mfma_f32_16x16x32_bf16 v[68:71], v[4:7], v[76:79], v[68:71]
    s_waitcnt lgkmcnt(3)
    v_mfma_f32_16x16x32_bf16 v[40:43], v[112:115], v[80:83], v[40:43]
    ds_read_b128 v[96:99], v9 offset:28672
    v_mfma_f32_16x16x32_bf16 v[44:47], v[116:119], v[80:83], v[44:47]
    v_mfma_f32_16x16x32_bf16 v[48:51], v[120:123], v[80:83], v[48:51]
    buffer_load_dwordx4 v11, s[16:19], s29 offen offset:1024 sc1 lds
    s_waitcnt lgkmcnt(3)
    v_mfma_f32_16x16x32_bf16 v[52:55], v[112:115], v[84:87], v[52:55]
    ds_read_b128 v[100:103], v9 offset:29696
    v_mfma_f32_16x16x32_bf16 v[56:59], v[116:119], v[84:87], v[56:59]
    v_mfma_f32_16x16x32_bf16 v[60:63], v[120:123], v[84:87], v[60:63]
    s_waitcnt vmcnt(6)
    s_barrier
    s_waitcnt lgkmcnt(3)
    v_mfma_f32_16x16x32_bf16 v[16:19], v[124:127], v[88:91], v[16:19]
    ds_read_b128 v[72:75], v8 offset:32768
    v_mfma_f32_16x16x32_bf16 v[20:23], v[128:131], v[88:91], v[20:23]
    v_mfma_f32_16x16x32_bf16 v[24:27], v[132:135], v[88:91], v[24:27]
    v_mfma_f32_16x16x32_bf16 v[64:67], v[4:7], v[88:91], v[64:67]
    buffer_load_dwordx4 v12, s[16:19], s29 offen offset:2048 sc1 lds
    s_waitcnt lgkmcnt(3)
    v_mfma_f32_16x16x32_bf16 v[28:31], v[124:127], v[92:95], v[28:31]
    ds_read_b128 v[76:79], v8 offset:33792
    v_mfma_f32_16x16x32_bf16 v[32:35], v[128:131], v[92:95], v[32:35]
    v_mfma_f32_16x16x32_bf16 v[36:39], v[132:135], v[92:95], v[36:39]
    v_mfma_f32_16x16x32_bf16 v[68:71], v[4:7], v[92:95], v[68:71]
    s_waitcnt lgkmcnt(3)
    v_mfma_f32_16x16x32_bf16 v[40:43], v[124:127], v[96:99], v[40:43]
    ds_read_b128 v[80:83], v9 offset:32768
    v_mfma_f32_16x16x32_bf16 v[44:47], v[128:131], v[96:99], v[44:47]
    v_mfma_f32_16x16x32_bf16 v[48:51], v[132:135], v[96:99], v[48:51]
    buffer_load_dwordx4 v13, s[16:19], s29 offen offset:3072 sc1 lds
    s_waitcnt lgkmcnt(3)
    v_mfma_f32_16x16x32_bf16 v[52:55], v[124:127], v[100:103], v[52:55]
    ds_read_b128 v[84:87], v9 offset:33792
    v_mfma_f32_16x16x32_bf16 v[56:59], v[128:131], v[100:103], v[56:59]
    v_mfma_f32_16x16x32_bf16 v[60:63], v[132:135], v[100:103], v[60:63]
    s_waitcnt lgkmcnt(3)
    v_mfma_f32_16x16x32_bf16 v[16:19], v[136:139], v[72:75], v[16:19]
    ds_read_b128 v[88:91], v8 offset:36864
    v_mfma_f32_16x16x32_bf16 v[20:23], v[140:143], v[72:75], v[20:23]
    v_mfma_f32_16x16x32_bf16 v[24:27], v[144:147], v[72:75], v[24:27]
    v_mfma_f32_16x16x32_bf16 v[64:67], v[4:7], v[72:75], v[64:67]
    s_add_u32 s60, s31, 7
    s_and_b32 s60, s60, 7
    s_lshl_b32 s60, s60, 11
    s_add_u32 s29, s22, s60
    s_mov_b32 m0, s23
    s_add_u32 s23, s23, s28
    buffer_load_dwordx4 v10, s[16:19], s29 offen offset:0 sc1 lds
    s_waitcnt lgkmcnt(3)
    v_mfma_f32_16x16x32_bf16 v[28:31], v[136:139], v[76:79], v[28:31]
    ds_read_b128 v[92:95], v8 offset:37888
    v_mfma_f32_16x16x32_bf16 v[32:35], v[140:143], v[76:79], v[32:35]
    v_mfma_f32_16x16x32_bf16 v[36:39], v[144:147], v[76:79], v[36:39]
    v_mfma_f32_16x16x32_bf16 v[68:71], v[4:7], v[76:79], v[68:71]
    s_waitcnt lgkmcnt(3)
    v_mfma_f32_16x16x32_bf16 v[40:43], v[136:139], v[80:83], v[40:43]
    ds_read_b128 v[96:99], v9 offset:36864
    v_mfma_f32_16x16x32_bf16 v[44:47], v[140:143], v[80:83], v[44:47]
    v_mfma_f32_16x16x32_bf16 v[48:51], v[144:147], v[80:83], v[48:51]
    buffer_load_dwordx4 v11, s[16:19], s29 offen offset:1024 sc1 lds
    s_waitcnt lgkmcnt(3)
    v_mfma_f32_16x16x32_bf16 v[52:55], v[136:139], v[84:87], v[52:55]
    ds_read_b128 v[100:103], v9 offset:37888
    v_mfma_f32_16x16x32_bf16 v[56:59], v[140:143], v[84:87], v[56:59]
    v_mfma_f32_16x16x32_bf16 v[60:63], v[144:147], v[84:87], v[60:63]
    s_waitcnt vmcnt(6)
    s_barrier
    s_waitcnt lgkmcnt(3)
    v_mfma_f32_16x16x32_bf16 v[16:19], v[148:151], v[88:91], v[16:19]
    ds_read_b128 v[72:75], v8 offset:40960
    v_mfma_f32_16x16x32_bf16 v[20:23], v[152:155], v[88:91], v[20:23]
    v_mfma_f32_16x16x32_bf16 v[24:27], v[156:159], v[88:91], v[24:27]
    v_mfma_f32_16x16x32_bf16 v[64:67], v[4:7], v[88:91], v[64:67]
    buffer_load_dwordx4 v12, s[16:19], s29 offen offset:2048 sc1 lds
    s_waitcnt lgkmcnt(3)
    v_mfma_f32_16x16x32_bf16 v[28:31], v[148:151], v[92:95], v[28:31]
    ds_read_b128 v[76:79], v8 offset:41984
    v_mfma_f32_16x16x32_bf16 v[32:35], v[152:155], v[92:95], v[32:35]
    v_mfma_f32_16x16x32_bf16 v[36:39], v[156:159], v[92:95], v[36:39]
    v_mfma_f32_16x16x32_bf16 v[68:71], v[4:7], v[92:95], v[68:71]
    s_waitcnt lgkmcnt(3)
    v_mfma_f32_16x16x32_bf16 v[40:43], v[148:151], v[96:99], v[40:43]
    ds_read_b128 v[80:83], v9 offset:40960
    v_mfma_f32_16x16x32_bf16 v[44:47], v[152:155], v[96:99], v[44:47]
    v_mfma_f32_16x16x32_bf16 v[48:51], v[156:159], v[96:99], v[48:51]
    buffer_load_dwordx4 v13, s[16:19], s29 offen offset:3072 sc1 lds
    s_waitcnt lgkmcnt(3)
    v_mfma_f32_16x16x32_bf16 v[52:55], v[148:151], v[100:103], v[52:55]
    ds_read_b128 v[84:87], v9 offset:41984
    v_mfma_f32_16x16x32_bf16 v[56:59], v[152:155], v[100:103], v[56:59]
    v_mfma_f32_16x16x32_bf16 v[60:63], v[156:159], v[100:103], v[60:63]
    s_waitcnt lgkmcnt(3)
    v_mfma_f32_16x16x32_bf16 v[16:19], v[160:163], v[72:75], v[16:19]
    ds_read_b128 v[88:91], v8 offset:45056
    v_mfma_f32_16x16x32_bf16 v[20:23], v[164:167], v[72:75], v[20:23]
    v_mfma_f32_16x16x32_bf16 v[24:27], v[168:171], v[72:75], v[24:27]
    v_mfma_f32_16x16x32_bf16 v[64:67], v[4:7], v[72:75], v[64:67]
    s_waitcnt lgkmcnt(3)
    v_mfma_f32_16x16x32_bf16 v[28:31], v[160:163], v[76:79], v[28:31]
    ds_read_b128 v[92:95], v8 offset:46080
    v_mfma_f32_16x16x32_bf16 v[32:35], v[164:167], v[76:79], v[32:35]
    v_mfma_f32_16x16x32_bf16 v[36:39], v[168:171], v[76:79], v[36:39]
    v_mfma_f32_16x16x32_bf16 v[68:71], v[4:7], v[76:79], v[68:71]
    s_waitcnt lgkmcnt(3)
    v_mfma_f32_16x16x32_bf16 v[40:43], v[160:163], v[80:83], v[40:43]
    ds_read_b128 v[96:99], v9 offset:45056
    v_mfma_f32_16x16x32_bf16 v[44:47], v[164:167], v[80:83], v[44:47]
    v_mfma_f32_16x16x32_bf16 v[48:51], v[168:171], v[80:83], v[48:51]
    s_waitcnt lgkmcnt(3)
    v_mfma_f32_16x16x32_bf16 v[52:55], v[160:163], v[84:87], v[52:55]
    ds_read_b128 v[100:103], v9 offset:46080
    v_mfma_f32_16x16x32_bf16 v[56:59], v[164:167], v[84:87], v[56:59]
    v_mfma_f32_16x16x32_bf16 v[60:63], v[168:171], v[84:87], v[60:63]
    s_waitcnt vmcnt(4)
    s_barrier
    s_waitcnt lgkmcnt(3)
    v_mfma_f32_16x16x32_bf16 v[16:19], v[172:175], v[88:91], v[16:19]
    ds_read_b128 v[72:75], v8 offset:49152
    v_mfma_f32_16x16x32_bf16 v[20:23], v[176:179], v[88:91], v[20:23]
    v_mfma_f32_16x16x32_bf16 v[24:27], v[180:183], v[88:91], v[24:27]
    v_mfma_f32_16x16x32_bf16 v[64:67], v[4:7], v[88:91], v[64:67]
    s_waitcnt lgkmcnt(3)
    v_mfma_f32_16x16x32_bf16 v[28:31], v[172:175], v[92:95], v[28:31]
    ds_read_b128 v[76:79], v8 offset:50176
    v_mfma_f32_16x16x32_bf16 v[32:35], v[176:179], v[92:95], v[32:35]
    v_mfma_f32_16x16x32_bf16 v[36:39], v[180:183], v[92:95], v[36:39]
    v_mfma_f32_16x16x32_bf16 v[68:71], v[4:7], v[92:95], v[68:71]
    s_waitcnt lgkmcnt(3)
    v_mfma_f32_16x16x32_bf16 v[40:43], v[172:175], v[96:99], v[40:43]
    ds_read_b128 v[80:83], v9 offset:49152
    v_mfma_f32_16x16x32_bf16 v[44:47], v[176:179], v[96:99], v[44:47]
    v_mfma_f32_16x16x32_bf16 v[48:51], v[180:183], v[96:99], v[48:51]
    s_waitcnt lgkmcnt(3)
    v_mfma_f32_16x16x32_bf16 v[52:55], v[172:175], v[100:103], v[52:55]
    ds_read_b128 v[84:87], v9 offset:50176
    v_mfma_f32_16x16x32_bf16 v[56:59], v[176:179], v[100:103], v[56:59]
    v_mfma_f32_16x16x32_bf16 v[60:63], v[180:183], v[100:103], v[60:63]
    s_waitcnt lgkmcnt(3)
    v_mfma_f32_16x16x32_bf16 v[16:19], v[184:187], v[72:75], v[16:19]
    ds_read_b128 v[88:91], v8 offset:53248
    v_mfma_f32_16x16x32_bf16 v[20:23], v[188:191], v[72:75], v[20:23]
    v_mfma_f32_16x16x32_bf16 v[24:27], v[192:195], v[72:75], v[24:27]
    v_mfma_f32_16x16x32_bf16 v[64:67], v[4:7], v[72:75], v[64:67]
    s_waitcnt lgkmcnt(3)
    v_mfma_f32_16x16x32_bf16 v[28:31], v[184:187], v[76:79], v[28:31]
    ds_read_b128 v[92:95], v8 offset:54272
    v_mfma_f32_16x16x32_bf16 v[32:35], v[188:191], v[76:79], v[32:35]
    v_mfma_f32_16x16x32_bf16 v[36:39], v[192:195], v[76:79], v[36:39]
    v_mfma_f32_16x16x32_bf16 v[68:71], v[4:7], v[76:79], v[68:71]
    s_waitcnt lgkmcnt(3)
    v_mfma_f32_16x16x32_bf16 v[40:43], v[184:187], v[80:83], v[40:43]
    ds_read_b128 v[96:99], v9 offset:53248
    v_mfma_f32_16x16x32_bf16 v[44:47], v[188:191], v[80:83], v[44:47]
    v_mfma_f32_16x16x32_bf16 v[48:51], v[192:195], v[80:83], v[48:51]
    s_waitcnt lgkmcnt(3)
    v_mfma_f32_16x16x32_bf16 v[52:55], v[184:187], v[84:87], v[52:55]
    ds_read_b128 v[100:103], v9 offset:54272
    v_mfma_f32_16x16x32_bf16 v[56:59], v[188:191], v[84:87], v[56:59]
    v_mfma_f32_16x16x32_bf16 v[60:63], v[192:195], v[84:87], v[60:63]
    s_waitcnt vmcnt(0)
    s_barrier
    s_waitcnt lgkmcnt(3)
    v_mfma_f32_16x16x32_bf16 v[16:19], v[196:199], v[88:91], v[16:19]
    ds_read_b128 v[72:75], v8 offset:57344
    v_mfma_f32_16x16x32_bf16 v[20:23], a[0:3], v[88:91], v[20:23]
    v_mfma_f32_16x16x32_bf16 v[24:27], a[4:7], v[88:91], v[24:27]
    v_mfma_f32_16x16x32_bf16 v[64:67], v[4:7], v[88:91], v[64:67]
    s_waitcnt lgkmcnt(3)
    v_mfma_f32_16x16x32_bf16 v[28:31], v[196:199], v[92:95], v[28:31]
    ds_read_b128 v[76:79], v8 offset:58368
    v_mfma_f32_16x16x32_bf16 v[32:35], a[0:3], v[92:95], v[32:35]
    v_mfma_f32_16x16x32_bf16 v[36:39], a[4:7], v[92:95], v[36:39]
    v_mfma_f32_16x16x32_bf16 v[68:71], v[4:7], v[92:95], v[68:71]
    s_waitcnt lgkmcnt(3)
    v_mfma_f32_16x16x32_bf16 v[40:43], v[196:199], v[96:99], v[40:43]
    ds_read_b128 v[80:83], v9 offset:57344
    v_mfma_f32_16x16x32_bf16 v[44:47], a[0:3], v[96:99], v[44:47]
    v_mfma_f32_16x16x32_bf16 v[48:51], a[4:7], v[96:99], v[48:51]
    s_waitcnt lgkmcnt(3)
    v_mfma_f32_16x16x32_bf16 v[52:55], v[196:199], v[100:103], v[52:55]
    ds_read_b128 v[84:87], v9 offset:58368
    v_mfma_f32_16x16x32_bf16 v[56:59], a[0:3], v[100:103], v[56:59]
    v_mfma_f32_16x16x32_bf16 v[60:63], a[4:7], v[100:103], v[60:63]
    s_waitcnt lgkmcnt(3)
    v_mfma_f32_16x16x32_bf16 v[16:19], a[8:11], v[72:75], v[16:19]
    ds_read_b128 v[88:91], v8 offset:61440
    v_mfma_f32_16x16x32_bf16 v[20:23], a[12:15], v[72:75], v[20:23]
    v_mfma_f32_16x16x32_bf16 v[24:27], a[16:19], v[72:75], v[24:27]
    v_mfma_f32_16x16x32_bf16 v[64:67], v[4:7], v[72:75], v[64:67]
    s_waitcnt lgkmcnt(3)
    v_mfma_f32_16x16x32_bf16 v[28:31], a[8:11], v[76:79], v[28:31]
    ds_read_b128 v[92:95], v8 offset:62464
    v_mfma_f32_16x16x32_bf16 v[32:35], a[12:15], v[76:79], v[32:35]
    v_mfma_f32_16x16x32_bf16 v[36:39], a[16:19], v[76:79], v[36:39]
    v_mfma_f32_16x16x32_bf16 v[68:71], v[4:7], v[76:79], v[68:71]
    s_waitcnt lgkmcnt(3)
    v_mfma_f32_16x16x32_bf16 v[40:43], a[8:11], v[80:83], v[40:43]
    ds_read_b128 v[96:99], v9 offset:61440
    v_mfma_f32_16x16x32_bf16 v[44:47], a[12:15], v[80:83], v[44:47]
    v_mfma_f32_16x16x32_bf16 v[48:51], a[16:19], v[80:83], v[48:51]
    s_waitcnt lgkmcnt(3)
    v_mfma_f32_16x16x32_bf16 v[52:55], a[8:11], v[84:87], v[52:55]
    ds_read_b128 v[100:103], v9 offset:62464
    v_mfma_f32_16x16x32_bf16 v[56:59], a[12:15], v[84:87], v[56:59]
    v_mfma_f32_16x16x32_bf16 v[60:63], a[16:19], v[84:87], v[60:63]
    s_waitcnt lgkmcnt(3)
    v_mfma_f32_16x16x32_bf16 v[16:19], a[20:23], v[88:91], v[16:19]
    v_mfma_f32_16x16x32_bf16 v[20:23], a[24:27], v[88:91], v[20:23]
    v_mfma_f32_16x16x32_bf16 v[24:27], a[28:31], v[88:91], v[24:27]
    v_mfma_f32_16x16x32_bf16 v[64:67], v[4:7], v[88:91], v[64:67]
    s_waitcnt lgkmcnt(2)
    v_mfma_f32_16x16x32_bf16 v[28:31], a[20:23], v[92:95], v[28:31]
    v_mfma_f32_16x16x32_bf16 v[32:35], a[24:27], v[92:95], v[32:35]
    v_mfma_f32_16x16x32_bf16 v[36:39], a[28:31], v[92:95], v[36:39]
    v_mfma_f32_16x16x32_bf16 v[68:71], v[4:7], v[92:95], v[68:71]
    s_waitcnt lgkmcnt(1)
    v_mfma_f32_16x16x32_bf16 v[40:43], a[20:23], v[96:99], v[40:43]
    v_mfma_f32_16x16x32_bf16 v[44:47], a[24:27], v[96:99], v[44:47]
    v_mfma_f32_16x16x32_bf16 v[48:51], a[28:31], v[96:99], v[48:51]
    s_waitcnt lgkmcnt(0)
    v_mfma_f32_16x16x32_bf16 v[52:55], a[20:23], v[100:103], v[52:55]
    v_mfma_f32_16x16x32_bf16 v[56:59], a[24:27], v[100:103], v[56:59]
    v_mfma_f32_16x16x32_bf16 v[60:63], a[28:31], v[100:103], v[60:63]
    s_branch pd_epi
pd_nh1:
    s_waitcnt lgkmcnt(3)
    v_mfma_f32_16x16x32_bf16 v[16:19], a[192:195], v[72:75], 0
    ds_read_b128 v[88:91], v8 offset:4096
    v_mfma_f32_16x16x32_bf16 v[20:23], a[196:199], v[72:75], 0
    v_mfma_f32_16x16x32_bf16 v[24:27], a[200:203], v[72:75], 0
    s_add_u32 s60, s31, 3
    s_and_b32 s60, s60, 7
    s_lshl_b32 s60, s60, 11
    s_add_u32 s29, s22, s60
    s_mov_b32 m0, s23
    s_add_u32 s23, s23, s28
    buffer_load_dwordx4 v10, s[16:19], s29 offen offset:0 sc1 lds
    s_waitcnt lgkmcnt(3)
    v_mfma_f32_16x16x32_bf16 v[28:31], a[192:195], v[76:79], 0
    ds_read_b128 v[92:95], v8 offset:5120
    v_mfma_f32_16x16x32_bf16 v[32:35], a[196:199], v[76:79], 0
    v_mfma_f32_16x16x32_bf16 v[36:39], a[200:203], v[76:79], 0
    s_waitcnt lgkmcnt(3)
    v_mfma_f32_16x16x32_bf16 v[40:43], a[192:195], v[80:83], 0
    ds_read_b128 v[96:99], v9 offset:4096
    v_mfma_f32_16x16x32_bf16 v[44:47], a[196:199], v[80:83], 0
    v_mfma_f32_16x16x32_bf16 v[48:51], a[200:203], v[80:83], 0
    v_mfma_f32_16x16x32_bf16 v[64:67], v[4:7], v[80:83], 0
    buffer_load_dwordx4 v11, s[16:19], s29 offen offset:1024 sc1 lds
    s_waitcnt lgkmcnt(3)
    v_mfma_f32_16x16x32_bf16 v[52:55], a[192:195], v[84:87], 0
    ds_read_b128 v[100:103], v9 offset:5120
    v_mfma_f32_16x16x32_bf16 v[56:59], a[196:199], v[84:87], 0
    v_mfma_f32_16x16x32_bf16 v[60:63], a[200:203], v[84:87], 0
    v_mfma_f32_16x16x32_bf16 v[68:71], v[4:7], v[84:87], 0
    s_waitcnt vmcnt(6)
    s_barrier
    s_waitcnt lgkmcnt(3)
    v_mfma_f32_16x16x32_bf16 v[16:19], a[204:207], v[88:91], v[16:19]
    ds_read_b128 v[72:75], v8 offset:8192
    v_mfma_f32_16x16x32_bf16 v[20:23], a[208:211], v[88:91], v[20:23]
    v_mfma_f32_16x16x32_bf16 v[24:27], a[212:215], v[88:91], v[24:27]
    buffer_load_dwordx4 v12, s[16:19], s29 offen offset:2048 sc1 lds
    s_waitcnt lgkmcnt(3)
    v_mfma_f32_16x16x32_bf16 v[28:31], a[204:207], v[92:95], v[28:31]
    ds_read_b128 v[76:79], v8 offset:9216
    v_mfma_f32_16x16x32_bf16 v[32:35], a[208:211], v[92:95], v[32:35]
    v_mfma_f32_16x16x32_bf16 v[36:39], a[212:215], v[92:95], v[36:39]
    s_waitcnt lgkmcnt(3)
    v_mfma_f32_16x16x32_bf16 v[40:43], a[204:207], v[96:99], v[40:43]
    ds_read_b128 v[80:83], v9 offset:8192
    v_mfma_f32_16x16x32_bf16 v[44:47], a[208:211], v[96:99], v[44:47]
    v_mfma_f32_16x16x32_bf16 v[48:51], a[212:215], v[96:99], v[48:51]
    v_mfma_f32_16x16x32_bf16 v[64:67], v[4:7], v[96:99], v[64:67]
    buffer_load_dwordx4 v13, s[16:19], s29 offen offset:3072 sc1 lds
    s_waitcnt lgkmcnt(3)
    v_mfma_f32_16x16x32_bf16 v[52:55], a[204:207], v[100:103], v[52:55]
    ds_read_b128 v[84:87], v9 offset:9216
    v_mfma_f32_16x16x32_bf16 v[56:59], a[208:211], v[100:103], v[56:59]
    v_mfma_f32_16x16x32_bf16 v[60:63], a[212:215], v[100:103], v[60:63]
    v_mfma_f32_16x16x32_bf16 v[68:71], v[4:7], v[100:103], v[68:71]
    s_waitcnt lgkmcnt(3)
    v_mfma_f32_16x16x32_bf16 v[16:19], a[216:219], v[72:75], v[16:19]
    ds_read_b128 v[88:91], v8 offset:12288
    v_mfma_f32_16x16x32_bf16 v[20:23], a[220:223], v[72:75], v[20:23]
    v_mfma_f32_16x16x32_bf16 v[24:27], a[224:227], v[72:75], v[24:27]
    s_add_u32 s60, s31, 4
    s_and_b32 s60, s60, 7
    s_lshl_b32 s60, s60, 11
    s_add_u32 s29, s22, s60
    s_mov_b32 m0, s23
    s_add_u32 s23, s23, s28
    buffer_load_dwordx4 v10, s[16:19], s29 offen offset:0 sc1 lds
    s_waitcnt lgkmcnt(3)
    v_mfma_f32_16x16x32_bf16 v[28:31], a[216:219], v[76:79], v[28:31]
    ds_read_b128 v[92:95], v8 offset:13312
    v_mfma_f32_16x16x32_bf16 v[32:35], a[220:223], v[76:79], v[32:35]
    v_mfma_f32_16x16x32_bf16 v[36:39], a[224:227], v[76:79], v[36:39]
    s_waitcnt lgkmcnt(3)
    v_mfma_f32_16x16x32_bf16 v[40:43], a[216:219], v[80:83], v[40:43]
    ds_read_b128 v[96:99], v9 offset:12288
    v_mfma_f32_16x16x32_bf16 v[44:47], a[220:223], v[80:83], v[44:47]
    v_mfma_f32_16x16x32_bf16 v[48:51], a[224:227], v[80:83], v[48:51]
    v_mfma_f32_16x16x32_bf16 v[64:67], v[4:7], v[80:83], v[64:67]
    buffer_load_dwordx4 v11, s[16:19], s29 offen offset:1024 sc1 lds
    s_waitcnt lgkmcnt(3)
    v_mfma_f32_16x16x32_bf16 v[52:55], a[216:219], v[84:87], v[52:55]
    ds_read_b128 v[100:103], v9 offset:13312
    v_mfma_f32_16x16x32_bf16 v[56:59], a[220:223], v[84:87], v[56:59]
    v_mfma_f32_16x16x32_bf16 v[60:63], a[224:227], v[84:87], v[60:63]
    v_mfma_f32_16x16x32_bf16 v[68:71], v[4:7], v[84:87], v[68:71]
    s_waitcnt vmcnt(6)
    s_barrier
    s_waitcnt lgkmcnt(3)
    v_mfma_f32_16x16x32_bf16 v[16:19], a[228:231], v[88:91], v[16:19]
    ds_read_b128 v[72:75], v8 offset:16384
    v_mfma_f32_16x16x32_bf16 v[20:23], a[232:235], v[88:91], v[20:23]
    v_mfma_f32_16x16x32_bf16 v[24:27], a[236:239], v[88:91], v[24:27]
    buffer_load_dwordx4 v12, s[16:19], s29 offen offset:2048 sc1 lds
    s_waitcnt lgkmcnt(3)
    v_mfma_f32_16x16x32_bf16 v[28:31], a[228:231], v[92:95], v[28:31]
    ds_read_b128 v[76:79], v8 offset:17408
    v_mfma_f32_16x16x32_bf16 v[32:35], a[232:235], v[92:95], v[32:35]
    v_mfma_f32_16x16x32_bf16 v[36:39], a[236:239], v[92:95], v[36:39]
    s_waitcnt lgkmcnt(3)
    v_mfma_f32_16x16x32_bf16 v[40:43], a[228:231], v[96:99], v[40:43]
    ds_read_b128 v[80:83], v9 offset:16384
    v_mfma_f32_16x16x32_bf16 v[44:47], a[232:235], v[96:99], v[44:47]
    v_mfma_f32_16x16x32_bf16 v[48:51], a[236:239], v[96:99], v[48:51]
    v_mfma_f32_16x16x32_bf16 v[64:67], v[4:7], v[96:99], v[64:67]
    buffer_load_dwordx4 v13, s[16:19], s29 offen offset:3072 sc1 lds
    s_waitcnt lgkmcnt(3)
    v_mfma_f32_16x16x32_bf16 v[52:55], a[228:231], v[100:103], v[52:55]
    ds_read_b128 v[84:87], v9 offset:17408
    v_mfma_f32_16x16x32_bf16 v[56:59], a[232:235], v[100:103], v[56:59]
    v_mfma_f32_16x16x32_bf16 v[60:63], a[236:239], v[100:103], v[60:63]
    v_mfma_f32_16x16x32_bf16 v[68:71], v[4:7], v[100:103], v[68:71]
    s_waitcnt lgkmcnt(3)
    v_mfma_f32_16x16x32_bf16 v[16:19], a[240:243], v[72:75], v[16:19]
    ds_read_b128 v[88:91], v8 offset:20480
    v_mfma_f32_16x16x32_bf16 v[20:23], a[244:247], v[72:75], v[20:23]
    v_mfma_f32_16x16x32_bf16 v[24:27], a[248:251], v[72:75], v[24:27]
    s_add_u32 s60, s31, 5
    s_and_b32 s60, s60, 7
    s_lshl_b32 s60, s60, 11
    s_add_u32 s29, s22, s60
    s_mov_b32 m0, s23
    s_add_u32 s23, s23, s28
    buffer_load_dwordx4 v10, s[16:19], s29 offen offset:0 sc1 lds
    s_waitcnt lgkmcnt(3)
    v_mfma_f32_16x16x32_bf16 v[28:31], a[240:243], v[76:79], v[28:31]
    ds_read_b128 v[92:95], v8 offset:21504
    v_mfma_f32_16x16x32_bf16 v[32:35], a[244:247], v[76:79], v[32:35]
    v_mfma_f32_16x16x32_bf16 v[36:39], a[248:251], v[76:79], v[36:39]
    s_waitcnt lgkmcnt(3)
    v_mfma_f32_16x16x32_bf16 v[40:43], a[240:243], v[80:83], v[40:43]
    ds_read_b128 v[96:99], v9 offset:20480
    v_mfma_f32_16x16x32_bf16 v[44:47], a[244:247], v[80:83], v[44:47]
    v_mfma_f32_16x16x32_bf16 v[48:51], a[248:251], v[80:83], v[48:51]
    v_mfma_f32_16x16x32_bf16 v[64:67], v[4:7], v[80:83], v[64:67]
    buffer_load_dwordx4 v11, s[16:19], s29 offen offset:1024 sc1 lds
    s_waitcnt lgkmcnt(3)
    v_mfma_f32_16x16x32_bf16 v[52:55], a[240:243], v[84:87], v[52:55]
    ds_read_b128 v[100:103], v9 offset:21504
    v_mfma_f32_16x16x32_bf16 v[56:59], a[244:247], v[84:87], v[56:59]
    v_mfma_f32_16x16x32_bf16 v[60:63], a[248:251], v[84:87], v[60:63]
    v_mfma_f32_16x16x32_bf16 v[68:71], v[4:7], v[84:87], v[68:71]
    s_waitcnt vmcnt(6)
    s_barrier
    s_waitcnt lgkmcnt(3)
    v_mfma_f32_16x16x32_bf16 v[16:19], a[252:255], v[88:91], v[16:19]
    ds_read_b128 v[72:75], v8 offset:24576
    v_mfma_f32_16x16x32_bf16 v[20:23], v[104:107], v[88:91], v[20:23]
    v_mfma_f32_16x16x32_bf16 v[24:27], v[108:111], v[88:91], v[24:27]
    buffer_load_dwordx4 v12, s[16:19], s29 offen offset:2048 sc1 lds
    s_waitcnt lgkmcnt(3)
    v_mfma_f32_16x16x32_bf16 v[28:31], a[252:255], v[92:95], v[28:31]
    ds_read_b128 v[76:79], v8 offset:25600
    v_mfma_f32_16x16x32_bf16 v[32:35], v[104:107], v[92:95], v[32:35]
    v_mfma_f32_16x16x32_bf16 v[36:39], v[108:111], v[92:95], v[36:39]
    s_waitcnt lgkmcnt(3)
    v_mfma_f32_16x16x32_bf16 v[40:43], a[252:255], v[96:99], v[40:43]
    ds_read_b128 v[80:83], v9 offset:24576
    v_mfma_f32_16x16x32_bf16 v[44:47], v[104:107], v[96:99], v[44:47]
    v_mfma_f32_16x16x32_bf16 v[48:51], v[108:111], v[96:99], v[48:51]
    v_mfma_f32_16x16x32_bf16 v[64:67], v[4:7], v[96:99], v[64:67]
    buffer_load_dwordx4 v13, s[16:19], s29 offen offset:3072 sc1 lds
    s_waitcnt lgkmcnt(3)
    v_mfma_f32_16x16x32_bf16 v[52:55], a[252:255], v[100:103], v[52:55]
    ds_read_b128 v[84:87], v9 offset:25600
    v_mfma_f32_16x16x32_bf16 v[56:59], v[104:107], v[100:103], v[56:59]
    v_mfma_f32_16x16x32_bf16 v[60:63], v[108:111], v[100:103], v[60:63]
    v_mfma_f32_16x16x32_bf16 v[68:71], v[4:7], v[100:103], v[68:71]
    s_waitcnt lgkmcnt(3)
    v_mfma_f32_16x16x32_bf16 v[16:19], v[112:115], v[72:75], v[16:19]
    ds_read_b128 v[88:91], v8 offset:28672
    v_mfma_f32_16x16x32_bf16 v[20:23], v[116:119], v[72:75], v[20:23]
    v_mfma_f32_16x16x32_bf16 v[24:27], v[120:123], v[72:75], v[24:27]
    s_add_u32 s60, s31, 6
    s_and_b32 s60, s60, 7
    s_lshl_b32 s60, s60, 11
    s_add_u32 s29, s22, s60
    s_mov_b32 m0, s23
    s_add_u32 s23, s23, s28
    buffer_load_dwordx4 v10, s[16:19], s29 offen offset:0 sc1 lds
    s_waitcnt lgkmcnt(3)
    v_mfma_f32_16x16x32_bf16 v[28:31], v[112:115], v[76:79], v[28:31]
    ds_read_b128 v[92:95], v8 offset:29696
    v_mfma_f32_16x16x32_bf16 v[32:35], v[116:119], v[76:79], v[32:35]
    v_mfma_f32_16x16x32_bf16 v[36:39], v[120:123], v[76:79], v[36:39]
    s_waitcnt lgkmcnt(3)
    v_mfma_f32_16x16x32_bf16 v[40:43], v[112:115], v[80:83], v[40:43]
    ds_read_b128 v[96:99], v9 offset:28672
    v_mfma_f32_16x16x32_bf16 v[44:47], v[116:119], v[80:83], v[44:47]
    v_mfma_f32_16x16x32_bf16 v[48:51], v[120:123], v[80:83], v[48:51]
    v_mfma_f32_16x16x32_bf16 v[64:67], v[4:7], v[80:83], v[64:67]
    buffer_load_dwordx4 v11, s[16:19], s29 offen offset:1024 sc1 lds
    s_waitcnt lgkmcnt(3)
    v_mfma_f32_16x16x32_bf16 v[52:55], v[112:115], v[84:87], v[52:55]
    ds_read_b128 v[100:103], v9 offset:29696
    v_mfma_f32_16x16x32_bf16 v[56:59], v[116:119], v[84:87], v[56:59]
    v_mfma_f32_16x16x32_bf16 v[60:63], v[120:123], v[84:87], v[60:63]
    v_mfma_f32_16x16x32_bf16 v[68:71], v[4:7], v[84:87], v[68:71]
    s_waitcnt vmcnt(6)
    s_barrier
    s_waitcnt lgkmcnt(3)
    v_mfma_f32_16x16x32_bf16 v[16:19], v[124:127], v[88:91], v[16:19]
    ds_read_b128 v[72:75], v8 offset:32768
    v_mfma_f32_16x16x32_bf16 v[20:23], v[128:131], v[88:91], v[20:23]
    v_mfma_f32_16x16x32_bf16 v[24:27], v[132:135], v[88:91], v[24:27]
    buffer_load_dwordx4 v12, s[16:19], s29 offen offset:2048 sc1 lds
    s_waitcnt lgkmcnt(3)
    v_mfma_f32_16x16x32_bf16 v[28:31], v[124:127], v[92:95], v[28:31]
    ds_read_b128 v[76:79], v8 offset:33792
    v_mfma_f32_16x16x32_bf16 v[32:35], v[128:131], v[92:95], v[32:35]
    v_mfma_f32_16x16x32_bf16 v[36:39], v[132:135], v[92:95], v[36:39]
    s_waitcnt lgkmcnt(3)
    v_mfma_f32_16x16x32_bf16 v[40:43], v[124:127], v[96:99], v[40:43]
    ds_read_b128 v[80:83], v9 offset:32768
    v_mfma_f32_16x16x32_bf16 v[44:47], v[128:131], v[96:99], v[44:47]
    v_mfma_f32_16x16x32_bf16 v[48:51], v[132:135], v[96:99], v[48:51]
    v_mfma_f32_16x16x32_bf16 v[64:67], v[4:7], v[96:99], v[64:67]
    buffer_load_dwordx4 v13, s[16:19], s29 offen offset:3072 sc1 lds
    s_waitcnt lgkmcnt(3)
    v_mfma_f32_16x16x32_bf16 v[52:55], v[124:127], v[100:103], v[52:55]
    ds_read_b128 v[84:87], v9 offset:33792
    v_mfma_f32_16x16x32_bf16 v[56:59], v[128:131], v[100:103], v[56:59]
    v_mfma_f32_16x16x32_bf16 v[60:63], v[132:135], v[100:103], v[60:63]
    v_mfma_f32_16x16x32_bf16 v[68:71], v[4:7], v[100:103], v[68:71]
    s_waitcnt lgkmcnt(3)
    v_mfma_f32_16x16x32_bf16 v[16:19], v[136:139], v[72:75], v[16:19]
    ds_read_b128 v[88:91], v8 offset:36864
    v_mfma_f32_16x16x32_bf16 v[20:23], v[140:143], v[72:75], v[20:23]
    v_mfma_f32_16x16x32_bf16 v[24:27], v[144:147], v[72:75], v[24:27]
    s_add_u32 s60, s31, 7
    s_and_b32 s60, s60, 7
    s_lshl_b32 s60, s60, 11
    s_add_u32 s29, s22, s60
    s_mov_b32 m0, s23
    s_add_u32 s23, s23, s28
    buffer_load_dwordx4 v10, s[16:19], s29 offen offset:0 sc1 lds
    s_waitcnt lgkmcnt(3)
    v_mfma_f32_16x16x32_bf16 v[28:31], v[136:139], v[76:79], v[28:31]
    ds_read_b128 v[92:95], v8 offset:37888
    v_mfma_f32_16x16x32_bf16 v[32:35], v[140:143], v[76:79], v[32:35]
    v_mfma_f32_16x16x32_bf16 v[36:39], v[144:147], v[76:79], v[36:39]
    s_waitcnt lgkmcnt(3)
    v_mfma_f32_16x16x32_bf16 v[40:43], v[136:139], v[80:83], v[40:43]
    ds_read_b128 v[96:99], v9 offset:36864
    v_mfma_f32_16x16x32_bf16 v[44:47], v[140:143], v[80:83], v[44:47]
    v_mfma_f32_16x16x32_bf16 v[48:51], v[144:147], v[80:83], v[48:51]
    v_mfma_f32_16x16x32_bf16 v[64:67], v[4:7], v[80:83], v[64:67]
    buffer_load_dwordx4 v11, s[16:19], s29 offen offset:1024 sc1 lds
    s_waitcnt lgkmcnt(3)
    v_mfma_f32_16x16x32_bf16 v[52:55], v[136:139], v[84:87], v[52:55]
    ds_read_b128 v[100:103], v9 offset:37888
    v_mfma_f32_16x16x32_bf16 v[56:59], v[140:143], v[84:87], v[56:59]
    v_mfma_f32_16x16x32_bf16 v[60:63], v[144:147], v[84:87], v[60:63]
    v_mfma_f32_16x16x32_bf16 v[68:71], v[4:7], v[84:87], v[68:71]
    s_waitcnt vmcnt(6)
    s_barrier
    s_waitcnt lgkmcnt(3)
    v_mfma_f32_16x16x32_bf16 v[16:19], v[148:151], v[88:91], v[16:19]
    ds_read_b128 v[72:75], v8 offset:40960
    v_mfma_f32_16x16x32_bf16 v[20:23], v[152:155], v[88:91], v[20:23]
    v_mfma_f32_16x16x32_bf16 v[24:27], v[156:159], v[88:91], v[24:27]
    buffer_load_dwordx4 v12, s[16:19], s29 offen offset:2048 sc1 lds
    s_waitcnt lgkmcnt(3)
    v_mfma_f32_16x16x32_bf16 v[28:31], v[148:151], v[92:95], v[28:31]
    ds_read_b128 v[76:79], v8 offset:41984
    v_mfma_f32_16x16x32_bf16 v[32:35], v[152:155], v[92:95], v[32:35]
    v_mfma_f32_16x16x32_bf16 v[36:39], v[156:159], v[92:95], v[36:39]
    s_waitcnt lgkmcnt(3)
    v_mfma_f32_16x16x32_bf16 v[40:43], v[148:151], v[96:99], v[40:43]
    ds_read_b128 v[80:83], v9 offset:40960
    v_mfma_f32_16x16x32_bf16 v[44:47], v[152:155], v[96:99], v[44:47]
    v_mfma_f32_16x16x32_bf16 v[48:51], v[156:159], v[96:99], v[48:51]
    v_mfma_f32_16x16x32_bf16 v[64:67], v[4:7], v[96:99], v[64:67]
    buffer_load_dwordx4 v13, s[16:19], s29 offen offset:3072 sc1 lds
    s_waitcnt lgkmcnt(3)
    v_mfma_f32_16x16x32_bf16 v[52:55], v[148:151], v[100:103], v[52:55]
    ds_read_b128 v[84:87], v9 offset:41984
    v_mfma_f32_16x16x32_bf16 v[56:59], v[152:155], v[100:103], v[56:59]
    v_mfma_f32_16x16x32_bf16 v[60:63], v[156:159], v[100:103], v[60:63]
    v_mfma_f32_16x16x32_bf16 v[68:71], v[4:7], v[100:103], v[68:71]
    s_waitcnt lgkmcnt(3)
    v_mfma_f32_16x16x32_bf16 v[16:19], v[160:163], v[72:75], v[16:19]
    ds_read_b128 v[88:91], v8 offset:45056
    v_mfma_f32_16x16x32_bf16 v[20:23], v[164:167], v[72:75], v[20:23]
    v_mfma_f32_16x16x32_bf16 v[24:27], v[168:171], v[72:75], v[24:27]
    s_waitcnt lgkmcnt(3)
    v_mfma_f32_16x16x32_bf16 v[28:31], v[160:163], v[76:79], v[28:31]
    ds_read_b128 v[92:95], v8 offset:46080
    v_mfma_f32_16x16x32_bf16 v[32:35], v[164:167], v[76:79], v[32:35]
    v_mfma_f32_16x16x32_bf16 v[36:39], v[168:171], v[76:79], v[36:39]
    s_waitcnt lgkmcnt(3)
    v_mfma_f32_16x16x32_bf16 v[40:43], v[160:163], v[80:83], v[40:43]
    ds_read_b128 v[96:99], v9 offset:45056
    v_mfma_f32_16x16x32_bf16 v[44:47], v[164:167], v[80:83], v[44:47]
    v_mfma_f32_16x16x32_bf16 v[48:51], v[168:171], v[80:83], v[48:51]
    v_mfma_f32_16x16x32_bf16 v[64:67], v[4:7], v[80:83], v[64:67]
    s_waitcnt lgkmcnt(3)
    v_mfma_f32_16x16x32_bf16 v[52:55], v[160:163], v[84:87], v[52:55]
    ds_read_b128 v[100:103], v9 offset:46080
    v_mfma_f32_16x16x32_bf16 v[56:59], v[164:167], v[84:87], v[56:59]
    v_mfma_f32_16x16x32_bf16 v[60:63], v[168:171], v[84:87], v[60:63]
    v_mfma_f32_16x16x32_bf16 v[68:71], v[4:7], v[84:87], v[68:71]
    s_waitcnt vmcnt(4)
    s_barrier
    s_waitcnt lgkmcnt(3)
    v_mfma_f32_16x16x32_bf16 v[16:19], v[172:175], v[88:91], v[16:19]
    ds_read_b128 v[72:75], v8 offset:49152
    v_mfma_f32_16x16x32_bf16 v[20:23], v[176:179], v[88:91], v[20:23]
    v_mfma_f32_16x16x32_bf16 v[24:27], v[180:183], v[88:91], v[24:27]
    s_waitcnt lgkmcnt(3)
    v_mfma_f32_16x16x32_bf16 v[28:31], v[172:175], v[92:95], v[28:31]
    ds_read_b128 v[76:79], v8 offset:50176
    v_mfma_f32_16x16x32_bf16 v[32:35], v[176:179], v[92:95], v[32:35]
    v_mfma_f32_16x16x32_bf16 v[36:39], v[180:183], v[92:95], v[36:39]
    s_waitcnt lgkmcnt(3)
    v_mfma_f32_16x16x32_bf16 v[40:43], v[172:175], v[96:99], v[40:43]
    ds_read_b128 v[80:83], v9 offset:49152
    v_mfma_f32_16x16x32_bf16 v[44:47], v[176:179], v[96:99], v[44:47]
    v_mfma_f32_16x16x32_bf16 v[48:51], v[180:183], v[96:99], v[48:51]
    v_mfma_f32_16x16x32_bf16 v[64:67], v[4:7], v[96:99], v[64:67]
    s_waitcnt lgkmcnt(3)
    v_mfma_f32_16x16x32_bf16 v[52:55], v[172:175], v[100:103], v[52:55]
    ds_read_b128 v[84:87], v9 offset:50176
    v_mfma_f32_16x16x32_bf16 v[56:59], v[176:179], v[100:103], v[56:59]
    v_mfma_f32_16x16x32_bf16 v[60:63], v[180:183], v[100:103], v[60:63]
    v_mfma_f32_16x16x32_bf16 v[68:71], v[4:7], v[100:103], v[68:71]
    s_waitcnt lgkmcnt(3)
    v_mfma_f32_16x16x32_bf16 v[16:19], v[184:187], v[72:75], v[16:19]
    ds_read_b128 v[88:91], v8 offset:53248
    v_mfma_f32_16x16x32_bf16 v[20:23], v[188:191], v[72:75], v[20:23]
    v_mfma_f32_16x16x32_bf16 v[24:27], v[192:195], v[72:75], v[24:27]
    s_waitcnt lgkmcnt(3)
    v_mfma_f32_16x16x32_bf16 v[28:31], v[184:187], v[76:79], v[28:31]
    ds_read_b128 v[92:95], v8 offset:54272
    v_mfma_f32_16x16x32_bf16 v[32:35], v[188:191], v[76:79], v[32:35]
    v_mfma_f32_16x16x32_bf16 v[36:39], v[192:195], v[76:79], v[36:39]
    s_waitcnt lgkmcnt(3)
    v_mfma_f32_16x16x32_bf16 v[40:43], v[184:187], v[80:83], v[40:43]
    ds_read_b128 v[96:99], v9 offset:53248
    v_mfma_f32_16x16x32_bf16 v[44:47], v[188:191], v[80:83], v[44:47]
    v_mfma_f32_16x16x32_bf16 v[48:51], v[192:195], v[80:83], v[48:51]
    v_mfma_f32_16x16x32_bf16 v[64:67], v[4:7], v[80:83], v[64:67]
    s_waitcnt lgkmcnt(3)
    v_mfma_f32_16x16x32_bf16 v[52:55], v[184:187], v[84:87], v[52:55]
    ds_read_b128 v[100:103], v9 offset:54272
    v_mfma_f32_16x16x32_bf16 v[56:59], v[188:191], v[84:87], v[56:59]
    v_mfma_f32_16x16x32_bf16 v[60:63], v[192:195], v[84:87], v[60:63]
    v_mfma_f32_16x16x32_bf16 v[68:71], v[4:7], v[84:87], v[68:71]
    s_waitcnt vmcnt(0)
    s_barrier
    s_waitcnt lgkmcnt(3)
    v_mfma_f32_16x16x32_bf16 v[16:19], v[196:199], v[88:91], v[16:19]
    ds_read_b128 v[72:75], v8 offset:57344
    v_mfma_f32_16x16x32_bf16 v[20:23], a[0:3], v[88:91], v[20:23]
    v_mfma_f32_16x16x32_bf16 v[24:27], a[4:7], v[88:91], v[24:27]
    s_waitcnt lgkmcnt(3)
    v_mfma_f32_16x16x32_bf16 v[28:31], v[196:199], v[92:95], v[28:31]
    ds_read_b128 v[76:79], v8 offset:58368
    v_mfma_f32_16x16x32_bf16 v[32:35], a[0:3], v[92:95], v[32:35]
    v_mfma_f32_16x16x32_bf16 v[36:39], a[4:7], v[92:95], v[36:39]
    s_waitcnt lgkmcnt(3)
    v_mfma_f32_16x16x32_bf16 v[40:43], v[196:199], v[96:99], v[40:43]
    ds_read_b128 v[80:83], v9 offset:57344
    v_mfma_f32_16x16x32_bf16 v[44:47], a[0:3], v[96:99], v[44:47]
    v_mfma_f32_16x16x32_bf16 v[48:51], a[4:7], v[96:99], v[48:51]
    v_mfma_f32_16x16x32_bf16 v[64:67], v[4:7], v[96:99], v[64:67]
    s_waitcnt lgkmcnt(3)
    v_mfma_f32_16x16x32_bf16 v[52:55], v[196:199], v[100:103], v[52:55]
    ds_read_b128 v[84:87], v9 offset:58368
    v_mfma_f32_16x16x32_bf16 v[56:59], a[0:3], v[100:103], v[56:59]
    v_mfma_f32_16x16x32_bf16 v[60:63], a[4:7], v[100:103], v[60:63]
    v_mfma_f32_16x16x32_bf16 v[68:71], v[4:7], v[100:103], v[68:71]
    s_waitcnt lgkmcnt(3)
    v_mfma_f32_16x16x32_bf16 v[16:19], a[8:11], v[72:75], v[16:19]
    ds_read_b128 v[88:91], v8 offset:61440
    v_mfma_f32_16x16x32_bf16 v[20:23], a[12:15], v[72:75], v[20:23]
    v_mfma_f32_16x16x32_bf16 v[24:27], a[16:19], v[72:75], v[24:27]
    s_waitcnt lgkmcnt(3)
    v_mfma_f32_16x16x32_bf16 v[28:31], a[8:11], v[76:79], v[28:31]
    ds_read_b128 v[92:95], v8 offset:62464
    v_mfma_f32_16x16x32_bf16 v[32:35], a[12:15], v[76:79], v[32:35]
    v_mfma_f32_16x16x32_bf16 v[36:39], a[16:19], v[76:79], v[36:39]
    s_waitcnt lgkmcnt(3)
    v_mfma_f32_16x16x32_bf16 v[40:43], a[8:11], v[80:83], v[40:43]
    ds_read_b128 v[96:99], v9 offset:61440
    v_mfma_f32_16x16x32_bf16 v[44:47], a[12:15], v[80:83], v[44:47]
    v_mfma_f32_16x16x32_bf16 v[48:51], a[16:19], v[80:83], v[48:51]
    v_mfma_f32_16x16x32_bf16 v[64:67], v[4:7], v[80:83], v[64:67]
    s_waitcnt lgkmcnt(3)
    v_mfma_f32_16x16x32_bf16 v[52:55], a[8:11], v[84:87], v[52:55]
    ds_read_b128 v[100:103], v9 offset:62464
    v_mfma_f32_16x16x32_bf16 v[56:59], a[12:15], v[84:87], v[56:59]
    v_mfma_f32_16x16x32_bf16 v[60:63], a[16:19], v[84:87], v[60:63]
    v_mfma_f32_16x16x32_bf16 v[68:71], v[4:7], v[84:87], v[68:71]
    s_waitcnt lgkmcnt(3)
    v_mfma_f32_16x16x32_bf16 v[16:19], a[20:23], v[88:91], v[16:19]
    v_mfma_f32_16x16x32_bf16 v[20:23], a[24:27], v[88:91], v[20:23]
    v_mfma_f32_16x16x32_bf16 v[24:27], a[28:31], v[88:91], v[24:27]
    s_waitcnt lgkmcnt(2)
    v_mfma_f32_16x16x32_bf16 v[28:31], a[20:23], v[92:95], v[28:31]
    v_mfma_f32_16x16x32_bf16 v[32:35], a[24:27], v[92:95], v[32:35]
    v_mfma_f32_16x16x32_bf16 v[36:39], a[28:31], v[92:95], v[36:39]
    s_waitcnt lgkmcnt(1)
    v_mfma_f32_16x16x32_bf16 v[40:43], a[20:23], v[96:99], v[40:43]
    v_mfma_f32_16x16x32_bf16 v[44:47], a[24:27], v[96:99], v[44:47]
    v_mfma_f32_16x16x32_bf16 v[48:51], a[28:31], v[96:99], v[48:51]
    v_mfma_f32_16x16x32_bf16 v[64:67], v[4:7], v[96:99], v[64:67]
    s_waitcnt lgkmcnt(0)
    v_mfma_f32_16x16x32_bf16 v[52:55], a[20:23], v[100:103], v[52:55]
    v_mfma_f32_16x16x32_bf16 v[56:59], a[24:27], v[100:103], v[56:59]
    v_mfma_f32_16x16x32_bf16 v[60:63], a[28:31], v[100:103], v[60:63]
    v_mfma_f32_16x16x32_bf16 v[68:71], v[4:7], v[100:103], v[68:71]
pd_epi:
    s_mul_i32 s21, s20, 6144
    s_add_u32 s21, s21, 131072
    v_add_u32 v10, s21, v254
    v_and_b32 v12, 15, v255
    v_lshlrev_b32 v12, 2, v12
    s_xor_b32 s60, s58, s59
    s_lshl_b32 s60, s60, 7
    s_lshl_b32 s21, s58, 8
    s_add_u32 s21, s21, s60
    s_add_u32 s21, s21, 155648
    v_add_u32 v11, s21, v12
    s_lshl_b32 s21, s58, 7
    s_add_u32 s21, s21, 155648
    v_add_u32 v12, s21, v12
    ds_write_b128 v10, v[40:43] offset:0
    ds_write_b128 v10, v[44:47] offset:1024
    ds_write_b128 v10, v[48:51] offset:2048
    s_xor_b32 s21, s20, 2
    s_mul_i32 s21, s21, 6144
    s_add_u32 s21, s21, 131072
    v_add_u32 v13, s21, v254
    ds_write_b128 v10, v[52:55] offset:3072
    ds_write_b128 v10, v[56:59] offset:4096
    ds_write_b128 v10, v[60:63] offset:5120
    ds_write_b32 v11, v64
    ds_write_b32 v11, v68 offset:64
    v_and_b32 v1, 31, v255
    v_mul_u32_u24 v1, 1024, v1
    v_lshrrev_b32 v2, 5, v255
    v_lshlrev_b32 v2, 5, v2
    v_add3_u32 v1, v1, v2, 0
    v_add_u32 v1, 18939904, v1
    s_waitcnt lgkmcnt(0)
    s_barrier
    ds_read_b32 v64, v12
    ds_read_b32 v65, v12 offset:64
    ds_read_b32 v66, v12 offset:256
    ds_read_b32 v67, v12 offset:320
    ds_read_b128 v[40:43], v13 offset:0
    ds_read_b128 v[44:47], v13 offset:1024
    ds_read_b128 v[48:51], v13 offset:2048
    ds_read_b128 v[52:55], v13 offset:3072
    ds_read_b128 v[56:59], v13 offset:4096
    ds_read_b128 v[60:63], v13 offset:5120
    s_waitcnt lgkmcnt(6)
    v_add_f32 v64, v64, v66
    v_add_f32 v65, v65, v67
    v_rcp_f32 v64, v64
    v_rcp_f32 v65, v65
    s_waitcnt lgkmcnt(5)
    v_pk_add_f32 v[16:17], v[16:17], v[40:41]
    v_pk_add_f32 v[18:19], v[18:19], v[42:43]
    v_pk_mul_f32 v[16:17], v[16:17], v[64:65] op_sel:[0,0] op_sel_hi:[1,0]
    v_pk_mul_f32 v[18:19], v[18:19], v[64:65] op_sel:[0,0] op_sel_hi:[1,0]
    v_pk_fma_f32 v[16:17], v[16:17], v[212:213], v[224:225]
    v_pk_fma_f32 v[18:19], v[18:19], v[214:215], v[226:227]
    v_cvt_pk_bf16_f32 v72, v16, v17
    v_cvt_pk_bf16_f32 v73, v18, v19
    buffer_store_dwordx2 v[72:73], v236, s[48:51], s26 offen offset:0
    s_waitcnt lgkmcnt(4)
    v_pk_add_f32 v[20:21], v[20:21], v[44:45]
    v_pk_add_f32 v[22:23], v[22:23], v[46:47]
    v_pk_mul_f32 v[20:21], v[20:21], v[64:65] op_sel:[0,0] op_sel_hi:[1,0]
    v_pk_mul_f32 v[22:23], v[22:23], v[64:65] op_sel:[0,0] op_sel_hi:[1,0]
    v_pk_fma_f32 v[20:21], v[20:21], v[216:217], v[228:229]
    v_pk_fma_f32 v[22:23], v[22:23], v[218:219], v[230:231]
    v_cvt_pk_bf16_f32 v74, v20, v21
    v_cvt_pk_bf16_f32 v75, v22, v23
    buffer_store_dwordx2 v[74:75], v236, s[48:51], s26 offen offset:32
    s_waitcnt lgkmcnt(3)
    v_pk_add_f32 v[24:25], v[24:25], v[48:49]
    v_pk_add_f32 v[26:27], v[26:27], v[50:51]
    v_pk_mul_f32 v[24:25], v[24:25], v[64:65] op_sel:[0,0] op_sel_hi:[1,0]
    v_pk_mul_f32 v[26:27], v[26:27], v[64:65] op_sel:[0,0] op_sel_hi:[1,0]
    v_pk_fma_f32 v[24:25], v[24:25], v[220:221], v[232:233]
    v_pk_fma_f32 v[26:27], v[26:27], v[222:223], v[234:235]
    v_cvt_pk_bf16_f32 v76, v24, v25
    v_cvt_pk_bf16_f32 v77, v26, v27
    buffer_store_dwordx2 v[76:77], v236, s[48:51], s26 offen offset:64
    s_waitcnt lgkmcnt(2)
    v_pk_add_f32 v[28:29], v[28:29], v[52:53]
    v_pk_add_f32 v[30:31], v[30:31], v[54:55]
    v_pk_mul_f32 v[28:29], v[28:29], v[64:65] op_sel:[0,1] op_sel_hi:[1,1]
    v_pk_mul_f32 v[30:31], v[30:31], v[64:65] op_sel:[0,1] op_sel_hi:[1,1]
    v_pk_fma_f32 v[28:29], v[28:29], v[212:213], v[200:201]
    v_pk_fma_f32 v[30:31], v[30:31], v[214:215], v[202:203]
    v_cvt_pk_bf16_f32 v78, v28, v29
    v_cvt_pk_bf16_f32 v79, v30, v31
    buffer_store_dwordx2 v[78:79], v239, s[48:51], s26 offen offset:0
    s_waitcnt lgkmcnt(1)
    v_pk_add_f32 v[32:33], v[32:33], v[56:57]
    v_pk_add_f32 v[34:35], v[34:35], v[58:59]
    v_pk_mul_f32 v[32:33], v[32:33], v[64:65] op_sel:[0,1] op_sel_hi:[1,1]
    v_pk_mul_f32 v[34:35], v[34:35], v[64:65] op_sel:[0,1] op_sel_hi:[1,1]
    v_pk_fma_f32 v[32:33], v[32:33], v[216:217], v[204:205]
    v_pk_fma_f32 v[34:35], v[34:35], v[218:219], v[206:207]
    v_cvt_pk_bf16_f32 v80, v32, v33
    v_cvt_pk_bf16_f32 v81, v34, v35
    buffer_store_dwordx2 v[80:81], v239, s[48:51], s26 offen offset:32
    s_waitcnt lgkmcnt(0)
    v_pk_add_f32 v[36:37], v[36:37], v[60:61]
    v_pk_add_f32 v[38:39], v[38:39], v[62:63]
    v_pk_mul_f32 v[36:37], v[36:37], v[64:65] op_sel:[0,1] op_sel_hi:[1,1]
    v_pk_mul_f32 v[38:39], v[38:39], v[64:65] op_sel:[0,1] op_sel_hi:[1,1]
    v_pk_fma_f32 v[36:37], v[36:37], v[220:221], v[208:209]
    v_pk_fma_f32 v[38:39], v[38:39], v[222:223], v[210:211]
    v_cvt_pk_bf16_f32 v82, v36, v37
    v_cvt_pk_bf16_f32 v83, v38, v39
    buffer_store_dwordx2 v[82:83], v239, s[48:51], s26 offen offset:64
    s_or_b32 s60, s2, s20
    s_cmp_eq_u32 s60, 0
    s_cbranch_scc0 ep_end_49
    s_mov_b32 s60, 0
ep_top_50:
    buffer_load_dwordx2 v[12:13], v1, s[16:19], 0 offen sc1
    buffer_load_dwordx2 v[14:15], v1, s[16:19], 0 offen offset:16 sc1
    s_add_u32 s60, s60, 1
    s_cmp_gt_u32 s60, 20000
    s_cbranch_scc1 ep_end_49
    s_waitcnt vmcnt(0)
    v_cmp_ne_u32 vcc, s37, v12
    v_cmp_ne_u32 s[62:63], s37, v13
    s_or_b64 vcc, vcc, s[62:63]
    v_cmp_ne_u32 s[62:63], s37, v14
    s_or_b64 vcc, vcc, s[62:63]
    v_cmp_ne_u32 s[62:63], s37, v15
    s_or_b64 vcc, vcc, s[62:63]
    s_cmp_eq_u64 vcc, 0
    s_cbranch_scc0 ep_top_50
    v_mov_b32 v12, s37
    v_mov_b32 v13, 262144
    s_mov_b64 exec, 1
    buffer_store_dword v12, v13, s[16:19], 0 offen sc1
ep_end_49:
L_exit:
    s_endpgm
slowc_34:
    v_max3_f32 v57, v16, v17, v18
    v_max3_f32 v57, v57, v19, v20
    v_max3_f32 v57, v57, v21, v22
    v_max3_f32 v57, v57, v23, v24
    v_max3_f32 v57, v57, v25, v26
    v_max3_f32 v57, v57, v27, v28
    v_max3_f32 v57, v57, v29, v30
    v_max_f32 v58, v57, v31
    v_max_f32 v57, v57, v31
    s_nop 1
    v_permlane32_swap_b32 v57, v58
    s_nop 1
    v_max_f32 v58, v57, v58
    v_sub_f32 v16, v16, v58
    v_sub_f32 v17, v17, v58
    v_sub_f32 v18, v18, v58
    v_sub_f32 v19, v19, v58
    v_sub_f32 v20, v20, v58
    v_sub_f32 v21, v21, v58
    v_sub_f32 v22, v22, v58
    v_sub_f32 v23, v23, v58
    v_sub_f32 v24, v24, v58
    v_sub_f32 v25, v25, v58
    v_sub_f32 v26, v26, v58
    v_sub_f32 v27, v27, v58
    v_sub_f32 v28, v28, v58
    v_sub_f32 v29, v29, v58
    v_sub_f32 v30, v30, v58
    v_sub_f32 v31, v31, v58
    s_lshl_b32 s60, s34, 5
    s_lshl_b32 s61, s35, 2
    s_add_u32 s60, s60, s61
    s_add_u32 s60, s60, s20
    s_lshl_b32 s60, s60, 10
    s_lshl_b32 s61, s36, 6
    s_add_u32 s60, s60, s61
    s_add_u32 s60, s60, 0
    s_lshl_b32 s60, s60, 3
    s_add_u32 s60, s60, 17825792
    v_and_b32 v57, 31, v255
    v_lshlrev_b32 v57, 3, v57
    v_mov_b32 v59, s37
    buffer_store_dwordx2 v[58:59], v57, s[16:19], s60 offen sc1
    s_add_u32 s60, s97, 8
    v_lshlrev_b32 v60, 7, v255
    s_mov_b64 exec, 255
    buffer_store_dword v59, v60, s[16:19], s60 offen sc1
    s_mov_b64 exec, -1
    s_branch slowc_back_33
slowc_38:
    v_max3_f32 v57, v32, v33, v34
    v_max3_f32 v57, v57, v35, v36
    v_max3_f32 v57, v57, v37, v38
    v_max3_f32 v57, v57, v39, v40
    v_max3_f32 v57, v57, v41, v42
    v_max3_f32 v57, v57, v43, v44
    v_max3_f32 v57, v57, v45, v46
    v_max_f32 v58, v57, v47
    v_max_f32 v57, v57, v47
    s_nop 1
    v_permlane32_swap_b32 v57, v58
    s_nop 1
    v_max_f32 v58, v57, v58
    v_sub_f32 v32, v32, v58
    v_sub_f32 v33, v33, v58
    v_sub_f32 v34, v34, v58
    v_sub_f32 v35, v35, v58
    v_sub_f32 v36, v36, v58
    v_sub_f32 v37, v37, v58
    v_sub_f32 v38, v38, v58
    v_sub_f32 v39, v39, v58
    v_sub_f32 v40, v40, v58
    v_sub_f32 v41, v41, v58
    v_sub_f32 v42, v42, v58
    v_sub_f32 v43, v43, v58
    v_sub_f32 v44, v44, v58
    v_sub_f32 v45, v45, v58
    v_sub_f32 v46, v46, v58
    v_sub_f32 v47, v47, v58
    s_lshl_b32 s60, s34, 5
    s_lshl_b32 s61, s35, 2
    s_add_u32 s60, s60, s61
    s_add_u32 s60, s60, s20
    s_lshl_b32 s60, s60, 10
    s_lshl_b32 s61, s36, 6
    s_add_u32 s60, s60, s61
    s_add_u32 s60, s60, 32
    s_lshl_b32 s60, s60, 3
    s_add_u32 s60, s60, 17825792
    v_and_b32 v57, 31, v255
    v_lshlrev_b32 v57, 3, v57
    v_mov_b32 v59, s37
    buffer_store_dwordx2 v[58:59], v57, s[16:19], s60 offen sc1
    s_add_u32 s60, s97, 8
    v_lshlrev_b32 v60, 7, v255
    s_mov_b64 exec, 255
    buffer_store_dword v59, v60, s[16:19], s60 offen sc1
    s_mov_b64 exec, -1
    s_branch slowc_back_37
slowd_48:
    s_add_u32 s60, s31, 3
    s_and_b32 s60, s60, 7
    s_lshl_b32 s60, s60, 11
    s_add_u32 s29, s22, s60
    s_mov_b32 m0, s23
    s_add_u32 s23, s23, s28
    buffer_load_dwordx4 v10, s[16:19], s29 offen offset:0 sc1 lds
    buffer_load_dwordx4 v11, s[16:19], s29 offen offset:1024 sc1 lds
    buffer_load_dwordx4 v12, s[16:19], s29 offen offset:2048 sc1 lds
    buffer_load_dwordx4 v13, s[16:19], s29 offen offset:3072 sc1 lds
    s_add_u32 s60, s31, 4
    s_and_b32 s60, s60, 7
    s_lshl_b32 s60, s60, 11
    s_add_u32 s29, s22, s60
    s_mov_b32 m0, s23
    s_add_u32 s23, s23, s28
    buffer_load_dwordx4 v10, s[16:19], s29 offen offset:0 sc1 lds
    buffer_load_dwordx4 v11, s[16:19], s29 offen offset:1024 sc1 lds
    buffer_load_dwordx4 v12, s[16:19], s29 offen offset:2048 sc1 lds
    buffer_load_dwordx4 v13, s[16:19], s29 offen offset:3072 sc1 lds
    s_add_u32 s60, s31, 5
    s_and_b32 s60, s60, 7
    s_lshl_b32 s60, s60, 11
    s_add_u32 s29, s22, s60
    s_mov_b32 m0, s23
    s_add_u32 s23, s23, s28
    buffer_load_dwordx4 v10, s[16:19], s29 offen offset:0 sc1 lds
    buffer_load_dwordx4 v11, s[16:19], s29 offen offset:1024 sc1 lds
    buffer_load_dwordx4 v12, s[16:19], s29 offen offset:2048 sc1 lds
    buffer_load_dwordx4 v13, s[16:19], s29 offen offset:3072 sc1 lds
    s_add_u32 s60, s31, 6
    s_and_b32 s60, s60, 7
    s_lshl_b32 s60, s60, 11
    s_add_u32 s29, s22, s60
    s_mov_b32 m0, s23
    s_add_u32 s23, s23, s28
    buffer_load_dwordx4 v10, s[16:19], s29 offen offset:0 sc1 lds
    buffer_load_dwordx4 v11, s[16:19], s29 offen offset:1024 sc1 lds
    buffer_load_dwordx4 v12, s[16:19], s29 offen offset:2048 sc1 lds
    buffer_load_dwordx4 v13, s[16:19], s29 offen offset:3072 sc1 lds
    s_add_u32 s60, s31, 7
    s_and_b32 s60, s60, 7
    s_lshl_b32 s60, s60, 11
    s_add_u32 s29, s22, s60
    s_mov_b32 m0, s23
    s_add_u32 s23, s23, s28
    buffer_load_dwordx4 v10, s[16:19], s29 offen offset:0 sc1 lds
    buffer_load_dwordx4 v11, s[16:19], s29 offen offset:1024 sc1 lds
    buffer_load_dwordx4 v12, s[16:19], s29 offen offset:2048 sc1 lds
    buffer_load_dwordx4 v13, s[16:19], s29 offen offset:3072 sc1 lds
    s_waitcnt vmcnt(0) lgkmcnt(0)
    s_barrier
    v_and_b32 v1, 15, v255
    v_lshlrev_b32 v1, 3, v1
    v_lshrrev_b32 v2, 4, v255
    v_lshlrev_b32 v2, 13, v2
    v_add_u32 v2, v1, v2
    s_lshl_b32 s60, s34, 15
    s_lshl_b32 s61, s56, 6
    s_add_u32 s60, s60, s61
    s_lshl_b32 s60, s60, 3
    s_add_u32 s24, s60, 17825792
    v_mov_b32 v96, 0xff800000
    v_mov_b32 v97, 0xff800000
    v_mov_b32 v98, 0xff800000
    v_mov_b32 v99, 0xff800000
    s_mov_b32 s25, 0
    s_mov_b32 s60, s24
sd_max_51:
    buffer_load_dwordx2 v[80:81], v2, s[16:19], s60 offen offset:0 sc1
    buffer_load_dwordx2 v[82:83], v2, s[16:19], s60 offen offset:128 sc1
    buffer_load_dwordx2 v[84:85], v2, s[16:19], s60 offen offset:256 sc1
    buffer_load_dwordx2 v[86:87], v2, s[16:19], s60 offen offset:384 sc1
    s_waitcnt vmcnt(0)
    v_cmp_eq_u32 vcc, s37, v81
    v_cndmask_b32 v80, 0, v80, vcc
    v_max_f32 v96, v96, v80
    v_cmp_eq_u32 vcc, s37, v83
    v_cndmask_b32 v82, 0, v82, vcc
    v_max_f32 v97, v97, v82
    v_cmp_eq_u32 vcc, s37, v85
    v_cndmask_b32 v84, 0, v84, vcc
    v_max_f32 v98, v98, v84
    v_cmp_eq_u32 vcc, s37, v87
    v_cndmask_b32 v86, 0, v86, vcc
    v_max_f32 v99, v99, v86
    s_add_u32 s60, s60, 32768
    s_add_u32 s25, s25, 1
    s_cmp_lt_u32 s25, 8
    s_cbranch_scc1 sd_max_51
    v_mov_b32 v80, v96
    s_nop 1
    v_permlane16_swap_b32 v96, v80
    s_nop 1
    v_max_f32 v96, v96, v80
    v_mov_b32 v80, v96
    s_nop 1
    v_permlane32_swap_b32 v96, v80
    s_nop 1
    v_max_f32 v96, v96, v80
    v_mov_b32 v80, v97
    s_nop 1
    v_permlane16_swap_b32 v97, v80
    s_nop 1
    v_max_f32 v97, v97, v80
    v_mov_b32 v80, v97
    s_nop 1
    v_permlane32_swap_b32 v97, v80
    s_nop 1
    v_max_f32 v97, v97, v80
    v_mov_b32 v80, v98
    s_nop 1
    v_permlane16_swap_b32 v98, v80
    s_nop 1
    v_max_f32 v98, v98, v80
    v_mov_b32 v80, v98
    s_nop 1
    v_permlane32_swap_b32 v98, v80
    s_nop 1
    v_max_f32 v98, v98, v80
    v_mov_b32 v80, v99
    s_nop 1
    v_permlane16_swap_b32 v99, v80
    s_nop 1
    v_max_f32 v99, v99, v80
    v_mov_b32 v80, v99
    s_nop 1
    v_permlane32_swap_b32 v99, v80
    s_nop 1
    v_max_f32 v99, v99, v80
    s_lshl_b32 s61, s20, 15
    v_add_u32 v2, s61, v254
    s_mov_b32 s25, 0
sd_scale_52:
    s_lshl_b32 s60, s20, 3
    s_add_u32 s60, s60, s25
    s_add_u32 s60, s60, s30
    s_and_b32 s60, s60, 15
    s_lshl_b32 s61, s58, 4
    s_add_u32 s60, s60, s61
    s_lshl_b32 s60, s60, 13
    s_add_u32 s60, s60, s24
    buffer_load_dwordx2 v[80:81], v1, s[16:19], s60 offen offset:0 sc1
    ds_read_b128 v[64:67], v2 offset:0
    buffer_load_dwordx2 v[82:83], v1, s[16:19], s60 offen offset:128 sc1
    ds_read_b128 v[68:71], v2 offset:1024
    buffer_load_dwordx2 v[84:85], v1, s[16:19], s60 offen offset:256 sc1
    ds_read_b128 v[72:75], v2 offset:2048
    buffer_load_dwordx2 v[86:87], v1, s[16:19], s60 offen offset:384 sc1
    ds_read_b128 v[76:79], v2 offset:3072
    s_waitcnt vmcnt(0) lgkmcnt(0)
    v_cmp_eq_u32 vcc, s37, v81
    v_cndmask_b32 v80, 0, v80, vcc
    v_sub_f32 v80, v80, v96
    v_exp_f32 v80, v80
    s_nop 0
    v_lshlrev_b32 v100, 16, v64
    v_and_b32 v101, 0xffff0000, v64
    v_mul_f32 v100, v100, v80
    v_mul_f32 v101, v101, v80
    v_cvt_pk_bf16_f32 v64, v100, v101
    v_lshlrev_b32 v100, 16, v65
    v_and_b32 v101, 0xffff0000, v65
    v_mul_f32 v100, v100, v80
    v_mul_f32 v101, v101, v80
    v_cvt_pk_bf16_f32 v65, v100, v101
    v_lshlrev_b32 v100, 16, v66
    v_and_b32 v101, 0xffff0000, v66
    v_mul_f32 v100, v100, v80
    v_mul_f32 v101, v101, v80
    v_cvt_pk_bf16_f32 v66, v100, v101
    v_lshlrev_b32 v100, 16, v67
    v_and_b32 v101, 0xffff0000, v67
    v_mul_f32 v100, v100, v80
    v_mul_f32 v101, v101, v80
    v_cvt_pk_bf16_f32 v67, v100, v101
    ds_write_b128 v2, v[64:67] offset:0
    v_cmp_eq_u32 vcc, s37, v83
    v_cndmask_b32 v82, 0, v82, vcc
    v_sub_f32 v82, v82, v97
    v_exp_f32 v82, v82
    s_nop 0
    v_lshlrev_b32 v100, 16, v68
    v_and_b32 v101, 0xffff0000, v68
    v_mul_f32 v100, v100, v82
    v_mul_f32 v101, v101, v82
    v_cvt_pk_bf16_f32 v68, v100, v101
    v_lshlrev_b32 v100, 16, v69
    v_and_b32 v101, 0xffff0000, v69
    v_mul_f32 v100, v100, v82
    v_mul_f32 v101, v101, v82
    v_cvt_pk_bf16_f32 v69, v100, v101
    v_lshlrev_b32 v100, 16, v70
    v_and_b32 v101, 0xffff0000, v70
    v_mul_f32 v100, v100, v82
    v_mul_f32 v101, v101, v82
    v_cvt_pk_bf16_f32 v70, v100, v101
    v_lshlrev_b32 v100, 16, v71
    v_and_b32 v101, 0xffff0000, v71
    v_mul_f32 v100, v100, v82
    v_mul_f32 v101, v101, v82
    v_cvt_pk_bf16_f32 v71, v100, v101
    ds_write_b128 v2, v[68:71] offset:1024
    v_cmp_eq_u32 vcc, s37, v85
    v_cndmask_b32 v84, 0, v84, vcc
    v_sub_f32 v84, v84, v98
    v_exp_f32 v84, v84
    s_nop 0
    v_lshlrev_b32 v100, 16, v72
    v_and_b32 v101, 0xffff0000, v72
    v_mul_f32 v100, v100, v84
    v_mul_f32 v101, v101, v84
    v_cvt_pk_bf16_f32 v72, v100, v101
    v_lshlrev_b32 v100, 16, v73
    v_and_b32 v101, 0xffff0000, v73
    v_mul_f32 v100, v100, v84
    v_mul_f32 v101, v101, v84
    v_cvt_pk_bf16_f32 v73, v100, v101
    v_lshlrev_b32 v100, 16, v74
    v_and_b32 v101, 0xffff0000, v74
    v_mul_f32 v100, v100, v84
    v_mul_f32 v101, v101, v84
    v_cvt_pk_bf16_f32 v74, v100, v101
    v_lshlrev_b32 v100, 16, v75
    v_and_b32 v101, 0xffff0000, v75
    v_mul_f32 v100, v100, v84
    v_mul_f32 v101, v101, v84
    v_cvt_pk_bf16_f32 v75, v100, v101
    ds_write_b128 v2, v[72:75] offset:2048
    v_cmp_eq_u32 vcc, s37, v87
    v_cndmask_b32 v86, 0, v86, vcc
    v_sub_f32 v86, v86, v99
    v_exp_f32 v86, v86
    s_nop 0
    v_lshlrev_b32 v100, 16, v76
    v_and_b32 v101, 0xffff0000, v76
    v_mul_f32 v100, v100, v86
    v_mul_f32 v101, v101, v86
    v_cvt_pk_bf16_f32 v76, v100, v101
    v_lshlrev_b32 v100, 16, v77
    v_and_b32 v101, 0xffff0000, v77
    v_mul_f32 v100, v100, v86
    v_mul_f32 v101, v101, v86
    v_cvt_pk_bf16_f32 v77, v100, v101
    v_lshlrev_b32 v100, 16, v78
    v_and_b32 v101, 0xffff0000, v78
    v_mul_f32 v100, v100, v86
    v_mul_f32 v101, v101, v86
    v_cvt_pk_bf16_f32 v78, v100, v101
    v_lshlrev_b32 v100, 16, v79
    v_and_b32 v101, 0xffff0000, v79
    v_mul_f32 v100, v100, v86
    v_mul_f32 v101, v101, v86
    v_cvt_pk_bf16_f32 v79, v100, v101
    ds_write_b128 v2, v[76:79] offset:3072
    v_add_u32 v2, 4096, v2
    s_add_u32 s25, s25, 1
    s_cmp_lt_u32 s25, 8
    s_cbranch_scc1 sd_scale_52
    s_mov_b32 s28, 0
    s_mov_b32 s23, 131072
    s_waitcnt lgkmcnt(0)
    s_barrier
    ds_read_b128 v[72:75], v8 offset:0
    ds_read_b128 v[76:79], v8 offset:1024
    ds_read_b128 v[80:83], v9 offset:0
    ds_read_b128 v[84:87], v9 offset:1024
    v_mov_b32 v1, 0
    s_waitcnt lgkmcnt(0)
    s_branch slowd_back_47
    s_endpgm
L_codeend:
.section .rodata,"a"
.p2align 6
.amdhsa_kernel standalone__dit_adaln_block__diffusion_kernel
  .amdhsa_next_free_vgpr 512
  .amdhsa_next_free_sgpr 102
  .amdhsa_accum_offset 256
  .amdhsa_group_segment_fixed_size 0
  .amdhsa_kernarg_size 64
  .amdhsa_user_sgpr_count 2
  .amdhsa_user_sgpr_kernarg_segment_ptr 1
  .amdhsa_system_sgpr_workgroup_id_x 1
  .amdhsa_float_denorm_mode_32 3
.end_amdhsa_kernel
```
